```python
import torch

def _softmax(x, axis=-1):
    return torch.softmax(x, dim=axis)
def _gelu(x):
    return torch.nn.functional.gelu(x, approximate="tanh")
def _silu(x):
    return torch.nn.functional.silu(x)
def _sigmoid(x):
    return torch.sigmoid(x)
def _layernorm(x, axis=-1, eps=1e-5):
    m = x.mean(dim=axis, keepdim=True)
    v = x.var(dim=axis, keepdim=True, unbiased=False)
    return (x - m) / torch.sqrt(v + eps)
def _scatter_add(tgt, idx, src, axis=0):
    return tgt.clone().index_add_(axis, idx, src)
def _segment_sum(src, seg, n):
    out = torch.zeros((n,) + src.shape[1:], dtype=src.dtype)
    return out.index_add_(0, seg, src)
def _pad(x, pw):
    flat = tuple(v for pair in reversed(pw) for v in pair)
    return torch.nn.functional.pad(x, flat)

kernel_name = 'standalone__standard_2d_1d_3d_conv__vision'

def setup_inputs():

    _w = (lambda a: (lambda t: t.to(torch.bfloat16) if t.is_floating_point() else t)(torch.as_tensor(a)))
    H = W = 384
    C = 384
    K = 1
    return {
        "x": _w((lambda *s: torch.randn(*s, dtype=torch.bfloat16) * 0.05)(1, H, W, C)),
        "w": _w((lambda *s: torch.randn(*s, dtype=torch.bfloat16) * 0.05)(K, K, C, C)),
        "b": _w((lambda *s: torch.randn(*s, dtype=torch.bfloat16) * 0.05)(C)),
    }

def reference(x, w, b):
    B, H, W, Cin = x.shape
    K = w.shape[0]
    pl = (K - 1) // 2
    pr = K // 2
    xp = _pad(x, ((0, 0), (pl, pr), (pl, pr), (0, 0)))
    out = sum(
        torch.einsum('bhwc,cd->bhwd', xp[:, i:i+H, j:j+W, :], w[i, j])
        for i in range(K) for j in range(K)
    )
    return out + b[None, None, None, :]
```

```asm
; @launch grid=(256,1,1) block=(256,1,1) lds=160256
.amdgcn_target "amdgcn-amd-amdhsa--gfx950"
.text
.globl standalone__standard_2d_1d_3d_conv__vision_kernel
.p2align 8
.type standalone__standard_2d_1d_3d_conv__vision_kernel,@function
standalone__standard_2d_1d_3d_conv__vision_kernel:
    s_cmp_ge_u32 s2, 256
    s_cbranch_scc1 L_end
    s_load_dwordx8 s[4:11], s[0:1], 0
    s_load_dwordx2 s[28:29], s[0:1], 32
    s_load_dwordx2 s[74:75], s[0:1], 40
    v_and_b32 v20, 63, v0
    v_and_b32 v21, 15, v0
    v_lshrrev_b32 v22, 4, v20
    v_lshrrev_b32 v23, 6, v0
    v_lshlrev_b32 v28, 4, v0
    v_readfirstlane_b32 s32, v23
    v_lshlrev_b32 v29, 2, v0
    s_lshr_b32 s66, s2, 3
    s_mul_i32 s71, s66, 9216
    s_add_u32 s72, s71, 4096
    s_add_u32 s73, s71, 8192
    s_getpc_b64 s[44:45]
L_pc:
    s_lshl_b32 s39, s66, 15
    v_lshl_add_u32 v30, v0, 7, s39
    v_mov_b32 v31, s45
    v_cmp_gt_u32 vcc, L_end-L_pc, v30
    s_and_saveexec_b64 s[46:47], vcc
    s_cbranch_execz L_nocpf
    v_add_co_u32 v30, vcc, s44, v30
    s_nop 1
    v_addc_co_u32 v31, vcc, 0, v31, vcc
    global_load_dword v249, v[30:31], off
L_nocpf:
    s_mov_b64 exec, s[46:47]
    v_mul_u32_u24 v24, 12, v23
    v_add_u32 v24, v24, v22
    v_lshlrev_b32 v24, 8, v24
    v_add_u32 v25, 0, v22
    v_mul_u32_u24 v25, 11, v25
    v_lshrrev_b32 v25, 5, v25
    v_lshl_add_u32 v25, v23, 2, v25
    v_xor_b32 v25, v25, v21
    v_lshl_add_u32 v1, v25, 4, v24
    v_add_u32 v25, 4, v22
    v_mul_u32_u24 v25, 11, v25
    v_lshrrev_b32 v25, 5, v25
    v_lshl_add_u32 v25, v23, 2, v25
    v_xor_b32 v25, v25, v21
    v_lshl_add_u32 v2, v25, 4, v24
    v_add_u32 v25, 8, v22
    v_mul_u32_u24 v25, 11, v25
    v_lshrrev_b32 v25, 5, v25
    v_lshl_add_u32 v25, v23, 2, v25
    v_xor_b32 v25, v25, v21
    v_lshl_add_u32 v3, v25, 4, v24
    s_mul_i32 s42, s32, 3072
    s_mov_b32 s14, 113246208
    s_mov_b32 s15, 0x20000
    s_mov_b32 s18, 294912
    s_mov_b32 s19, 0x20000
    s_and_b32 s67, s2, 7
    s_lshr_b32 s68, s66, 1
    s_and_b32 s69, s66, 1
    s_sub_u32 s54, s66, s68
    s_sub_u32 s54, s54, 1
    s_cmp_eq_u32 s69, 0
    s_cselect_b32 s54, s68, s54
    s_cselect_b32 s34, 44040192, 0
    s_cselect_b32 s53, 13, 2
    s_lshl_b32 s54, s54, 3
    s_add_u32 s54, s54, s67
    s_mul_i32 s54, s54, 12288
    s_add_u32 s34, s34, s54
    s_mov_b32 s43, 1572864
    s_mov_b32 s35, s34
    s_mov_b32 m0, s42
    s_waitcnt lgkmcnt(0)
    s_mov_b32 s16, s6
    s_and_b32 s17, s7, 0xffff
    s_mov_b32 s12, s4
    s_and_b32 s13, s5, 0xffff
    buffer_load_dwordx4 v[240:243], v28, s[16:19], s71 offen
    buffer_load_dwordx4 v[244:247], v28, s[16:19], s72 offen
    buffer_load_dword v248, v29, s[16:19], s73 offen
L_x0:
    buffer_load_dwordx4 v1, s[12:15], s34 offen offset:0 nt lds
    buffer_load_dwordx4 v2, s[12:15], s34 offen offset:1024 nt lds
    buffer_load_dwordx4 v3, s[12:15], s34 offen offset:2048 nt lds
    s_add_u32 s34, s34, s43
    s_add_u32 m0, m0, 12288
    s_sub_u32 s53, s53, 1
    s_cmp_lg_u32 s53, 0
    s_cbranch_scc1 L_x0
    v_mul_u32_u24 v27, 192, v23
    v_mul_u32_u24 v26, 12, v21
    v_add_u32 v27, v27, v26
    v_mul_u32_u24 v26, 6144, v22
    v_add_u32 v10, v27, v26
    v_add_u32 v11, 3072, v10
    s_mov_b32 s26, 768
    s_mov_b32 s27, 0x20000
    s_mov_b32 s24, s8
    s_and_b32 s25, s9, 0xffff
    buffer_load_dwordx3 v[252:254], v27, s[24:27], 0 offen
    s_mov_b32 s39, 0
    buffer_load_dwordx3 v[160:162], v10, s[16:19], s39 offen offset:0
    buffer_load_dwordx3 v[164:166], v10, s[16:19], s39 offen offset:768
    buffer_load_dwordx3 v[168:170], v10, s[16:19], s39 offen offset:1536
    buffer_load_dwordx3 v[172:174], v10, s[16:19], s39 offen offset:2304
    buffer_load_dwordx3 v[176:178], v11, s[16:19], s39 offen offset:0
    buffer_load_dwordx3 v[180:182], v11, s[16:19], s39 offen offset:768
    buffer_load_dwordx3 v[184:186], v11, s[16:19], s39 offen offset:1536
    buffer_load_dwordx3 v[188:190], v11, s[16:19], s39 offen offset:2304
    s_mov_b32 s39, 24576
    buffer_load_dwordx3 v[84:86], v10, s[16:19], s39 offen offset:0
    buffer_load_dwordx3 v[88:90], v10, s[16:19], s39 offen offset:768
    buffer_load_dwordx3 v[92:94], v10, s[16:19], s39 offen offset:1536
    buffer_load_dwordx3 v[96:98], v10, s[16:19], s39 offen offset:2304
    buffer_load_dwordx3 v[100:102], v11, s[16:19], s39 offen offset:0
    buffer_load_dwordx3 v[104:106], v11, s[16:19], s39 offen offset:768
    buffer_load_dwordx3 v[108:110], v11, s[16:19], s39 offen offset:1536
    buffer_load_dwordx3 v[112:114], v11, s[16:19], s39 offen offset:2304
    s_mov_b32 s39, 49152
    buffer_load_dwordx3 v[116:118], v10, s[16:19], s39 offen offset:0
    buffer_load_dwordx3 v[120:122], v10, s[16:19], s39 offen offset:768
    buffer_load_dwordx3 v[124:126], v10, s[16:19], s39 offen offset:1536
    buffer_load_dwordx3 v[128:130], v10, s[16:19], s39 offen offset:2304
    buffer_load_dwordx3 v[136:138], v11, s[16:19], s39 offen offset:0
    buffer_load_dwordx3 v[140:142], v11, s[16:19], s39 offen offset:768
    buffer_load_dwordx3 v[144:146], v11, s[16:19], s39 offen offset:1536
    buffer_load_dwordx3 v[156:158], v11, s[16:19], s39 offen offset:2304
    v_xor_b32 v25, v22, v21
    v_lshlrev_b32 v25, 4, v25
    v_mul_u32_u24 v26, 768, v21
    v_add_u32 v8, v25, v26
    v_mul_u32_u24 v26, 3072, v22
    v_add_u32 v9, v27, v26
    v_mov_b32 v4, v8
    v_xor_b32 v5, 64, v8
    v_xor_b32 v6, 128, v8
    v_xor_b32 v7, 192, v8
    s_mov_b32 s40, 0x05040100
    s_mov_b32 s41, 0x07060302
    s_mov_b32 s22, 113246208
    s_mov_b32 s23, 0x20000
    s_mov_b32 s30, 0
    s_mov_b32 s31, 0x20000
    s_and_b32 s39, s68, 3
    s_mul_i32 s48, s39, 6291456
    s_add_u32 s48, s48, 88080384
    s_mul_i32 s70, s39, 4352
    s_add_u32 s70, s70, 1048576
    s_mul_i32 s39, s39, 64
    v_lshl_add_u32 v149, v20, 24, s39
    v_mov_b32 v153, 159744
    v_lshl_add_u32 v152, v20, 2, v153
    v_mov_b32 v150, 0
    v_mov_b32 v151, 0
    s_mov_b32 s20, s10
    s_and_b32 s21, s11, 0xffff
    s_and_b32 s29, s29, 0xffff
    v_mul_lo_u32 v148, v20, s43
    v_add_u32 v148, s35, v148
    s_cmp_eq_u32 s69, 0
    s_cbranch_scc1 L_proB
    s_mov_b32 s56, 0x36edfc
    s_mov_b32 s57, 0x0
    s_mov_b32 s58, 0xdb800000
    s_mov_b32 s59, 0xffffffff
    s_mov_b32 s62, 0xf6e00000
    s_mov_b32 s63, 0xffffffff
    s_mov_b32 s36, 73728
    s_mov_b32 s46, 6
    s_waitcnt vmcnt(24)
    v_lshlrev_b32 v12, 16, v252
    v_lshlrev_b32 v13, 16, v252
    v_lshlrev_b32 v14, 16, v252
    v_lshlrev_b32 v15, 16, v252
    v_and_b32 v16, 0xffff0000, v252
    v_and_b32 v17, 0xffff0000, v252
    v_and_b32 v18, 0xffff0000, v252
    v_and_b32 v19, 0xffff0000, v252
    v_lshlrev_b32 v20, 16, v253
    v_lshlrev_b32 v21, 16, v253
    v_lshlrev_b32 v22, 16, v253
    v_lshlrev_b32 v23, 16, v253
    v_and_b32 v24, 0xffff0000, v253
    v_and_b32 v25, 0xffff0000, v253
    v_and_b32 v26, 0xffff0000, v253
    v_and_b32 v27, 0xffff0000, v253
    v_lshlrev_b32 v28, 16, v254
    v_lshlrev_b32 v29, 16, v254
    v_lshlrev_b32 v30, 16, v254
    v_lshlrev_b32 v31, 16, v254
    v_and_b32 v32, 0xffff0000, v254
    v_and_b32 v33, 0xffff0000, v254
    v_and_b32 v34, 0xffff0000, v254
    v_and_b32 v35, 0xffff0000, v254
    s_barrier
    ds_read_b128 v[240:243], v4 offset:0
    ds_read_b128 v[244:247], v4 offset:12288
    s_waitcnt vmcnt(16)
    v_perm_b32 v132, v164, v160, s40
    v_perm_b32 v133, v172, v168, s40
    v_perm_b32 v134, v180, v176, s40
    v_perm_b32 v135, v188, v184, s40
    v_accvgpr_write_b32 a0, v132
    v_accvgpr_write_b32 a1, v133
    v_accvgpr_write_b32 a2, v134
    v_accvgpr_write_b32 a3, v135
    v_perm_b32 v132, v164, v160, s41
    v_perm_b32 v133, v172, v168, s41
    v_perm_b32 v134, v180, v176, s41
    v_perm_b32 v135, v188, v184, s41
    v_accvgpr_write_b32 a4, v132
    v_accvgpr_write_b32 a5, v133
    v_accvgpr_write_b32 a6, v134
    v_accvgpr_write_b32 a7, v135
    v_perm_b32 v132, v165, v161, s40
    v_perm_b32 v133, v173, v169, s40
    v_perm_b32 v134, v181, v177, s40
    v_perm_b32 v135, v189, v185, s40
    v_accvgpr_write_b32 a8, v132
    v_accvgpr_write_b32 a9, v133
    v_accvgpr_write_b32 a10, v134
    v_accvgpr_write_b32 a11, v135
    v_perm_b32 v132, v165, v161, s41
    v_perm_b32 v133, v173, v169, s41
    v_perm_b32 v134, v181, v177, s41
    v_perm_b32 v135, v189, v185, s41
    v_accvgpr_write_b32 a12, v132
    v_accvgpr_write_b32 a13, v133
    v_accvgpr_write_b32 a14, v134
    v_accvgpr_write_b32 a15, v135
    v_perm_b32 v132, v166, v162, s40
    v_perm_b32 v133, v174, v170, s40
    v_perm_b32 v134, v182, v178, s40
    v_perm_b32 v135, v190, v186, s40
    v_accvgpr_write_b32 a16, v132
    v_accvgpr_write_b32 a17, v133
    v_accvgpr_write_b32 a18, v134
    v_accvgpr_write_b32 a19, v135
    v_perm_b32 v132, v166, v162, s41
    v_perm_b32 v133, v174, v170, s41
    v_perm_b32 v134, v182, v178, s41
    v_perm_b32 v135, v190, v186, s41
    v_accvgpr_write_b32 a20, v132
    v_accvgpr_write_b32 a21, v133
    v_accvgpr_write_b32 a22, v134
    v_accvgpr_write_b32 a23, v135
    s_mov_b32 s39, 73728
    buffer_load_dwordx3 v[160:162], v10, s[16:19], s39 offen offset:0
    buffer_load_dwordx3 v[164:166], v10, s[16:19], s39 offen offset:768
    buffer_load_dwordx3 v[168:170], v10, s[16:19], s39 offen offset:1536
    buffer_load_dwordx3 v[172:174], v10, s[16:19], s39 offen offset:2304
    buffer_load_dwordx3 v[176:178], v11, s[16:19], s39 offen offset:0
    buffer_load_dwordx3 v[180:182], v11, s[16:19], s39 offen offset:768
    buffer_load_dwordx3 v[184:186], v11, s[16:19], s39 offen offset:1536
    buffer_load_dwordx3 v[188:190], v11, s[16:19], s39 offen offset:2304
    s_waitcnt vmcnt(16)
    s_waitcnt lgkmcnt(1)
    v_mfma_f32_16x16x32_bf16 v[36:39], v[240:243], a[0:3], v[12:15]
    v_perm_b32 v132, v88, v84, s40
    v_perm_b32 v133, v96, v92, s40
    v_perm_b32 v134, v104, v100, s40
    v_perm_b32 v135, v112, v108, s40
    v_mfma_f32_16x16x32_bf16 v[40:43], v[240:243], a[4:7], v[16:19]
    v_accvgpr_write_b32 a24, v132
    v_accvgpr_write_b32 a25, v133
    v_accvgpr_write_b32 a26, v134
    v_accvgpr_write_b32 a27, v135
    v_mfma_f32_16x16x32_bf16 v[44:47], v[240:243], a[8:11], v[20:23]
    v_perm_b32 v132, v88, v84, s41
    v_perm_b32 v133, v96, v92, s41
    v_perm_b32 v134, v104, v100, s41
    v_perm_b32 v135, v112, v108, s41
    v_mfma_f32_16x16x32_bf16 v[48:51], v[240:243], a[12:15], v[24:27]
    v_accvgpr_write_b32 a28, v132
    v_accvgpr_write_b32 a29, v133
    v_accvgpr_write_b32 a30, v134
    v_accvgpr_write_b32 a31, v135
    v_mfma_f32_16x16x32_bf16 v[52:55], v[240:243], a[16:19], v[28:31]
    v_perm_b32 v132, v89, v85, s40
    v_perm_b32 v133, v97, v93, s40
    v_perm_b32 v134, v105, v101, s40
    v_perm_b32 v135, v113, v109, s40
    v_mfma_f32_16x16x32_bf16 v[56:59], v[240:243], a[20:23], v[32:35]
    v_accvgpr_write_b32 a32, v132
    v_accvgpr_write_b32 a33, v133
    v_accvgpr_write_b32 a34, v134
    v_accvgpr_write_b32 a35, v135
    ds_read_b128 v[240:243], v5 offset:0
    s_waitcnt lgkmcnt(1)
    v_mfma_f32_16x16x32_bf16 v[60:63], v[244:247], a[0:3], v[12:15]
    v_perm_b32 v132, v89, v85, s41
    v_perm_b32 v133, v97, v93, s41
    v_perm_b32 v134, v105, v101, s41
    v_perm_b32 v135, v113, v109, s41
    v_mfma_f32_16x16x32_bf16 v[64:67], v[244:247], a[4:7], v[16:19]
    v_accvgpr_write_b32 a36, v132
    v_accvgpr_write_b32 a37, v133
    v_accvgpr_write_b32 a38, v134
    v_accvgpr_write_b32 a39, v135
    v_mfma_f32_16x16x32_bf16 v[68:71], v[244:247], a[8:11], v[20:23]
    v_perm_b32 v132, v90, v86, s40
    v_perm_b32 v133, v98, v94, s40
    v_perm_b32 v134, v106, v102, s40
    v_perm_b32 v135, v114, v110, s40
    v_mfma_f32_16x16x32_bf16 v[72:75], v[244:247], a[12:15], v[24:27]
    v_accvgpr_write_b32 a40, v132
    v_accvgpr_write_b32 a41, v133
    v_accvgpr_write_b32 a42, v134
    v_accvgpr_write_b32 a43, v135
    v_mfma_f32_16x16x32_bf16 v[76:79], v[244:247], a[16:19], v[28:31]
    v_perm_b32 v132, v90, v86, s41
    v_perm_b32 v133, v98, v94, s41
    v_perm_b32 v134, v106, v102, s41
    v_perm_b32 v135, v114, v110, s41
    v_mfma_f32_16x16x32_bf16 v[80:83], v[244:247], a[20:23], v[32:35]
    v_accvgpr_write_b32 a44, v132
    v_accvgpr_write_b32 a45, v133
    v_accvgpr_write_b32 a46, v134
    v_accvgpr_write_b32 a47, v135
    ds_read_b128 v[244:247], v5 offset:12288
    s_mov_b32 s39, 98304
    buffer_load_dwordx3 v[84:86], v10, s[16:19], s39 offen offset:0
    buffer_load_dwordx3 v[88:90], v10, s[16:19], s39 offen offset:768
    buffer_load_dwordx3 v[92:94], v10, s[16:19], s39 offen offset:1536
    buffer_load_dwordx3 v[96:98], v10, s[16:19], s39 offen offset:2304
    buffer_load_dwordx3 v[100:102], v11, s[16:19], s39 offen offset:0
    buffer_load_dwordx3 v[104:106], v11, s[16:19], s39 offen offset:768
    buffer_load_dwordx3 v[108:110], v11, s[16:19], s39 offen offset:1536
    buffer_load_dwordx3 v[112:114], v11, s[16:19], s39 offen offset:2304
    s_waitcnt vmcnt(16)
    s_waitcnt lgkmcnt(1)
    v_mfma_f32_16x16x32_bf16 v[36:39], v[240:243], a[24:27], v[36:39]
    v_perm_b32 v132, v120, v116, s40
    v_perm_b32 v133, v128, v124, s40
    v_perm_b32 v134, v140, v136, s40
    v_perm_b32 v135, v156, v144, s40
    v_mfma_f32_16x16x32_bf16 v[40:43], v[240:243], a[28:31], v[40:43]
    v_accvgpr_write_b32 a48, v132
    v_accvgpr_write_b32 a49, v133
    v_accvgpr_write_b32 a50, v134
    v_accvgpr_write_b32 a51, v135
    v_mfma_f32_16x16x32_bf16 v[44:47], v[240:243], a[32:35], v[44:47]
    v_perm_b32 v132, v120, v116, s41
    v_perm_b32 v133, v128, v124, s41
    v_perm_b32 v134, v140, v136, s41
    v_perm_b32 v135, v156, v144, s41
    v_mfma_f32_16x16x32_bf16 v[48:51], v[240:243], a[36:39], v[48:51]
    v_accvgpr_write_b32 a52, v132
    v_accvgpr_write_b32 a53, v133
    v_accvgpr_write_b32 a54, v134
    v_accvgpr_write_b32 a55, v135
    v_mfma_f32_16x16x32_bf16 v[52:55], v[240:243], a[40:43], v[52:55]
    v_perm_b32 v132, v121, v117, s40
    v_perm_b32 v133, v129, v125, s40
    v_perm_b32 v134, v141, v137, s40
    v_perm_b32 v135, v157, v145, s40
    v_mfma_f32_16x16x32_bf16 v[56:59], v[240:243], a[44:47], v[56:59]
    v_accvgpr_write_b32 a56, v132
    v_accvgpr_write_b32 a57, v133
    v_accvgpr_write_b32 a58, v134
    v_accvgpr_write_b32 a59, v135
    ds_read_b128 v[240:243], v6 offset:0
    s_waitcnt lgkmcnt(1)
    v_mfma_f32_16x16x32_bf16 v[60:63], v[244:247], a[24:27], v[60:63]
    v_perm_b32 v132, v121, v117, s41
    v_perm_b32 v133, v129, v125, s41
    v_perm_b32 v134, v141, v137, s41
    v_perm_b32 v135, v157, v145, s41
    v_mfma_f32_16x16x32_bf16 v[64:67], v[244:247], a[28:31], v[64:67]
    v_accvgpr_write_b32 a60, v132
    v_accvgpr_write_b32 a61, v133
    v_accvgpr_write_b32 a62, v134
    v_accvgpr_write_b32 a63, v135
    v_mfma_f32_16x16x32_bf16 v[68:71], v[244:247], a[32:35], v[68:71]
    v_perm_b32 v132, v122, v118, s40
    v_perm_b32 v133, v130, v126, s40
    v_perm_b32 v134, v142, v138, s40
    v_perm_b32 v135, v158, v146, s40
    v_mfma_f32_16x16x32_bf16 v[72:75], v[244:247], a[36:39], v[72:75]
    v_accvgpr_write_b32 a64, v132
    v_accvgpr_write_b32 a65, v133
    v_accvgpr_write_b32 a66, v134
    v_accvgpr_write_b32 a67, v135
    v_mfma_f32_16x16x32_bf16 v[76:79], v[244:247], a[40:43], v[76:79]
    v_perm_b32 v132, v122, v118, s41
    v_perm_b32 v133, v130, v126, s41
    v_perm_b32 v134, v142, v138, s41
    v_perm_b32 v135, v158, v146, s41
    v_mfma_f32_16x16x32_bf16 v[80:83], v[244:247], a[44:47], v[80:83]
    v_accvgpr_write_b32 a68, v132
    v_accvgpr_write_b32 a69, v133
    v_accvgpr_write_b32 a70, v134
    v_accvgpr_write_b32 a71, v135
    ds_read_b128 v[244:247], v6 offset:12288
    s_mov_b32 s39, 122880
    buffer_load_dwordx3 v[116:118], v10, s[16:19], s39 offen offset:0
    buffer_load_dwordx3 v[120:122], v10, s[16:19], s39 offen offset:768
    buffer_load_dwordx3 v[124:126], v10, s[16:19], s39 offen offset:1536
    buffer_load_dwordx3 v[128:130], v10, s[16:19], s39 offen offset:2304
    buffer_load_dwordx3 v[136:138], v11, s[16:19], s39 offen offset:0
    buffer_load_dwordx3 v[140:142], v11, s[16:19], s39 offen offset:768
    buffer_load_dwordx3 v[144:146], v11, s[16:19], s39 offen offset:1536
    buffer_load_dwordx3 v[156:158], v11, s[16:19], s39 offen offset:2304
    s_waitcnt vmcnt(16)
    s_waitcnt lgkmcnt(1)
    v_mfma_f32_16x16x32_bf16 v[36:39], v[240:243], a[48:51], v[36:39]
    v_perm_b32 v132, v164, v160, s40
    v_perm_b32 v133, v172, v168, s40
    v_perm_b32 v134, v180, v176, s40
    v_perm_b32 v135, v188, v184, s40
    v_mfma_f32_16x16x32_bf16 v[40:43], v[240:243], a[52:55], v[40:43]
    v_accvgpr_write_b32 a72, v132
    v_accvgpr_write_b32 a73, v133
    v_accvgpr_write_b32 a74, v134
    v_accvgpr_write_b32 a75, v135
    v_mfma_f32_16x16x32_bf16 v[44:47], v[240:243], a[56:59], v[44:47]
    v_perm_b32 v132, v164, v160, s41
    v_perm_b32 v133, v172, v168, s41
    v_perm_b32 v134, v180, v176, s41
    v_perm_b32 v135, v188, v184, s41
    v_mfma_f32_16x16x32_bf16 v[48:51], v[240:243], a[60:63], v[48:51]
    v_accvgpr_write_b32 a76, v132
    v_accvgpr_write_b32 a77, v133
    v_accvgpr_write_b32 a78, v134
    v_accvgpr_write_b32 a79, v135
    v_mfma_f32_16x16x32_bf16 v[52:55], v[240:243], a[64:67], v[52:55]
    v_perm_b32 v132, v165, v161, s40
    v_perm_b32 v133, v173, v169, s40
    v_perm_b32 v134, v181, v177, s40
    v_perm_b32 v135, v189, v185, s40
    v_mfma_f32_16x16x32_bf16 v[56:59], v[240:243], a[68:71], v[56:59]
    v_accvgpr_write_b32 a80, v132
    v_accvgpr_write_b32 a81, v133
    v_accvgpr_write_b32 a82, v134
    v_accvgpr_write_b32 a83, v135
    ds_read_b128 v[240:243], v7 offset:0
    s_waitcnt lgkmcnt(1)
    v_mfma_f32_16x16x32_bf16 v[60:63], v[244:247], a[48:51], v[60:63]
    v_perm_b32 v132, v165, v161, s41
    v_perm_b32 v133, v173, v169, s41
    v_perm_b32 v134, v181, v177, s41
    v_perm_b32 v135, v189, v185, s41
    v_mfma_f32_16x16x32_bf16 v[64:67], v[244:247], a[52:55], v[64:67]
    v_accvgpr_write_b32 a84, v132
    v_accvgpr_write_b32 a85, v133
    v_accvgpr_write_b32 a86, v134
    v_accvgpr_write_b32 a87, v135
    v_mfma_f32_16x16x32_bf16 v[68:71], v[244:247], a[56:59], v[68:71]
    v_perm_b32 v132, v166, v162, s40
    v_perm_b32 v133, v174, v170, s40
    v_perm_b32 v134, v182, v178, s40
    v_perm_b32 v135, v190, v186, s40
    v_mfma_f32_16x16x32_bf16 v[72:75], v[244:247], a[60:63], v[72:75]
    v_accvgpr_write_b32 a88, v132
    v_accvgpr_write_b32 a89, v133
    v_accvgpr_write_b32 a90, v134
    v_accvgpr_write_b32 a91, v135
    v_mfma_f32_16x16x32_bf16 v[76:79], v[244:247], a[64:67], v[76:79]
    v_perm_b32 v132, v166, v162, s41
    v_perm_b32 v133, v174, v170, s41
    v_perm_b32 v134, v182, v178, s41
    v_perm_b32 v135, v190, v186, s41
    v_mfma_f32_16x16x32_bf16 v[80:83], v[244:247], a[68:71], v[80:83]
    v_accvgpr_write_b32 a92, v132
    v_accvgpr_write_b32 a93, v133
    v_accvgpr_write_b32 a94, v134
    v_accvgpr_write_b32 a95, v135
    ds_read_b128 v[244:247], v7 offset:12288
    s_mov_b32 s39, 147456
    buffer_load_dwordx3 v[160:162], v10, s[16:19], s39 offen offset:0
    buffer_load_dwordx3 v[164:166], v10, s[16:19], s39 offen offset:768
    buffer_load_dwordx3 v[168:170], v10, s[16:19], s39 offen offset:1536
    buffer_load_dwordx3 v[172:174], v10, s[16:19], s39 offen offset:2304
    buffer_load_dwordx3 v[176:178], v11, s[16:19], s39 offen offset:0
    buffer_load_dwordx3 v[180:182], v11, s[16:19], s39 offen offset:768
    buffer_load_dwordx3 v[184:186], v11, s[16:19], s39 offen offset:1536
    buffer_load_dwordx3 v[188:190], v11, s[16:19], s39 offen offset:2304
    s_waitcnt vmcnt(16)
    s_waitcnt lgkmcnt(1)
    v_mfma_f32_16x16x32_bf16 v[36:39], v[240:243], a[72:75], v[36:39]
    v_perm_b32 v132, v88, v84, s40
    v_perm_b32 v133, v96, v92, s40
    v_perm_b32 v134, v104, v100, s40
    v_perm_b32 v135, v112, v108, s40
    v_mfma_f32_16x16x32_bf16 v[40:43], v[240:243], a[76:79], v[40:43]
    v_accvgpr_write_b32 a96, v132
    v_accvgpr_write_b32 a97, v133
    v_accvgpr_write_b32 a98, v134
    v_accvgpr_write_b32 a99, v135
    v_mfma_f32_16x16x32_bf16 v[44:47], v[240:243], a[80:83], v[44:47]
    v_perm_b32 v132, v88, v84, s41
    v_perm_b32 v133, v96, v92, s41
    v_perm_b32 v134, v104, v100, s41
    v_perm_b32 v135, v112, v108, s41
    v_mfma_f32_16x16x32_bf16 v[48:51], v[240:243], a[84:87], v[48:51]
    v_accvgpr_write_b32 a100, v132
    v_accvgpr_write_b32 a101, v133
    v_accvgpr_write_b32 a102, v134
    v_accvgpr_write_b32 a103, v135
    v_mfma_f32_16x16x32_bf16 v[52:55], v[240:243], a[88:91], v[52:55]
    v_perm_b32 v132, v89, v85, s40
    v_perm_b32 v133, v97, v93, s40
    v_perm_b32 v134, v105, v101, s40
    v_perm_b32 v135, v113, v109, s40
    v_mfma_f32_16x16x32_bf16 v[56:59], v[240:243], a[92:95], v[56:59]
    v_accvgpr_write_b32 a104, v132
    v_accvgpr_write_b32 a105, v133
    v_accvgpr_write_b32 a106, v134
    v_accvgpr_write_b32 a107, v135
    ds_read_b128 v[240:243], v4 offset:256
    s_waitcnt lgkmcnt(1)
    v_mfma_f32_16x16x32_bf16 v[60:63], v[244:247], a[72:75], v[60:63]
    v_perm_b32 v132, v89, v85, s41
    v_perm_b32 v133, v97, v93, s41
    v_perm_b32 v134, v105, v101, s41
    v_perm_b32 v135, v113, v109, s41
    v_mfma_f32_16x16x32_bf16 v[64:67], v[244:247], a[76:79], v[64:67]
    v_accvgpr_write_b32 a108, v132
    v_accvgpr_write_b32 a109, v133
    v_accvgpr_write_b32 a110, v134
    v_accvgpr_write_b32 a111, v135
    v_mfma_f32_16x16x32_bf16 v[68:71], v[244:247], a[80:83], v[68:71]
    v_perm_b32 v132, v90, v86, s40
    v_perm_b32 v133, v98, v94, s40
    v_perm_b32 v134, v106, v102, s40
    v_perm_b32 v135, v114, v110, s40
    v_mfma_f32_16x16x32_bf16 v[72:75], v[244:247], a[84:87], v[72:75]
    v_accvgpr_write_b32 a112, v132
    v_accvgpr_write_b32 a113, v133
    v_accvgpr_write_b32 a114, v134
    v_accvgpr_write_b32 a115, v135
    v_mfma_f32_16x16x32_bf16 v[76:79], v[244:247], a[88:91], v[76:79]
    v_perm_b32 v132, v90, v86, s41
    v_perm_b32 v133, v98, v94, s41
    v_perm_b32 v134, v106, v102, s41
    v_perm_b32 v135, v114, v110, s41
    v_mfma_f32_16x16x32_bf16 v[80:83], v[244:247], a[92:95], v[80:83]
    v_accvgpr_write_b32 a116, v132
    v_accvgpr_write_b32 a117, v133
    v_accvgpr_write_b32 a118, v134
    v_accvgpr_write_b32 a119, v135
    ds_read_b128 v[244:247], v4 offset:12544
    s_mov_b32 s39, 172032
    buffer_load_dwordx3 v[84:86], v10, s[16:19], s39 offen offset:0
    buffer_load_dwordx3 v[88:90], v10, s[16:19], s39 offen offset:768
    buffer_load_dwordx3 v[92:94], v10, s[16:19], s39 offen offset:1536
    buffer_load_dwordx3 v[96:98], v10, s[16:19], s39 offen offset:2304
    buffer_load_dwordx3 v[100:102], v11, s[16:19], s39 offen offset:0
    buffer_load_dwordx3 v[104:106], v11, s[16:19], s39 offen offset:768
    buffer_load_dwordx3 v[108:110], v11, s[16:19], s39 offen offset:1536
    buffer_load_dwordx3 v[112:114], v11, s[16:19], s39 offen offset:2304
    s_waitcnt vmcnt(16)
    s_waitcnt lgkmcnt(1)
    v_mfma_f32_16x16x32_bf16 v[36:39], v[240:243], a[96:99], v[36:39]
    v_perm_b32 v132, v120, v116, s40
    v_perm_b32 v133, v128, v124, s40
    v_perm_b32 v134, v140, v136, s40
    v_perm_b32 v135, v156, v144, s40
    v_mfma_f32_16x16x32_bf16 v[40:43], v[240:243], a[100:103], v[40:43]
    v_accvgpr_write_b32 a120, v132
    v_accvgpr_write_b32 a121, v133
    v_accvgpr_write_b32 a122, v134
    v_accvgpr_write_b32 a123, v135
    v_mfma_f32_16x16x32_bf16 v[44:47], v[240:243], a[104:107], v[44:47]
    v_perm_b32 v132, v120, v116, s41
    v_perm_b32 v133, v128, v124, s41
    v_perm_b32 v134, v140, v136, s41
    v_perm_b32 v135, v156, v144, s41
    v_mfma_f32_16x16x32_bf16 v[48:51], v[240:243], a[108:111], v[48:51]
    v_accvgpr_write_b32 a124, v132
    v_accvgpr_write_b32 a125, v133
    v_accvgpr_write_b32 a126, v134
    v_accvgpr_write_b32 a127, v135
    v_mfma_f32_16x16x32_bf16 v[52:55], v[240:243], a[112:115], v[52:55]
    v_perm_b32 v132, v121, v117, s40
    v_perm_b32 v133, v129, v125, s40
    v_perm_b32 v134, v141, v137, s40
    v_perm_b32 v135, v157, v145, s40
    v_mfma_f32_16x16x32_bf16 v[56:59], v[240:243], a[116:119], v[56:59]
    v_accvgpr_write_b32 a128, v132
    v_accvgpr_write_b32 a129, v133
    v_accvgpr_write_b32 a130, v134
    v_accvgpr_write_b32 a131, v135
    ds_read_b128 v[240:243], v5 offset:256
    s_waitcnt lgkmcnt(1)
    v_mfma_f32_16x16x32_bf16 v[60:63], v[244:247], a[96:99], v[60:63]
    v_perm_b32 v132, v121, v117, s41
    v_perm_b32 v133, v129, v125, s41
    v_perm_b32 v134, v141, v137, s41
    v_perm_b32 v135, v157, v145, s41
    v_mfma_f32_16x16x32_bf16 v[64:67], v[244:247], a[100:103], v[64:67]
    v_accvgpr_write_b32 a132, v132
    v_accvgpr_write_b32 a133, v133
    v_accvgpr_write_b32 a134, v134
    v_accvgpr_write_b32 a135, v135
    v_mfma_f32_16x16x32_bf16 v[68:71], v[244:247], a[104:107], v[68:71]
    v_perm_b32 v132, v122, v118, s40
    v_perm_b32 v133, v130, v126, s40
    v_perm_b32 v134, v142, v138, s40
    v_perm_b32 v135, v158, v146, s40
    v_mfma_f32_16x16x32_bf16 v[72:75], v[244:247], a[108:111], v[72:75]
    v_accvgpr_write_b32 a136, v132
    v_accvgpr_write_b32 a137, v133
    v_accvgpr_write_b32 a138, v134
    v_accvgpr_write_b32 a139, v135
    v_mfma_f32_16x16x32_bf16 v[76:79], v[244:247], a[112:115], v[76:79]
    v_perm_b32 v132, v122, v118, s41
    v_perm_b32 v133, v130, v126, s41
    v_perm_b32 v134, v142, v138, s41
    v_perm_b32 v135, v158, v146, s41
    v_mfma_f32_16x16x32_bf16 v[80:83], v[244:247], a[116:119], v[80:83]
    v_accvgpr_write_b32 a140, v132
    v_accvgpr_write_b32 a141, v133
    v_accvgpr_write_b32 a142, v134
    v_accvgpr_write_b32 a143, v135
    ds_read_b128 v[244:247], v5 offset:12544
    s_mov_b32 s39, 196608
    buffer_load_dwordx3 v[116:118], v10, s[16:19], s39 offen offset:0
    buffer_load_dwordx3 v[120:122], v10, s[16:19], s39 offen offset:768
    buffer_load_dwordx3 v[124:126], v10, s[16:19], s39 offen offset:1536
    buffer_load_dwordx3 v[128:130], v10, s[16:19], s39 offen offset:2304
    buffer_load_dwordx3 v[136:138], v11, s[16:19], s39 offen offset:0
    buffer_load_dwordx3 v[140:142], v11, s[16:19], s39 offen offset:768
    buffer_load_dwordx3 v[144:146], v11, s[16:19], s39 offen offset:1536
    buffer_load_dwordx3 v[156:158], v11, s[16:19], s39 offen offset:2304
    s_waitcnt vmcnt(16)
    s_waitcnt lgkmcnt(1)
    v_mfma_f32_16x16x32_bf16 v[36:39], v[240:243], a[120:123], v[36:39]
    v_perm_b32 v132, v164, v160, s40
    v_perm_b32 v133, v172, v168, s40
    v_perm_b32 v134, v180, v176, s40
    v_perm_b32 v135, v188, v184, s40
    v_mfma_f32_16x16x32_bf16 v[40:43], v[240:243], a[124:127], v[40:43]
    v_accvgpr_write_b32 a144, v132
    v_accvgpr_write_b32 a145, v133
    v_accvgpr_write_b32 a146, v134
    v_accvgpr_write_b32 a147, v135
    v_mfma_f32_16x16x32_bf16 v[44:47], v[240:243], a[128:131], v[44:47]
    v_perm_b32 v132, v164, v160, s41
    v_perm_b32 v133, v172, v168, s41
    v_perm_b32 v134, v180, v176, s41
    v_perm_b32 v135, v188, v184, s41
    v_mfma_f32_16x16x32_bf16 v[48:51], v[240:243], a[132:135], v[48:51]
    v_accvgpr_write_b32 a148, v132
    v_accvgpr_write_b32 a149, v133
    v_accvgpr_write_b32 a150, v134
    v_accvgpr_write_b32 a151, v135
    v_mfma_f32_16x16x32_bf16 v[52:55], v[240:243], a[136:139], v[52:55]
    v_perm_b32 v132, v165, v161, s40
    v_perm_b32 v133, v173, v169, s40
    v_perm_b32 v134, v181, v177, s40
    v_perm_b32 v135, v189, v185, s40
    v_mfma_f32_16x16x32_bf16 v[56:59], v[240:243], a[140:143], v[56:59]
    v_accvgpr_write_b32 a152, v132
    v_accvgpr_write_b32 a153, v133
    v_accvgpr_write_b32 a154, v134
    v_accvgpr_write_b32 a155, v135
    ds_read_b128 v[240:243], v6 offset:256
    s_waitcnt lgkmcnt(1)
    v_mfma_f32_16x16x32_bf16 v[60:63], v[244:247], a[120:123], v[60:63]
    v_perm_b32 v132, v165, v161, s41
    v_perm_b32 v133, v173, v169, s41
    v_perm_b32 v134, v181, v177, s41
    v_perm_b32 v135, v189, v185, s41
    v_mfma_f32_16x16x32_bf16 v[64:67], v[244:247], a[124:127], v[64:67]
    v_accvgpr_write_b32 a156, v132
    v_accvgpr_write_b32 a157, v133
    v_accvgpr_write_b32 a158, v134
    v_accvgpr_write_b32 a159, v135
    v_mfma_f32_16x16x32_bf16 v[68:71], v[244:247], a[128:131], v[68:71]
    v_perm_b32 v132, v166, v162, s40
    v_perm_b32 v133, v174, v170, s40
    v_perm_b32 v134, v182, v178, s40
    v_perm_b32 v135, v190, v186, s40
    v_mfma_f32_16x16x32_bf16 v[72:75], v[244:247], a[132:135], v[72:75]
    v_accvgpr_write_b32 a160, v132
    v_accvgpr_write_b32 a161, v133
    v_accvgpr_write_b32 a162, v134
    v_accvgpr_write_b32 a163, v135
    v_mfma_f32_16x16x32_bf16 v[76:79], v[244:247], a[136:139], v[76:79]
    v_perm_b32 v132, v166, v162, s41
    v_perm_b32 v133, v174, v170, s41
    v_perm_b32 v134, v182, v178, s41
    v_perm_b32 v135, v190, v186, s41
    v_mfma_f32_16x16x32_bf16 v[80:83], v[244:247], a[140:143], v[80:83]
    v_accvgpr_write_b32 a164, v132
    v_accvgpr_write_b32 a165, v133
    v_accvgpr_write_b32 a166, v134
    v_accvgpr_write_b32 a167, v135
    ds_read_b128 v[244:247], v6 offset:12544
    s_mov_b32 s39, 221184
    buffer_load_dwordx3 v[160:162], v10, s[16:19], s39 offen offset:0
    buffer_load_dwordx3 v[164:166], v10, s[16:19], s39 offen offset:768
    buffer_load_dwordx3 v[168:170], v10, s[16:19], s39 offen offset:1536
    buffer_load_dwordx3 v[172:174], v10, s[16:19], s39 offen offset:2304
    buffer_load_dwordx3 v[176:178], v11, s[16:19], s39 offen offset:0
    buffer_load_dwordx3 v[180:182], v11, s[16:19], s39 offen offset:768
    buffer_load_dwordx3 v[184:186], v11, s[16:19], s39 offen offset:1536
    buffer_load_dwordx3 v[188:190], v11, s[16:19], s39 offen offset:2304
    s_waitcnt vmcnt(16)
    s_waitcnt lgkmcnt(1)
    v_mfma_f32_16x16x32_bf16 v[36:39], v[240:243], a[144:147], v[36:39]
    v_perm_b32 v132, v88, v84, s40
    v_perm_b32 v133, v96, v92, s40
    v_perm_b32 v134, v104, v100, s40
    v_perm_b32 v135, v112, v108, s40
    v_mfma_f32_16x16x32_bf16 v[40:43], v[240:243], a[148:151], v[40:43]
    v_accvgpr_write_b32 a168, v132
    v_accvgpr_write_b32 a169, v133
    v_accvgpr_write_b32 a170, v134
    v_accvgpr_write_b32 a171, v135
    v_mfma_f32_16x16x32_bf16 v[44:47], v[240:243], a[152:155], v[44:47]
    v_perm_b32 v132, v88, v84, s41
    v_perm_b32 v133, v96, v92, s41
    v_perm_b32 v134, v104, v100, s41
    v_perm_b32 v135, v112, v108, s41
    v_mfma_f32_16x16x32_bf16 v[48:51], v[240:243], a[156:159], v[48:51]
    v_accvgpr_write_b32 a172, v132
    v_accvgpr_write_b32 a173, v133
    v_accvgpr_write_b32 a174, v134
    v_accvgpr_write_b32 a175, v135
    v_mfma_f32_16x16x32_bf16 v[52:55], v[240:243], a[160:163], v[52:55]
    v_perm_b32 v132, v89, v85, s40
    v_perm_b32 v133, v97, v93, s40
    v_perm_b32 v134, v105, v101, s40
    v_perm_b32 v135, v113, v109, s40
    v_mfma_f32_16x16x32_bf16 v[56:59], v[240:243], a[164:167], v[56:59]
    v_accvgpr_write_b32 a176, v132
    v_accvgpr_write_b32 a177, v133
    v_accvgpr_write_b32 a178, v134
    v_accvgpr_write_b32 a179, v135
    ds_read_b128 v[240:243], v7 offset:256
    s_waitcnt lgkmcnt(1)
    v_mfma_f32_16x16x32_bf16 v[60:63], v[244:247], a[144:147], v[60:63]
    v_perm_b32 v132, v89, v85, s41
    v_perm_b32 v133, v97, v93, s41
    v_perm_b32 v134, v105, v101, s41
    v_perm_b32 v135, v113, v109, s41
    v_mfma_f32_16x16x32_bf16 v[64:67], v[244:247], a[148:151], v[64:67]
    v_accvgpr_write_b32 a180, v132
    v_accvgpr_write_b32 a181, v133
    v_accvgpr_write_b32 a182, v134
    v_accvgpr_write_b32 a183, v135
    v_mfma_f32_16x16x32_bf16 v[68:71], v[244:247], a[152:155], v[68:71]
    v_perm_b32 v132, v90, v86, s40
    v_perm_b32 v133, v98, v94, s40
    v_perm_b32 v134, v106, v102, s40
    v_perm_b32 v135, v114, v110, s40
    v_mfma_f32_16x16x32_bf16 v[72:75], v[244:247], a[156:159], v[72:75]
    v_accvgpr_write_b32 a184, v132
    v_accvgpr_write_b32 a185, v133
    v_accvgpr_write_b32 a186, v134
    v_accvgpr_write_b32 a187, v135
    v_mfma_f32_16x16x32_bf16 v[76:79], v[244:247], a[160:163], v[76:79]
    v_perm_b32 v132, v90, v86, s41
    v_perm_b32 v133, v98, v94, s41
    v_perm_b32 v134, v106, v102, s41
    v_perm_b32 v135, v114, v110, s41
    v_mfma_f32_16x16x32_bf16 v[80:83], v[244:247], a[164:167], v[80:83]
    v_accvgpr_write_b32 a188, v132
    v_accvgpr_write_b32 a189, v133
    v_accvgpr_write_b32 a190, v134
    v_accvgpr_write_b32 a191, v135
    ds_read_b128 v[244:247], v7 offset:12544
    s_mov_b32 s39, 245760
    buffer_load_dwordx3 v[84:86], v10, s[16:19], s39 offen offset:0
    buffer_load_dwordx3 v[88:90], v10, s[16:19], s39 offen offset:768
    buffer_load_dwordx3 v[92:94], v10, s[16:19], s39 offen offset:1536
    buffer_load_dwordx3 v[96:98], v10, s[16:19], s39 offen offset:2304
    buffer_load_dwordx3 v[100:102], v11, s[16:19], s39 offen offset:0
    buffer_load_dwordx3 v[104:106], v11, s[16:19], s39 offen offset:768
    buffer_load_dwordx3 v[108:110], v11, s[16:19], s39 offen offset:1536
    buffer_load_dwordx3 v[112:114], v11, s[16:19], s39 offen offset:2304
    s_waitcnt vmcnt(16)
    s_waitcnt lgkmcnt(1)
    v_mfma_f32_16x16x32_bf16 v[36:39], v[240:243], a[168:171], v[36:39]
    v_perm_b32 v132, v120, v116, s40
    v_perm_b32 v133, v128, v124, s40
    v_perm_b32 v134, v140, v136, s40
    v_perm_b32 v135, v156, v144, s40
    v_mfma_f32_16x16x32_bf16 v[40:43], v[240:243], a[172:175], v[40:43]
    v_accvgpr_write_b32 a192, v132
    v_accvgpr_write_b32 a193, v133
    v_accvgpr_write_b32 a194, v134
    v_accvgpr_write_b32 a195, v135
    v_mfma_f32_16x16x32_bf16 v[44:47], v[240:243], a[176:179], v[44:47]
    v_perm_b32 v132, v120, v116, s41
    v_perm_b32 v133, v128, v124, s41
    v_perm_b32 v134, v140, v136, s41
    v_perm_b32 v135, v156, v144, s41
    v_mfma_f32_16x16x32_bf16 v[48:51], v[240:243], a[180:183], v[48:51]
    v_accvgpr_write_b32 a196, v132
    v_accvgpr_write_b32 a197, v133
    v_accvgpr_write_b32 a198, v134
    v_accvgpr_write_b32 a199, v135
    v_mfma_f32_16x16x32_bf16 v[52:55], v[240:243], a[184:187], v[52:55]
    v_perm_b32 v132, v121, v117, s40
    v_perm_b32 v133, v129, v125, s40
    v_perm_b32 v134, v141, v137, s40
    v_perm_b32 v135, v157, v145, s40
    v_mfma_f32_16x16x32_bf16 v[56:59], v[240:243], a[188:191], v[56:59]
    v_accvgpr_write_b32 a200, v132
    v_accvgpr_write_b32 a201, v133
    v_accvgpr_write_b32 a202, v134
    v_accvgpr_write_b32 a203, v135
    ds_read_b128 v[240:243], v4 offset:512
    s_waitcnt lgkmcnt(1)
    v_mfma_f32_16x16x32_bf16 v[60:63], v[244:247], a[168:171], v[60:63]
    v_perm_b32 v132, v121, v117, s41
    v_perm_b32 v133, v129, v125, s41
    v_perm_b32 v134, v141, v137, s41
    v_perm_b32 v135, v157, v145, s41
    v_mfma_f32_16x16x32_bf16 v[64:67], v[244:247], a[172:175], v[64:67]
    v_accvgpr_write_b32 a204, v132
    v_accvgpr_write_b32 a205, v133
    v_accvgpr_write_b32 a206, v134
    v_accvgpr_write_b32 a207, v135
    v_mfma_f32_16x16x32_bf16 v[68:71], v[244:247], a[176:179], v[68:71]
    v_perm_b32 v132, v122, v118, s40
    v_perm_b32 v133, v130, v126, s40
    v_perm_b32 v134, v142, v138, s40
    v_perm_b32 v135, v158, v146, s40
    v_mfma_f32_16x16x32_bf16 v[72:75], v[244:247], a[180:183], v[72:75]
    v_accvgpr_write_b32 a208, v132
    v_accvgpr_write_b32 a209, v133
    v_accvgpr_write_b32 a210, v134
    v_accvgpr_write_b32 a211, v135
    v_mfma_f32_16x16x32_bf16 v[76:79], v[244:247], a[184:187], v[76:79]
    v_perm_b32 v132, v122, v118, s41
    v_perm_b32 v133, v130, v126, s41
    v_perm_b32 v134, v142, v138, s41
    v_perm_b32 v135, v158, v146, s41
    v_mfma_f32_16x16x32_bf16 v[80:83], v[244:247], a[188:191], v[80:83]
    v_accvgpr_write_b32 a212, v132
    v_accvgpr_write_b32 a213, v133
    v_accvgpr_write_b32 a214, v134
    v_accvgpr_write_b32 a215, v135
    ds_read_b128 v[244:247], v4 offset:12800
    s_mov_b32 s39, 270336
    buffer_load_dwordx3 v[116:118], v10, s[16:19], s39 offen offset:0
    buffer_load_dwordx3 v[120:122], v10, s[16:19], s39 offen offset:768
    buffer_load_dwordx3 v[124:126], v10, s[16:19], s39 offen offset:1536
    buffer_load_dwordx3 v[128:130], v10, s[16:19], s39 offen offset:2304
    buffer_load_dwordx3 v[136:138], v11, s[16:19], s39 offen offset:0
    buffer_load_dwordx3 v[140:142], v11, s[16:19], s39 offen offset:768
    buffer_load_dwordx3 v[144:146], v11, s[16:19], s39 offen offset:1536
    buffer_load_dwordx3 v[156:158], v11, s[16:19], s39 offen offset:2304
    s_waitcnt vmcnt(16)
    s_waitcnt lgkmcnt(1)
    v_mfma_f32_16x16x32_bf16 v[36:39], v[240:243], a[192:195], v[36:39]
    v_perm_b32 v132, v164, v160, s40
    v_perm_b32 v133, v172, v168, s40
    v_perm_b32 v134, v180, v176, s40
    v_perm_b32 v135, v188, v184, s40
    v_mfma_f32_16x16x32_bf16 v[40:43], v[240:243], a[196:199], v[40:43]
    v_accvgpr_write_b32 a216, v132
    v_accvgpr_write_b32 a217, v133
    v_accvgpr_write_b32 a218, v134
    v_accvgpr_write_b32 a219, v135
    s_add_u32 m0, s42, 24576
    s_nop 0
    v_mfma_f32_16x16x32_bf16 v[44:47], v[240:243], a[200:203], v[44:47]
    v_perm_b32 v132, v164, v160, s41
    v_perm_b32 v133, v172, v168, s41
    v_perm_b32 v134, v180, v176, s41
    v_perm_b32 v135, v188, v184, s41
    v_mfma_f32_16x16x32_bf16 v[48:51], v[240:243], a[204:207], v[48:51]
    v_accvgpr_write_b32 a220, v132
    v_accvgpr_write_b32 a221, v133
    v_accvgpr_write_b32 a222, v134
    v_accvgpr_write_b32 a223, v135
    v_mfma_f32_16x16x32_bf16 v[52:55], v[240:243], a[208:211], v[52:55]
    v_perm_b32 v132, v165, v161, s40
    v_perm_b32 v133, v173, v169, s40
    v_perm_b32 v134, v181, v177, s40
    v_perm_b32 v135, v189, v185, s40
    v_mfma_f32_16x16x32_bf16 v[56:59], v[240:243], a[212:215], v[56:59]
    v_accvgpr_write_b32 a224, v132
    v_accvgpr_write_b32 a225, v133
    v_accvgpr_write_b32 a226, v134
    v_accvgpr_write_b32 a227, v135
    buffer_load_dwordx4 v1, s[12:15], s34 offen offset:0 nt lds
    ds_read_b128 v[240:243], v5 offset:512
    s_waitcnt lgkmcnt(1)
    v_mfma_f32_16x16x32_bf16 v[60:63], v[244:247], a[192:195], v[60:63]
    v_perm_b32 v132, v165, v161, s41
    v_perm_b32 v133, v173, v169, s41
    v_perm_b32 v134, v181, v177, s41
    v_perm_b32 v135, v189, v185, s41
    v_mfma_f32_16x16x32_bf16 v[64:67], v[244:247], a[196:199], v[64:67]
    v_accvgpr_write_b32 a228, v132
    v_accvgpr_write_b32 a229, v133
    v_accvgpr_write_b32 a230, v134
    v_accvgpr_write_b32 a231, v135
    v_mfma_f32_16x16x32_bf16 v[68:71], v[244:247], a[200:203], v[68:71]
    v_perm_b32 v132, v166, v162, s40
    v_perm_b32 v133, v174, v170, s40
    v_perm_b32 v134, v182, v178, s40
    v_perm_b32 v135, v190, v186, s40
    v_mfma_f32_16x16x32_bf16 v[72:75], v[244:247], a[204:207], v[72:75]
    v_accvgpr_write_b32 a232, v132
    v_accvgpr_write_b32 a233, v133
    v_accvgpr_write_b32 a234, v134
    v_accvgpr_write_b32 a235, v135
    buffer_load_dwordx4 v2, s[12:15], s34 offen offset:1024 nt lds
    v_mfma_f32_16x16x32_bf16 v[76:79], v[244:247], a[208:211], v[76:79]
    v_perm_b32 v132, v166, v162, s41
    v_perm_b32 v133, v174, v170, s41
    v_perm_b32 v134, v182, v178, s41
    v_perm_b32 v135, v190, v186, s41
    v_mfma_f32_16x16x32_bf16 v[80:83], v[244:247], a[212:215], v[80:83]
    v_accvgpr_write_b32 a236, v132
    v_accvgpr_write_b32 a237, v133
    v_accvgpr_write_b32 a238, v134
    v_accvgpr_write_b32 a239, v135
    ds_read_b128 v[244:247], v5 offset:12800
    buffer_load_dwordx4 v3, s[12:15], s34 offen offset:2048 nt lds
    s_add_u32 s34, s34, s43
    s_waitcnt vmcnt(11)
    s_waitcnt lgkmcnt(1)
    v_mfma_f32_16x16x32_bf16 v[36:39], v[240:243], a[216:219], v[36:39]
    v_perm_b32 v132, v88, v84, s40
    v_perm_b32 v133, v96, v92, s40
    v_perm_b32 v134, v104, v100, s40
    v_perm_b32 v135, v112, v108, s40
    v_mfma_f32_16x16x32_bf16 v[40:43], v[240:243], a[220:223], v[40:43]
    v_accvgpr_write_b32 a240, v132
    v_accvgpr_write_b32 a241, v133
    v_accvgpr_write_b32 a242, v134
    v_accvgpr_write_b32 a243, v135
    s_add_u32 m0, s42, 36864
    s_nop 0
    v_mfma_f32_16x16x32_bf16 v[44:47], v[240:243], a[224:227], v[44:47]
    v_perm_b32 v132, v88, v84, s41
    v_perm_b32 v133, v96, v92, s41
    v_perm_b32 v134, v104, v100, s41
    v_perm_b32 v135, v112, v108, s41
    v_mfma_f32_16x16x32_bf16 v[48:51], v[240:243], a[228:231], v[48:51]
    v_accvgpr_write_b32 a244, v132
    v_accvgpr_write_b32 a245, v133
    v_accvgpr_write_b32 a246, v134
    v_accvgpr_write_b32 a247, v135
    v_mfma_f32_16x16x32_bf16 v[52:55], v[240:243], a[232:235], v[52:55]
    v_perm_b32 v132, v89, v85, s40
    v_perm_b32 v133, v97, v93, s40
    v_perm_b32 v134, v105, v101, s40
    v_perm_b32 v135, v113, v109, s40
    v_mfma_f32_16x16x32_bf16 v[56:59], v[240:243], a[236:239], v[56:59]
    v_accvgpr_write_b32 a248, v132
    v_accvgpr_write_b32 a249, v133
    v_accvgpr_write_b32 a250, v134
    v_accvgpr_write_b32 a251, v135
    buffer_load_dwordx4 v1, s[12:15], s34 offen offset:0 nt lds
    ds_read_b128 v[240:243], v6 offset:512
    s_waitcnt lgkmcnt(1)
    v_mfma_f32_16x16x32_bf16 v[60:63], v[244:247], a[216:219], v[60:63]
    v_perm_b32 v132, v89, v85, s41
    v_perm_b32 v133, v97, v93, s41
    v_perm_b32 v134, v105, v101, s41
    v_perm_b32 v135, v113, v109, s41
    v_mfma_f32_16x16x32_bf16 v[64:67], v[244:247], a[220:223], v[64:67]
    v_accvgpr_write_b32 a252, v132
    v_accvgpr_write_b32 a253, v133
    v_accvgpr_write_b32 a254, v134
    v_accvgpr_write_b32 a255, v135
    v_mfma_f32_16x16x32_bf16 v[68:71], v[244:247], a[224:227], v[68:71]
    v_perm_b32 v160, v90, v86, s40
    v_perm_b32 v161, v98, v94, s40
    v_perm_b32 v162, v106, v102, s40
    v_perm_b32 v163, v114, v110, s40
    v_mfma_f32_16x16x32_bf16 v[72:75], v[244:247], a[228:231], v[72:75]
    v_perm_b32 v164, v90, v86, s41
    v_perm_b32 v165, v98, v94, s41
    v_perm_b32 v166, v106, v102, s41
    v_perm_b32 v167, v114, v110, s41
    buffer_load_dwordx4 v2, s[12:15], s34 offen offset:1024 nt lds
    v_mfma_f32_16x16x32_bf16 v[76:79], v[244:247], a[232:235], v[76:79]
    v_mfma_f32_16x16x32_bf16 v[80:83], v[244:247], a[236:239], v[80:83]
    ds_read_b128 v[244:247], v6 offset:12800
    buffer_load_dwordx4 v3, s[12:15], s34 offen offset:2048 nt lds
    s_add_u32 s34, s34, s43
    s_waitcnt vmcnt(6)
    s_waitcnt lgkmcnt(1)
    v_mfma_f32_16x16x32_bf16 v[36:39], v[240:243], a[240:243], v[36:39]
    v_perm_b32 v168, v120, v116, s40
    v_perm_b32 v169, v128, v124, s40
    v_mfma_f32_16x16x32_bf16 v[40:43], v[240:243], a[244:247], v[40:43]
    v_perm_b32 v170, v140, v136, s40
    v_perm_b32 v171, v156, v144, s40
    s_add_u32 m0, s42, 49152
    s_nop 0
    v_mfma_f32_16x16x32_bf16 v[44:47], v[240:243], a[248:251], v[44:47]
    v_perm_b32 v172, v120, v116, s41
    v_perm_b32 v173, v128, v124, s41
    v_mfma_f32_16x16x32_bf16 v[48:51], v[240:243], a[252:255], v[48:51]
    v_perm_b32 v174, v140, v136, s41
    v_perm_b32 v175, v156, v144, s41
    v_mfma_f32_16x16x32_bf16 v[52:55], v[240:243], v[160:163], v[52:55]
    v_perm_b32 v176, v121, v117, s40
    v_perm_b32 v177, v129, v125, s40
    v_mfma_f32_16x16x32_bf16 v[56:59], v[240:243], v[164:167], v[56:59]
    v_perm_b32 v178, v141, v137, s40
    v_perm_b32 v179, v157, v145, s40
    buffer_load_dwordx4 v1, s[12:15], s34 offen offset:0 nt lds
    ds_read_b128 v[240:243], v7 offset:512
    s_waitcnt lgkmcnt(1)
    v_mfma_f32_16x16x32_bf16 v[60:63], v[244:247], a[240:243], v[60:63]
    v_perm_b32 v180, v121, v117, s41
    v_perm_b32 v181, v129, v125, s41
    v_mfma_f32_16x16x32_bf16 v[64:67], v[244:247], a[244:247], v[64:67]
    v_perm_b32 v182, v141, v137, s41
    v_perm_b32 v183, v157, v145, s41
    v_mfma_f32_16x16x32_bf16 v[68:71], v[244:247], a[248:251], v[68:71]
    v_perm_b32 v184, v122, v118, s40
    v_perm_b32 v185, v130, v126, s40
    v_mfma_f32_16x16x32_bf16 v[72:75], v[244:247], a[252:255], v[72:75]
    v_perm_b32 v186, v142, v138, s40
    v_perm_b32 v187, v158, v146, s40
    buffer_load_dwordx4 v2, s[12:15], s34 offen offset:1024 nt lds
    v_mfma_f32_16x16x32_bf16 v[76:79], v[244:247], v[160:163], v[76:79]
    v_perm_b32 v188, v122, v118, s41
    v_perm_b32 v189, v130, v126, s41
    v_mfma_f32_16x16x32_bf16 v[80:83], v[244:247], v[164:167], v[80:83]
    v_perm_b32 v190, v142, v138, s41
    v_perm_b32 v191, v158, v146, s41
    ds_read_b128 v[244:247], v7 offset:12800
    buffer_load_dwordx4 v3, s[12:15], s34 offen offset:2048 nt lds
    s_add_u32 s34, s34, s43
    s_nop 1
    s_waitcnt lgkmcnt(1)
    v_mfma_f32_16x16x32_bf16 v[36:39], v[240:243], v[168:171], v[36:39]
    v_mfma_f32_16x16x32_bf16 v[40:43], v[240:243], v[172:175], v[40:43]
    s_add_u32 m0, s42, 61440
    s_nop 0
    v_mfma_f32_16x16x32_bf16 v[44:47], v[240:243], v[176:179], v[44:47]
    v_mfma_f32_16x16x32_bf16 v[48:51], v[240:243], v[180:183], v[48:51]
    v_mfma_f32_16x16x32_bf16 v[52:55], v[240:243], v[184:187], v[52:55]
    v_mfma_f32_16x16x32_bf16 v[56:59], v[240:243], v[188:191], v[56:59]
    buffer_load_dwordx4 v1, s[12:15], s34 offen offset:0 nt lds
    s_waitcnt lgkmcnt(0)
    v_mfma_f32_16x16x32_bf16 v[60:63], v[244:247], v[168:171], v[60:63]
    v_mfma_f32_16x16x32_bf16 v[64:67], v[244:247], v[172:175], v[64:67]
    v_mfma_f32_16x16x32_bf16 v[68:71], v[244:247], v[176:179], v[68:71]
    v_mfma_f32_16x16x32_bf16 v[72:75], v[244:247], v[180:183], v[72:75]
    buffer_load_dwordx4 v2, s[12:15], s34 offen offset:1024 nt lds
    v_mfma_f32_16x16x32_bf16 v[76:79], v[244:247], v[184:187], v[76:79]
    v_mfma_f32_16x16x32_bf16 v[80:83], v[244:247], v[188:191], v[80:83]
    buffer_load_dwordx4 v3, s[12:15], s34 offen offset:2048 nt lds
    s_add_u32 s34, s34, s43
    s_nop 3
    v_cvt_pk_bf16_f32 v132, v36, v40
    v_cvt_pk_bf16_f32 v133, v44, v48
    v_cvt_pk_bf16_f32 v134, v52, v56
    buffer_store_dwordx3 v[132:134], v9, s[20:23], s35 offen offset:0 sc1
    v_cvt_pk_bf16_f32 v136, v37, v41
    v_cvt_pk_bf16_f32 v137, v45, v49
    v_cvt_pk_bf16_f32 v138, v53, v57
    buffer_store_dwordx3 v[136:138], v9, s[20:23], s35 offen offset:768 sc1
    v_cvt_pk_bf16_f32 v140, v38, v42
    v_cvt_pk_bf16_f32 v141, v46, v50
    v_cvt_pk_bf16_f32 v142, v54, v58
    buffer_store_dwordx3 v[140:142], v9, s[20:23], s35 offen offset:1536 sc1
    v_cvt_pk_bf16_f32 v144, v39, v43
    v_cvt_pk_bf16_f32 v145, v47, v51
    v_cvt_pk_bf16_f32 v146, v55, v59
    buffer_store_dwordx3 v[144:146], v9, s[20:23], s35 offen offset:2304 sc1
    s_add_u32 s35, s35, s43
    v_add_u32 v4, 24576, v8
    s_mov_b32 s37, 36864
    s_mov_b32 s33, 2
    s_waitcnt vmcnt(13)
    s_mov_b32 s72, 1
    s_branch L_pro_done
L_proB:
    s_mov_b32 s56, 0x5dddf0
    s_mov_b32 s57, 0x0
    s_mov_b32 s58, 0xdd800000
    s_mov_b32 s59, 0xffffffff
    s_mov_b32 s62, 0xf7600000
    s_mov_b32 s63, 0xffffffff
    s_mov_b32 s36, 0
    s_mov_b32 s46, 13
    s_waitcnt vmcnt(24)
    v_lshlrev_b32 v12, 16, v252
    v_lshlrev_b32 v13, 16, v252
    v_lshlrev_b32 v14, 16, v252
    v_lshlrev_b32 v15, 16, v252
    v_and_b32 v16, 0xffff0000, v252
    v_and_b32 v17, 0xffff0000, v252
    v_and_b32 v18, 0xffff0000, v252
    v_and_b32 v19, 0xffff0000, v252
    v_lshlrev_b32 v20, 16, v253
    v_lshlrev_b32 v21, 16, v253
    v_lshlrev_b32 v22, 16, v253
    v_lshlrev_b32 v23, 16, v253
    v_and_b32 v24, 0xffff0000, v253
    v_and_b32 v25, 0xffff0000, v253
    v_and_b32 v26, 0xffff0000, v253
    v_and_b32 v27, 0xffff0000, v253
    v_lshlrev_b32 v28, 16, v254
    v_lshlrev_b32 v29, 16, v254
    v_lshlrev_b32 v30, 16, v254
    v_lshlrev_b32 v31, 16, v254
    v_and_b32 v32, 0xffff0000, v254
    v_and_b32 v33, 0xffff0000, v254
    v_and_b32 v34, 0xffff0000, v254
    v_and_b32 v35, 0xffff0000, v254
    s_barrier
    ds_read_b128 v[240:243], v4 offset:0
    ds_read_b128 v[244:247], v4 offset:12288
    ds_read_b128 v[248:251], v4 offset:24576
    ds_read_b128 v[252:255], v4 offset:36864
    s_waitcnt vmcnt(16)
    v_perm_b32 v132, v164, v160, s40
    v_perm_b32 v133, v172, v168, s40
    v_perm_b32 v134, v180, v176, s40
    v_perm_b32 v135, v188, v184, s40
    v_accvgpr_write_b32 a0, v132
    v_accvgpr_write_b32 a1, v133
    v_accvgpr_write_b32 a2, v134
    v_accvgpr_write_b32 a3, v135
    v_perm_b32 v132, v164, v160, s41
    v_perm_b32 v133, v172, v168, s41
    v_perm_b32 v134, v180, v176, s41
    v_perm_b32 v135, v188, v184, s41
    v_accvgpr_write_b32 a4, v132
    v_accvgpr_write_b32 a5, v133
    v_accvgpr_write_b32 a6, v134
    v_accvgpr_write_b32 a7, v135
    v_perm_b32 v132, v165, v161, s40
    v_perm_b32 v133, v173, v169, s40
    v_perm_b32 v134, v181, v177, s40
    v_perm_b32 v135, v189, v185, s40
    v_accvgpr_write_b32 a8, v132
    v_accvgpr_write_b32 a9, v133
    v_accvgpr_write_b32 a10, v134
    v_accvgpr_write_b32 a11, v135
    v_perm_b32 v132, v165, v161, s41
    v_perm_b32 v133, v173, v169, s41
    v_perm_b32 v134, v181, v177, s41
    v_perm_b32 v135, v189, v185, s41
    v_accvgpr_write_b32 a12, v132
    v_accvgpr_write_b32 a13, v133
    v_accvgpr_write_b32 a14, v134
    v_accvgpr_write_b32 a15, v135
    v_perm_b32 v132, v166, v162, s40
    v_perm_b32 v133, v174, v170, s40
    v_perm_b32 v134, v182, v178, s40
    v_perm_b32 v135, v190, v186, s40
    v_accvgpr_write_b32 a16, v132
    v_accvgpr_write_b32 a17, v133
    v_accvgpr_write_b32 a18, v134
    v_accvgpr_write_b32 a19, v135
    v_perm_b32 v132, v166, v162, s41
    v_perm_b32 v133, v174, v170, s41
    v_perm_b32 v134, v182, v178, s41
    v_perm_b32 v135, v190, v186, s41
    v_accvgpr_write_b32 a20, v132
    v_accvgpr_write_b32 a21, v133
    v_accvgpr_write_b32 a22, v134
    v_accvgpr_write_b32 a23, v135
    s_mov_b32 s39, 73728
    buffer_load_dwordx3 v[160:162], v10, s[16:19], s39 offen offset:0
    buffer_load_dwordx3 v[164:166], v10, s[16:19], s39 offen offset:768
    buffer_load_dwordx3 v[168:170], v10, s[16:19], s39 offen offset:1536
    buffer_load_dwordx3 v[172:174], v10, s[16:19], s39 offen offset:2304
    buffer_load_dwordx3 v[176:178], v11, s[16:19], s39 offen offset:0
    buffer_load_dwordx3 v[180:182], v11, s[16:19], s39 offen offset:768
    buffer_load_dwordx3 v[184:186], v11, s[16:19], s39 offen offset:1536
    buffer_load_dwordx3 v[188:190], v11, s[16:19], s39 offen offset:2304
    s_waitcnt vmcnt(16)
    s_waitcnt lgkmcnt(3)
    v_mfma_f32_16x16x32_bf16 v[192:195], v[240:243], a[0:3], v[12:15]
    v_perm_b32 v132, v88, v84, s40
    v_perm_b32 v133, v96, v92, s40
    v_mfma_f32_16x16x32_bf16 v[196:199], v[240:243], a[4:7], v[16:19]
    v_perm_b32 v134, v104, v100, s40
    v_perm_b32 v135, v112, v108, s40
    v_mfma_f32_16x16x32_bf16 v[200:203], v[240:243], a[8:11], v[20:23]
    v_accvgpr_write_b32 a24, v132
    v_accvgpr_write_b32 a25, v133
    v_mfma_f32_16x16x32_bf16 v[204:207], v[240:243], a[12:15], v[24:27]
    v_accvgpr_write_b32 a26, v134
    v_accvgpr_write_b32 a27, v135
    v_mfma_f32_16x16x32_bf16 v[208:211], v[240:243], a[16:19], v[28:31]
    v_perm_b32 v132, v88, v84, s41
    v_perm_b32 v133, v96, v92, s41
    v_mfma_f32_16x16x32_bf16 v[212:215], v[240:243], a[20:23], v[32:35]
    v_perm_b32 v134, v104, v100, s41
    v_perm_b32 v135, v112, v108, s41
    ds_read_b128 v[240:243], v5 offset:0
    s_waitcnt lgkmcnt(3)
    v_mfma_f32_16x16x32_bf16 v[216:219], v[244:247], a[0:3], v[12:15]
    v_accvgpr_write_b32 a28, v132
    v_accvgpr_write_b32 a29, v133
    v_mfma_f32_16x16x32_bf16 v[220:223], v[244:247], a[4:7], v[16:19]
    v_accvgpr_write_b32 a30, v134
    v_accvgpr_write_b32 a31, v135
    v_mfma_f32_16x16x32_bf16 v[224:227], v[244:247], a[8:11], v[20:23]
    v_perm_b32 v132, v89, v85, s40
    v_perm_b32 v133, v97, v93, s40
    v_mfma_f32_16x16x32_bf16 v[228:231], v[244:247], a[12:15], v[24:27]
    v_perm_b32 v134, v105, v101, s40
    v_perm_b32 v135, v113, v109, s40
    v_mfma_f32_16x16x32_bf16 v[232:235], v[244:247], a[16:19], v[28:31]
    v_accvgpr_write_b32 a32, v132
    v_accvgpr_write_b32 a33, v133
    v_mfma_f32_16x16x32_bf16 v[236:239], v[244:247], a[20:23], v[32:35]
    v_accvgpr_write_b32 a34, v134
    v_accvgpr_write_b32 a35, v135
    ds_read_b128 v[244:247], v5 offset:12288
    s_waitcnt lgkmcnt(3)
    v_mfma_f32_16x16x32_bf16 v[36:39], v[248:251], a[0:3], v[12:15]
    v_perm_b32 v132, v89, v85, s41
    v_perm_b32 v133, v97, v93, s41
    v_mfma_f32_16x16x32_bf16 v[40:43], v[248:251], a[4:7], v[16:19]
    v_perm_b32 v134, v105, v101, s41
    v_perm_b32 v135, v113, v109, s41
    v_mfma_f32_16x16x32_bf16 v[44:47], v[248:251], a[8:11], v[20:23]
    v_accvgpr_write_b32 a36, v132
    v_accvgpr_write_b32 a37, v133
    v_mfma_f32_16x16x32_bf16 v[48:51], v[248:251], a[12:15], v[24:27]
    v_accvgpr_write_b32 a38, v134
    v_accvgpr_write_b32 a39, v135
    v_mfma_f32_16x16x32_bf16 v[52:55], v[248:251], a[16:19], v[28:31]
    v_perm_b32 v132, v90, v86, s40
    v_perm_b32 v133, v98, v94, s40
    v_mfma_f32_16x16x32_bf16 v[56:59], v[248:251], a[20:23], v[32:35]
    v_perm_b32 v134, v106, v102, s40
    v_perm_b32 v135, v114, v110, s40
    ds_read_b128 v[248:251], v5 offset:24576
    s_waitcnt lgkmcnt(3)
    v_mfma_f32_16x16x32_bf16 v[60:63], v[252:255], a[0:3], v[12:15]
    v_accvgpr_write_b32 a40, v132
    v_accvgpr_write_b32 a41, v133
    v_mfma_f32_16x16x32_bf16 v[64:67], v[252:255], a[4:7], v[16:19]
    v_accvgpr_write_b32 a42, v134
    v_accvgpr_write_b32 a43, v135
    v_mfma_f32_16x16x32_bf16 v[68:71], v[252:255], a[8:11], v[20:23]
    v_perm_b32 v132, v90, v86, s41
    v_perm_b32 v133, v98, v94, s41
    v_mfma_f32_16x16x32_bf16 v[72:75], v[252:255], a[12:15], v[24:27]
    v_perm_b32 v134, v106, v102, s41
    v_perm_b32 v135, v114, v110, s41
    v_mfma_f32_16x16x32_bf16 v[76:79], v[252:255], a[16:19], v[28:31]
    v_accvgpr_write_b32 a44, v132
    v_accvgpr_write_b32 a45, v133
    v_mfma_f32_16x16x32_bf16 v[80:83], v[252:255], a[20:23], v[32:35]
    v_accvgpr_write_b32 a46, v134
    v_accvgpr_write_b32 a47, v135
    ds_read_b128 v[252:255], v5 offset:36864
    s_mov_b32 s39, 98304
    buffer_load_dwordx3 v[84:86], v10, s[16:19], s39 offen offset:0
    buffer_load_dwordx3 v[88:90], v10, s[16:19], s39 offen offset:768
    buffer_load_dwordx3 v[92:94], v10, s[16:19], s39 offen offset:1536
    buffer_load_dwordx3 v[96:98], v10, s[16:19], s39 offen offset:2304
    buffer_load_dwordx3 v[100:102], v11, s[16:19], s39 offen offset:0
    buffer_load_dwordx3 v[104:106], v11, s[16:19], s39 offen offset:768
    buffer_load_dwordx3 v[108:110], v11, s[16:19], s39 offen offset:1536
    buffer_load_dwordx3 v[112:114], v11, s[16:19], s39 offen offset:2304
    s_waitcnt vmcnt(16)
    s_waitcnt lgkmcnt(3)
    v_mfma_f32_16x16x32_bf16 v[192:195], v[240:243], a[24:27], v[192:195]
    v_perm_b32 v132, v120, v116, s40
    v_perm_b32 v133, v128, v124, s40
    v_mfma_f32_16x16x32_bf16 v[196:199], v[240:243], a[28:31], v[196:199]
    v_perm_b32 v134, v140, v136, s40
    v_perm_b32 v135, v156, v144, s40
    v_mfma_f32_16x16x32_bf16 v[200:203], v[240:243], a[32:35], v[200:203]
    v_accvgpr_write_b32 a48, v132
    v_accvgpr_write_b32 a49, v133
    v_mfma_f32_16x16x32_bf16 v[204:207], v[240:243], a[36:39], v[204:207]
    v_accvgpr_write_b32 a50, v134
    v_accvgpr_write_b32 a51, v135
    v_mfma_f32_16x16x32_bf16 v[208:211], v[240:243], a[40:43], v[208:211]
    v_perm_b32 v132, v120, v116, s41
    v_perm_b32 v133, v128, v124, s41
    v_mfma_f32_16x16x32_bf16 v[212:215], v[240:243], a[44:47], v[212:215]
    v_perm_b32 v134, v140, v136, s41
    v_perm_b32 v135, v156, v144, s41
    ds_read_b128 v[240:243], v6 offset:0
    s_waitcnt lgkmcnt(3)
    v_mfma_f32_16x16x32_bf16 v[216:219], v[244:247], a[24:27], v[216:219]
    v_accvgpr_write_b32 a52, v132
    v_accvgpr_write_b32 a53, v133
    v_mfma_f32_16x16x32_bf16 v[220:223], v[244:247], a[28:31], v[220:223]
    v_accvgpr_write_b32 a54, v134
    v_accvgpr_write_b32 a55, v135
    v_mfma_f32_16x16x32_bf16 v[224:227], v[244:247], a[32:35], v[224:227]
    v_perm_b32 v132, v121, v117, s40
    v_perm_b32 v133, v129, v125, s40
    v_mfma_f32_16x16x32_bf16 v[228:231], v[244:247], a[36:39], v[228:231]
    v_perm_b32 v134, v141, v137, s40
    v_perm_b32 v135, v157, v145, s40
    v_mfma_f32_16x16x32_bf16 v[232:235], v[244:247], a[40:43], v[232:235]
    v_accvgpr_write_b32 a56, v132
    v_accvgpr_write_b32 a57, v133
    v_mfma_f32_16x16x32_bf16 v[236:239], v[244:247], a[44:47], v[236:239]
    v_accvgpr_write_b32 a58, v134
    v_accvgpr_write_b32 a59, v135
    ds_read_b128 v[244:247], v6 offset:12288
    s_waitcnt lgkmcnt(3)
    v_mfma_f32_16x16x32_bf16 v[36:39], v[248:251], a[24:27], v[36:39]
    v_perm_b32 v132, v121, v117, s41
    v_perm_b32 v133, v129, v125, s41
    v_mfma_f32_16x16x32_bf16 v[40:43], v[248:251], a[28:31], v[40:43]
    v_perm_b32 v134, v141, v137, s41
    v_perm_b32 v135, v157, v145, s41
    v_mfma_f32_16x16x32_bf16 v[44:47], v[248:251], a[32:35], v[44:47]
    v_accvgpr_write_b32 a60, v132
    v_accvgpr_write_b32 a61, v133
    v_mfma_f32_16x16x32_bf16 v[48:51], v[248:251], a[36:39], v[48:51]
    v_accvgpr_write_b32 a62, v134
    v_accvgpr_write_b32 a63, v135
    v_mfma_f32_16x16x32_bf16 v[52:55], v[248:251], a[40:43], v[52:55]
    v_perm_b32 v132, v122, v118, s40
    v_perm_b32 v133, v130, v126, s40
    v_mfma_f32_16x16x32_bf16 v[56:59], v[248:251], a[44:47], v[56:59]
    v_perm_b32 v134, v142, v138, s40
    v_perm_b32 v135, v158, v146, s40
    ds_read_b128 v[248:251], v6 offset:24576
    s_waitcnt lgkmcnt(3)
    v_mfma_f32_16x16x32_bf16 v[60:63], v[252:255], a[24:27], v[60:63]
    v_accvgpr_write_b32 a64, v132
    v_accvgpr_write_b32 a65, v133
    v_mfma_f32_16x16x32_bf16 v[64:67], v[252:255], a[28:31], v[64:67]
    v_accvgpr_write_b32 a66, v134
    v_accvgpr_write_b32 a67, v135
    v_mfma_f32_16x16x32_bf16 v[68:71], v[252:255], a[32:35], v[68:71]
    v_perm_b32 v132, v122, v118, s41
    v_perm_b32 v133, v130, v126, s41
    v_mfma_f32_16x16x32_bf16 v[72:75], v[252:255], a[36:39], v[72:75]
    v_perm_b32 v134, v142, v138, s41
    v_perm_b32 v135, v158, v146, s41
    v_mfma_f32_16x16x32_bf16 v[76:79], v[252:255], a[40:43], v[76:79]
    v_accvgpr_write_b32 a68, v132
    v_accvgpr_write_b32 a69, v133
    v_mfma_f32_16x16x32_bf16 v[80:83], v[252:255], a[44:47], v[80:83]
    v_accvgpr_write_b32 a70, v134
    v_accvgpr_write_b32 a71, v135
    ds_read_b128 v[252:255], v6 offset:36864
    s_mov_b32 s39, 122880
    buffer_load_dwordx3 v[116:118], v10, s[16:19], s39 offen offset:0
    buffer_load_dwordx3 v[120:122], v10, s[16:19], s39 offen offset:768
    buffer_load_dwordx3 v[124:126], v10, s[16:19], s39 offen offset:1536
    buffer_load_dwordx3 v[128:130], v10, s[16:19], s39 offen offset:2304
    buffer_load_dwordx3 v[136:138], v11, s[16:19], s39 offen offset:0
    buffer_load_dwordx3 v[140:142], v11, s[16:19], s39 offen offset:768
    buffer_load_dwordx3 v[144:146], v11, s[16:19], s39 offen offset:1536
    buffer_load_dwordx3 v[156:158], v11, s[16:19], s39 offen offset:2304
    s_waitcnt vmcnt(16)
    s_waitcnt lgkmcnt(3)
    v_mfma_f32_16x16x32_bf16 v[192:195], v[240:243], a[48:51], v[192:195]
    v_perm_b32 v132, v164, v160, s40
    v_perm_b32 v133, v172, v168, s40
    v_mfma_f32_16x16x32_bf16 v[196:199], v[240:243], a[52:55], v[196:199]
    v_perm_b32 v134, v180, v176, s40
    v_perm_b32 v135, v188, v184, s40
    v_mfma_f32_16x16x32_bf16 v[200:203], v[240:243], a[56:59], v[200:203]
    v_accvgpr_write_b32 a72, v132
    v_accvgpr_write_b32 a73, v133
    v_mfma_f32_16x16x32_bf16 v[204:207], v[240:243], a[60:63], v[204:207]
    v_accvgpr_write_b32 a74, v134
    v_accvgpr_write_b32 a75, v135
    v_mfma_f32_16x16x32_bf16 v[208:211], v[240:243], a[64:67], v[208:211]
    v_perm_b32 v132, v164, v160, s41
    v_perm_b32 v133, v172, v168, s41
    v_mfma_f32_16x16x32_bf16 v[212:215], v[240:243], a[68:71], v[212:215]
    v_perm_b32 v134, v180, v176, s41
    v_perm_b32 v135, v188, v184, s41
    ds_read_b128 v[240:243], v7 offset:0
    s_waitcnt lgkmcnt(3)
    v_mfma_f32_16x16x32_bf16 v[216:219], v[244:247], a[48:51], v[216:219]
    v_accvgpr_write_b32 a76, v132
    v_accvgpr_write_b32 a77, v133
    v_mfma_f32_16x16x32_bf16 v[220:223], v[244:247], a[52:55], v[220:223]
    v_accvgpr_write_b32 a78, v134
    v_accvgpr_write_b32 a79, v135
    v_mfma_f32_16x16x32_bf16 v[224:227], v[244:247], a[56:59], v[224:227]
    v_perm_b32 v132, v165, v161, s40
    v_perm_b32 v133, v173, v169, s40
    v_mfma_f32_16x16x32_bf16 v[228:231], v[244:247], a[60:63], v[228:231]
    v_perm_b32 v134, v181, v177, s40
    v_perm_b32 v135, v189, v185, s40
    v_mfma_f32_16x16x32_bf16 v[232:235], v[244:247], a[64:67], v[232:235]
    v_accvgpr_write_b32 a80, v132
    v_accvgpr_write_b32 a81, v133
    v_mfma_f32_16x16x32_bf16 v[236:239], v[244:247], a[68:71], v[236:239]
    v_accvgpr_write_b32 a82, v134
    v_accvgpr_write_b32 a83, v135
    ds_read_b128 v[244:247], v7 offset:12288
    s_waitcnt lgkmcnt(3)
    v_mfma_f32_16x16x32_bf16 v[36:39], v[248:251], a[48:51], v[36:39]
    v_perm_b32 v132, v165, v161, s41
    v_perm_b32 v133, v173, v169, s41
    v_mfma_f32_16x16x32_bf16 v[40:43], v[248:251], a[52:55], v[40:43]
    v_perm_b32 v134, v181, v177, s41
    v_perm_b32 v135, v189, v185, s41
    v_mfma_f32_16x16x32_bf16 v[44:47], v[248:251], a[56:59], v[44:47]
    v_accvgpr_write_b32 a84, v132
    v_accvgpr_write_b32 a85, v133
    v_mfma_f32_16x16x32_bf16 v[48:51], v[248:251], a[60:63], v[48:51]
    v_accvgpr_write_b32 a86, v134
    v_accvgpr_write_b32 a87, v135
    v_mfma_f32_16x16x32_bf16 v[52:55], v[248:251], a[64:67], v[52:55]
    v_perm_b32 v132, v166, v162, s40
    v_perm_b32 v133, v174, v170, s40
    v_mfma_f32_16x16x32_bf16 v[56:59], v[248:251], a[68:71], v[56:59]
    v_perm_b32 v134, v182, v178, s40
    v_perm_b32 v135, v190, v186, s40
    ds_read_b128 v[248:251], v7 offset:24576
    s_waitcnt lgkmcnt(3)
    v_mfma_f32_16x16x32_bf16 v[60:63], v[252:255], a[48:51], v[60:63]
    v_accvgpr_write_b32 a88, v132
    v_accvgpr_write_b32 a89, v133
    v_mfma_f32_16x16x32_bf16 v[64:67], v[252:255], a[52:55], v[64:67]
    v_accvgpr_write_b32 a90, v134
    v_accvgpr_write_b32 a91, v135
    v_mfma_f32_16x16x32_bf16 v[68:71], v[252:255], a[56:59], v[68:71]
    v_perm_b32 v132, v166, v162, s41
    v_perm_b32 v133, v174, v170, s41
    v_mfma_f32_16x16x32_bf16 v[72:75], v[252:255], a[60:63], v[72:75]
    v_perm_b32 v134, v182, v178, s41
    v_perm_b32 v135, v190, v186, s41
    v_mfma_f32_16x16x32_bf16 v[76:79], v[252:255], a[64:67], v[76:79]
    v_accvgpr_write_b32 a92, v132
    v_accvgpr_write_b32 a93, v133
    v_mfma_f32_16x16x32_bf16 v[80:83], v[252:255], a[68:71], v[80:83]
    v_accvgpr_write_b32 a94, v134
    v_accvgpr_write_b32 a95, v135
    ds_read_b128 v[252:255], v7 offset:36864
    s_mov_b32 s39, 147456
    buffer_load_dwordx3 v[160:162], v10, s[16:19], s39 offen offset:0
    buffer_load_dwordx3 v[164:166], v10, s[16:19], s39 offen offset:768
    buffer_load_dwordx3 v[168:170], v10, s[16:19], s39 offen offset:1536
    buffer_load_dwordx3 v[172:174], v10, s[16:19], s39 offen offset:2304
    buffer_load_dwordx3 v[176:178], v11, s[16:19], s39 offen offset:0
    buffer_load_dwordx3 v[180:182], v11, s[16:19], s39 offen offset:768
    buffer_load_dwordx3 v[184:186], v11, s[16:19], s39 offen offset:1536
    buffer_load_dwordx3 v[188:190], v11, s[16:19], s39 offen offset:2304
    s_waitcnt vmcnt(16)
    s_waitcnt lgkmcnt(3)
    v_mfma_f32_16x16x32_bf16 v[192:195], v[240:243], a[72:75], v[192:195]
    v_perm_b32 v132, v88, v84, s40
    v_perm_b32 v133, v96, v92, s40
    v_mfma_f32_16x16x32_bf16 v[196:199], v[240:243], a[76:79], v[196:199]
    v_perm_b32 v134, v104, v100, s40
    v_perm_b32 v135, v112, v108, s40
    v_mfma_f32_16x16x32_bf16 v[200:203], v[240:243], a[80:83], v[200:203]
    v_accvgpr_write_b32 a96, v132
    v_accvgpr_write_b32 a97, v133
    v_mfma_f32_16x16x32_bf16 v[204:207], v[240:243], a[84:87], v[204:207]
    v_accvgpr_write_b32 a98, v134
    v_accvgpr_write_b32 a99, v135
    v_mfma_f32_16x16x32_bf16 v[208:211], v[240:243], a[88:91], v[208:211]
    v_perm_b32 v132, v88, v84, s41
    v_perm_b32 v133, v96, v92, s41
    v_mfma_f32_16x16x32_bf16 v[212:215], v[240:243], a[92:95], v[212:215]
    v_perm_b32 v134, v104, v100, s41
    v_perm_b32 v135, v112, v108, s41
    ds_read_b128 v[240:243], v4 offset:256
    s_waitcnt lgkmcnt(3)
    v_mfma_f32_16x16x32_bf16 v[216:219], v[244:247], a[72:75], v[216:219]
    v_accvgpr_write_b32 a100, v132
    v_accvgpr_write_b32 a101, v133
    v_mfma_f32_16x16x32_bf16 v[220:223], v[244:247], a[76:79], v[220:223]
    v_accvgpr_write_b32 a102, v134
    v_accvgpr_write_b32 a103, v135
    v_mfma_f32_16x16x32_bf16 v[224:227], v[244:247], a[80:83], v[224:227]
    v_perm_b32 v132, v89, v85, s40
    v_perm_b32 v133, v97, v93, s40
    v_mfma_f32_16x16x32_bf16 v[228:231], v[244:247], a[84:87], v[228:231]
    v_perm_b32 v134, v105, v101, s40
    v_perm_b32 v135, v113, v109, s40
    v_mfma_f32_16x16x32_bf16 v[232:235], v[244:247], a[88:91], v[232:235]
    v_accvgpr_write_b32 a104, v132
    v_accvgpr_write_b32 a105, v133
    v_mfma_f32_16x16x32_bf16 v[236:239], v[244:247], a[92:95], v[236:239]
    v_accvgpr_write_b32 a106, v134
    v_accvgpr_write_b32 a107, v135
    ds_read_b128 v[244:247], v4 offset:12544
    s_waitcnt lgkmcnt(3)
    v_mfma_f32_16x16x32_bf16 v[36:39], v[248:251], a[72:75], v[36:39]
    v_perm_b32 v132, v89, v85, s41
    v_perm_b32 v133, v97, v93, s41
    v_mfma_f32_16x16x32_bf16 v[40:43], v[248:251], a[76:79], v[40:43]
    v_perm_b32 v134, v105, v101, s41
    v_perm_b32 v135, v113, v109, s41
    v_mfma_f32_16x16x32_bf16 v[44:47], v[248:251], a[80:83], v[44:47]
    v_accvgpr_write_b32 a108, v132
    v_accvgpr_write_b32 a109, v133
    v_mfma_f32_16x16x32_bf16 v[48:51], v[248:251], a[84:87], v[48:51]
    v_accvgpr_write_b32 a110, v134
    v_accvgpr_write_b32 a111, v135
    v_mfma_f32_16x16x32_bf16 v[52:55], v[248:251], a[88:91], v[52:55]
    v_perm_b32 v132, v90, v86, s40
    v_perm_b32 v133, v98, v94, s40
    v_mfma_f32_16x16x32_bf16 v[56:59], v[248:251], a[92:95], v[56:59]
    v_perm_b32 v134, v106, v102, s40
    v_perm_b32 v135, v114, v110, s40
    ds_read_b128 v[248:251], v4 offset:24832
    s_waitcnt lgkmcnt(3)
    v_mfma_f32_16x16x32_bf16 v[60:63], v[252:255], a[72:75], v[60:63]
    v_accvgpr_write_b32 a112, v132
    v_accvgpr_write_b32 a113, v133
    v_mfma_f32_16x16x32_bf16 v[64:67], v[252:255], a[76:79], v[64:67]
    v_accvgpr_write_b32 a114, v134
    v_accvgpr_write_b32 a115, v135
    v_mfma_f32_16x16x32_bf16 v[68:71], v[252:255], a[80:83], v[68:71]
    v_perm_b32 v132, v90, v86, s41
    v_perm_b32 v133, v98, v94, s41
    v_mfma_f32_16x16x32_bf16 v[72:75], v[252:255], a[84:87], v[72:75]
    v_perm_b32 v134, v106, v102, s41
    v_perm_b32 v135, v114, v110, s41
    v_mfma_f32_16x16x32_bf16 v[76:79], v[252:255], a[88:91], v[76:79]
    v_accvgpr_write_b32 a116, v132
    v_accvgpr_write_b32 a117, v133
    v_mfma_f32_16x16x32_bf16 v[80:83], v[252:255], a[92:95], v[80:83]
    v_accvgpr_write_b32 a118, v134
    v_accvgpr_write_b32 a119, v135
    ds_read_b128 v[252:255], v4 offset:37120
    s_mov_b32 s39, 172032
    buffer_load_dwordx3 v[84:86], v10, s[16:19], s39 offen offset:0
    buffer_load_dwordx3 v[88:90], v10, s[16:19], s39 offen offset:768
    buffer_load_dwordx3 v[92:94], v10, s[16:19], s39 offen offset:1536
    buffer_load_dwordx3 v[96:98], v10, s[16:19], s39 offen offset:2304
    buffer_load_dwordx3 v[100:102], v11, s[16:19], s39 offen offset:0
    buffer_load_dwordx3 v[104:106], v11, s[16:19], s39 offen offset:768
    buffer_load_dwordx3 v[108:110], v11, s[16:19], s39 offen offset:1536
    buffer_load_dwordx3 v[112:114], v11, s[16:19], s39 offen offset:2304
    s_waitcnt vmcnt(16)
    s_waitcnt lgkmcnt(3)
    v_mfma_f32_16x16x32_bf16 v[192:195], v[240:243], a[96:99], v[192:195]
    v_perm_b32 v132, v120, v116, s40
    v_perm_b32 v133, v128, v124, s40
    v_mfma_f32_16x16x32_bf16 v[196:199], v[240:243], a[100:103], v[196:199]
    v_perm_b32 v134, v140, v136, s40
    v_perm_b32 v135, v156, v144, s40
    v_mfma_f32_16x16x32_bf16 v[200:203], v[240:243], a[104:107], v[200:203]
    v_accvgpr_write_b32 a120, v132
    v_accvgpr_write_b32 a121, v133
    v_mfma_f32_16x16x32_bf16 v[204:207], v[240:243], a[108:111], v[204:207]
    v_accvgpr_write_b32 a122, v134
    v_accvgpr_write_b32 a123, v135
    v_mfma_f32_16x16x32_bf16 v[208:211], v[240:243], a[112:115], v[208:211]
    v_perm_b32 v132, v120, v116, s41
    v_perm_b32 v133, v128, v124, s41
    v_mfma_f32_16x16x32_bf16 v[212:215], v[240:243], a[116:119], v[212:215]
    v_perm_b32 v134, v140, v136, s41
    v_perm_b32 v135, v156, v144, s41
    ds_read_b128 v[240:243], v5 offset:256
    s_waitcnt lgkmcnt(3)
    v_mfma_f32_16x16x32_bf16 v[216:219], v[244:247], a[96:99], v[216:219]
    v_accvgpr_write_b32 a124, v132
    v_accvgpr_write_b32 a125, v133
    v_mfma_f32_16x16x32_bf16 v[220:223], v[244:247], a[100:103], v[220:223]
    v_accvgpr_write_b32 a126, v134
    v_accvgpr_write_b32 a127, v135
    v_mfma_f32_16x16x32_bf16 v[224:227], v[244:247], a[104:107], v[224:227]
    v_perm_b32 v132, v121, v117, s40
    v_perm_b32 v133, v129, v125, s40
    v_mfma_f32_16x16x32_bf16 v[228:231], v[244:247], a[108:111], v[228:231]
    v_perm_b32 v134, v141, v137, s40
    v_perm_b32 v135, v157, v145, s40
    v_mfma_f32_16x16x32_bf16 v[232:235], v[244:247], a[112:115], v[232:235]
    v_accvgpr_write_b32 a128, v132
    v_accvgpr_write_b32 a129, v133
    v_mfma_f32_16x16x32_bf16 v[236:239], v[244:247], a[116:119], v[236:239]
    v_accvgpr_write_b32 a130, v134
    v_accvgpr_write_b32 a131, v135
    ds_read_b128 v[244:247], v5 offset:12544
    s_waitcnt lgkmcnt(3)
    v_mfma_f32_16x16x32_bf16 v[36:39], v[248:251], a[96:99], v[36:39]
    v_perm_b32 v132, v121, v117, s41
    v_perm_b32 v133, v129, v125, s41
    v_mfma_f32_16x16x32_bf16 v[40:43], v[248:251], a[100:103], v[40:43]
    v_perm_b32 v134, v141, v137, s41
    v_perm_b32 v135, v157, v145, s41
    v_mfma_f32_16x16x32_bf16 v[44:47], v[248:251], a[104:107], v[44:47]
    v_accvgpr_write_b32 a132, v132
    v_accvgpr_write_b32 a133, v133
    v_mfma_f32_16x16x32_bf16 v[48:51], v[248:251], a[108:111], v[48:51]
    v_accvgpr_write_b32 a134, v134
    v_accvgpr_write_b32 a135, v135
    v_mfma_f32_16x16x32_bf16 v[52:55], v[248:251], a[112:115], v[52:55]
    v_perm_b32 v132, v122, v118, s40
    v_perm_b32 v133, v130, v126, s40
    v_mfma_f32_16x16x32_bf16 v[56:59], v[248:251], a[116:119], v[56:59]
    v_perm_b32 v134, v142, v138, s40
    v_perm_b32 v135, v158, v146, s40
    ds_read_b128 v[248:251], v5 offset:24832
    s_waitcnt lgkmcnt(3)
    v_mfma_f32_16x16x32_bf16 v[60:63], v[252:255], a[96:99], v[60:63]
    v_accvgpr_write_b32 a136, v132
    v_accvgpr_write_b32 a137, v133
    v_mfma_f32_16x16x32_bf16 v[64:67], v[252:255], a[100:103], v[64:67]
    v_accvgpr_write_b32 a138, v134
    v_accvgpr_write_b32 a139, v135
    v_mfma_f32_16x16x32_bf16 v[68:71], v[252:255], a[104:107], v[68:71]
    v_perm_b32 v132, v122, v118, s41
    v_perm_b32 v133, v130, v126, s41
    v_mfma_f32_16x16x32_bf16 v[72:75], v[252:255], a[108:111], v[72:75]
    v_perm_b32 v134, v142, v138, s41
    v_perm_b32 v135, v158, v146, s41
    v_mfma_f32_16x16x32_bf16 v[76:79], v[252:255], a[112:115], v[76:79]
    v_accvgpr_write_b32 a140, v132
    v_accvgpr_write_b32 a141, v133
    v_mfma_f32_16x16x32_bf16 v[80:83], v[252:255], a[116:119], v[80:83]
    v_accvgpr_write_b32 a142, v134
    v_accvgpr_write_b32 a143, v135
    ds_read_b128 v[252:255], v5 offset:37120
    s_mov_b32 s39, 196608
    buffer_load_dwordx3 v[116:118], v10, s[16:19], s39 offen offset:0
    buffer_load_dwordx3 v[120:122], v10, s[16:19], s39 offen offset:768
    buffer_load_dwordx3 v[124:126], v10, s[16:19], s39 offen offset:1536
    buffer_load_dwordx3 v[128:130], v10, s[16:19], s39 offen offset:2304
    buffer_load_dwordx3 v[136:138], v11, s[16:19], s39 offen offset:0
    buffer_load_dwordx3 v[140:142], v11, s[16:19], s39 offen offset:768
    buffer_load_dwordx3 v[144:146], v11, s[16:19], s39 offen offset:1536
    buffer_load_dwordx3 v[156:158], v11, s[16:19], s39 offen offset:2304
    s_waitcnt vmcnt(16)
    s_waitcnt lgkmcnt(3)
    v_mfma_f32_16x16x32_bf16 v[192:195], v[240:243], a[120:123], v[192:195]
    v_perm_b32 v132, v164, v160, s40
    v_perm_b32 v133, v172, v168, s40
    v_mfma_f32_16x16x32_bf16 v[196:199], v[240:243], a[124:127], v[196:199]
    v_perm_b32 v134, v180, v176, s40
    v_perm_b32 v135, v188, v184, s40
    v_mfma_f32_16x16x32_bf16 v[200:203], v[240:243], a[128:131], v[200:203]
    v_accvgpr_write_b32 a144, v132
    v_accvgpr_write_b32 a145, v133
    v_mfma_f32_16x16x32_bf16 v[204:207], v[240:243], a[132:135], v[204:207]
    v_accvgpr_write_b32 a146, v134
    v_accvgpr_write_b32 a147, v135
    v_mfma_f32_16x16x32_bf16 v[208:211], v[240:243], a[136:139], v[208:211]
    v_perm_b32 v132, v164, v160, s41
    v_perm_b32 v133, v172, v168, s41
    v_mfma_f32_16x16x32_bf16 v[212:215], v[240:243], a[140:143], v[212:215]
    v_perm_b32 v134, v180, v176, s41
    v_perm_b32 v135, v188, v184, s41
    ds_read_b128 v[240:243], v6 offset:256
    s_waitcnt lgkmcnt(3)
    v_mfma_f32_16x16x32_bf16 v[216:219], v[244:247], a[120:123], v[216:219]
    v_accvgpr_write_b32 a148, v132
    v_accvgpr_write_b32 a149, v133
    v_mfma_f32_16x16x32_bf16 v[220:223], v[244:247], a[124:127], v[220:223]
    v_accvgpr_write_b32 a150, v134
    v_accvgpr_write_b32 a151, v135
    v_mfma_f32_16x16x32_bf16 v[224:227], v[244:247], a[128:131], v[224:227]
    v_perm_b32 v132, v165, v161, s40
    v_perm_b32 v133, v173, v169, s40
    v_mfma_f32_16x16x32_bf16 v[228:231], v[244:247], a[132:135], v[228:231]
    v_perm_b32 v134, v181, v177, s40
    v_perm_b32 v135, v189, v185, s40
    v_mfma_f32_16x16x32_bf16 v[232:235], v[244:247], a[136:139], v[232:235]
    v_accvgpr_write_b32 a152, v132
    v_accvgpr_write_b32 a153, v133
    v_mfma_f32_16x16x32_bf16 v[236:239], v[244:247], a[140:143], v[236:239]
    v_accvgpr_write_b32 a154, v134
    v_accvgpr_write_b32 a155, v135
    ds_read_b128 v[244:247], v6 offset:12544
    s_waitcnt lgkmcnt(3)
    v_mfma_f32_16x16x32_bf16 v[36:39], v[248:251], a[120:123], v[36:39]
    v_perm_b32 v132, v165, v161, s41
    v_perm_b32 v133, v173, v169, s41
    v_mfma_f32_16x16x32_bf16 v[40:43], v[248:251], a[124:127], v[40:43]
    v_perm_b32 v134, v181, v177, s41
    v_perm_b32 v135, v189, v185, s41
    v_mfma_f32_16x16x32_bf16 v[44:47], v[248:251], a[128:131], v[44:47]
    v_accvgpr_write_b32 a156, v132
    v_accvgpr_write_b32 a157, v133
    v_mfma_f32_16x16x32_bf16 v[48:51], v[248:251], a[132:135], v[48:51]
    v_accvgpr_write_b32 a158, v134
    v_accvgpr_write_b32 a159, v135
    v_mfma_f32_16x16x32_bf16 v[52:55], v[248:251], a[136:139], v[52:55]
    v_perm_b32 v132, v166, v162, s40
    v_perm_b32 v133, v174, v170, s40
    v_mfma_f32_16x16x32_bf16 v[56:59], v[248:251], a[140:143], v[56:59]
    v_perm_b32 v134, v182, v178, s40
    v_perm_b32 v135, v190, v186, s40
    ds_read_b128 v[248:251], v6 offset:24832
    s_waitcnt lgkmcnt(3)
    v_mfma_f32_16x16x32_bf16 v[60:63], v[252:255], a[120:123], v[60:63]
    v_accvgpr_write_b32 a160, v132
    v_accvgpr_write_b32 a161, v133
    v_mfma_f32_16x16x32_bf16 v[64:67], v[252:255], a[124:127], v[64:67]
    v_accvgpr_write_b32 a162, v134
    v_accvgpr_write_b32 a163, v135
    v_mfma_f32_16x16x32_bf16 v[68:71], v[252:255], a[128:131], v[68:71]
    v_perm_b32 v132, v166, v162, s41
    v_perm_b32 v133, v174, v170, s41
    v_mfma_f32_16x16x32_bf16 v[72:75], v[252:255], a[132:135], v[72:75]
    v_perm_b32 v134, v182, v178, s41
    v_perm_b32 v135, v190, v186, s41
    v_mfma_f32_16x16x32_bf16 v[76:79], v[252:255], a[136:139], v[76:79]
    v_accvgpr_write_b32 a164, v132
    v_accvgpr_write_b32 a165, v133
    v_mfma_f32_16x16x32_bf16 v[80:83], v[252:255], a[140:143], v[80:83]
    v_accvgpr_write_b32 a166, v134
    v_accvgpr_write_b32 a167, v135
    ds_read_b128 v[252:255], v6 offset:37120
    s_mov_b32 s39, 221184
    buffer_load_dwordx3 v[160:162], v10, s[16:19], s39 offen offset:0
    buffer_load_dwordx3 v[164:166], v10, s[16:19], s39 offen offset:768
    buffer_load_dwordx3 v[168:170], v10, s[16:19], s39 offen offset:1536
    buffer_load_dwordx3 v[172:174], v10, s[16:19], s39 offen offset:2304
    buffer_load_dwordx3 v[176:178], v11, s[16:19], s39 offen offset:0
    buffer_load_dwordx3 v[180:182], v11, s[16:19], s39 offen offset:768
    buffer_load_dwordx3 v[184:186], v11, s[16:19], s39 offen offset:1536
    buffer_load_dwordx3 v[188:190], v11, s[16:19], s39 offen offset:2304
    s_waitcnt vmcnt(16)
    s_waitcnt lgkmcnt(3)
    v_mfma_f32_16x16x32_bf16 v[192:195], v[240:243], a[144:147], v[192:195]
    v_perm_b32 v132, v88, v84, s40
    v_perm_b32 v133, v96, v92, s40
    v_mfma_f32_16x16x32_bf16 v[196:199], v[240:243], a[148:151], v[196:199]
    v_perm_b32 v134, v104, v100, s40
    v_perm_b32 v135, v112, v108, s40
    v_mfma_f32_16x16x32_bf16 v[200:203], v[240:243], a[152:155], v[200:203]
    v_accvgpr_write_b32 a168, v132
    v_accvgpr_write_b32 a169, v133
    v_mfma_f32_16x16x32_bf16 v[204:207], v[240:243], a[156:159], v[204:207]
    v_accvgpr_write_b32 a170, v134
    v_accvgpr_write_b32 a171, v135
    v_mfma_f32_16x16x32_bf16 v[208:211], v[240:243], a[160:163], v[208:211]
    v_perm_b32 v132, v88, v84, s41
    v_perm_b32 v133, v96, v92, s41
    v_mfma_f32_16x16x32_bf16 v[212:215], v[240:243], a[164:167], v[212:215]
    v_perm_b32 v134, v104, v100, s41
    v_perm_b32 v135, v112, v108, s41
    ds_read_b128 v[240:243], v7 offset:256
    s_waitcnt lgkmcnt(3)
    v_mfma_f32_16x16x32_bf16 v[216:219], v[244:247], a[144:147], v[216:219]
    v_accvgpr_write_b32 a172, v132
    v_accvgpr_write_b32 a173, v133
    v_mfma_f32_16x16x32_bf16 v[220:223], v[244:247], a[148:151], v[220:223]
    v_accvgpr_write_b32 a174, v134
    v_accvgpr_write_b32 a175, v135
    v_mfma_f32_16x16x32_bf16 v[224:227], v[244:247], a[152:155], v[224:227]
    v_perm_b32 v132, v89, v85, s40
    v_perm_b32 v133, v97, v93, s40
    v_mfma_f32_16x16x32_bf16 v[228:231], v[244:247], a[156:159], v[228:231]
    v_perm_b32 v134, v105, v101, s40
    v_perm_b32 v135, v113, v109, s40
    v_mfma_f32_16x16x32_bf16 v[232:235], v[244:247], a[160:163], v[232:235]
    v_accvgpr_write_b32 a176, v132
    v_accvgpr_write_b32 a177, v133
    v_mfma_f32_16x16x32_bf16 v[236:239], v[244:247], a[164:167], v[236:239]
    v_accvgpr_write_b32 a178, v134
    v_accvgpr_write_b32 a179, v135
    ds_read_b128 v[244:247], v7 offset:12544
    s_waitcnt lgkmcnt(3)
    v_mfma_f32_16x16x32_bf16 v[36:39], v[248:251], a[144:147], v[36:39]
    v_perm_b32 v132, v89, v85, s41
    v_perm_b32 v133, v97, v93, s41
    v_mfma_f32_16x16x32_bf16 v[40:43], v[248:251], a[148:151], v[40:43]
    v_perm_b32 v134, v105, v101, s41
    v_perm_b32 v135, v113, v109, s41
    v_mfma_f32_16x16x32_bf16 v[44:47], v[248:251], a[152:155], v[44:47]
    v_accvgpr_write_b32 a180, v132
    v_accvgpr_write_b32 a181, v133
    v_mfma_f32_16x16x32_bf16 v[48:51], v[248:251], a[156:159], v[48:51]
    v_accvgpr_write_b32 a182, v134
    v_accvgpr_write_b32 a183, v135
    v_mfma_f32_16x16x32_bf16 v[52:55], v[248:251], a[160:163], v[52:55]
    v_perm_b32 v132, v90, v86, s40
    v_perm_b32 v133, v98, v94, s40
    v_mfma_f32_16x16x32_bf16 v[56:59], v[248:251], a[164:167], v[56:59]
    v_perm_b32 v134, v106, v102, s40
    v_perm_b32 v135, v114, v110, s40
    ds_read_b128 v[248:251], v7 offset:24832
    s_waitcnt lgkmcnt(3)
    v_mfma_f32_16x16x32_bf16 v[60:63], v[252:255], a[144:147], v[60:63]
    v_accvgpr_write_b32 a184, v132
    v_accvgpr_write_b32 a185, v133
    v_mfma_f32_16x16x32_bf16 v[64:67], v[252:255], a[148:151], v[64:67]
    v_accvgpr_write_b32 a186, v134
    v_accvgpr_write_b32 a187, v135
    v_mfma_f32_16x16x32_bf16 v[68:71], v[252:255], a[152:155], v[68:71]
    v_perm_b32 v132, v90, v86, s41
    v_perm_b32 v133, v98, v94, s41
    v_mfma_f32_16x16x32_bf16 v[72:75], v[252:255], a[156:159], v[72:75]
    v_perm_b32 v134, v106, v102, s41
    v_perm_b32 v135, v114, v110, s41
    v_mfma_f32_16x16x32_bf16 v[76:79], v[252:255], a[160:163], v[76:79]
    v_accvgpr_write_b32 a188, v132
    v_accvgpr_write_b32 a189, v133
    v_mfma_f32_16x16x32_bf16 v[80:83], v[252:255], a[164:167], v[80:83]
    v_accvgpr_write_b32 a190, v134
    v_accvgpr_write_b32 a191, v135
    ds_read_b128 v[252:255], v7 offset:37120
    s_mov_b32 s39, 245760
    buffer_load_dwordx3 v[84:86], v10, s[16:19], s39 offen offset:0
    buffer_load_dwordx3 v[88:90], v10, s[16:19], s39 offen offset:768
    buffer_load_dwordx3 v[92:94], v10, s[16:19], s39 offen offset:1536
    buffer_load_dwordx3 v[96:98], v10, s[16:19], s39 offen offset:2304
    buffer_load_dwordx3 v[100:102], v11, s[16:19], s39 offen offset:0
    buffer_load_dwordx3 v[104:106], v11, s[16:19], s39 offen offset:768
    buffer_load_dwordx3 v[108:110], v11, s[16:19], s39 offen offset:1536
    buffer_load_dwordx3 v[112:114], v11, s[16:19], s39 offen offset:2304
    s_waitcnt vmcnt(16)
    s_waitcnt lgkmcnt(3)
    v_mfma_f32_16x16x32_bf16 v[192:195], v[240:243], a[168:171], v[192:195]
    v_perm_b32 v132, v120, v116, s40
    v_perm_b32 v133, v128, v124, s40
    v_mfma_f32_16x16x32_bf16 v[196:199], v[240:243], a[172:175], v[196:199]
    v_perm_b32 v134, v140, v136, s40
    v_perm_b32 v135, v156, v144, s40
    v_mfma_f32_16x16x32_bf16 v[200:203], v[240:243], a[176:179], v[200:203]
    v_accvgpr_write_b32 a192, v132
    v_accvgpr_write_b32 a193, v133
    v_mfma_f32_16x16x32_bf16 v[204:207], v[240:243], a[180:183], v[204:207]
    v_accvgpr_write_b32 a194, v134
    v_accvgpr_write_b32 a195, v135
    v_mfma_f32_16x16x32_bf16 v[208:211], v[240:243], a[184:187], v[208:211]
    v_perm_b32 v132, v120, v116, s41
    v_perm_b32 v133, v128, v124, s41
    v_mfma_f32_16x16x32_bf16 v[212:215], v[240:243], a[188:191], v[212:215]
    v_perm_b32 v134, v140, v136, s41
    v_perm_b32 v135, v156, v144, s41
    ds_read_b128 v[240:243], v4 offset:512
    s_waitcnt lgkmcnt(3)
    v_mfma_f32_16x16x32_bf16 v[216:219], v[244:247], a[168:171], v[216:219]
    v_accvgpr_write_b32 a196, v132
    v_accvgpr_write_b32 a197, v133
    v_mfma_f32_16x16x32_bf16 v[220:223], v[244:247], a[172:175], v[220:223]
    v_accvgpr_write_b32 a198, v134
    v_accvgpr_write_b32 a199, v135
    v_mfma_f32_16x16x32_bf16 v[224:227], v[244:247], a[176:179], v[224:227]
    v_perm_b32 v132, v121, v117, s40
    v_perm_b32 v133, v129, v125, s40
    v_mfma_f32_16x16x32_bf16 v[228:231], v[244:247], a[180:183], v[228:231]
    v_perm_b32 v134, v141, v137, s40
    v_perm_b32 v135, v157, v145, s40
    v_mfma_f32_16x16x32_bf16 v[232:235], v[244:247], a[184:187], v[232:235]
    v_accvgpr_write_b32 a200, v132
    v_accvgpr_write_b32 a201, v133
    v_mfma_f32_16x16x32_bf16 v[236:239], v[244:247], a[188:191], v[236:239]
    v_accvgpr_write_b32 a202, v134
    v_accvgpr_write_b32 a203, v135
    ds_read_b128 v[244:247], v4 offset:12800
    s_waitcnt lgkmcnt(3)
    v_mfma_f32_16x16x32_bf16 v[36:39], v[248:251], a[168:171], v[36:39]
    v_perm_b32 v132, v121, v117, s41
    v_perm_b32 v133, v129, v125, s41
    v_mfma_f32_16x16x32_bf16 v[40:43], v[248:251], a[172:175], v[40:43]
    v_perm_b32 v134, v141, v137, s41
    v_perm_b32 v135, v157, v145, s41
    v_mfma_f32_16x16x32_bf16 v[44:47], v[248:251], a[176:179], v[44:47]
    v_accvgpr_write_b32 a204, v132
    v_accvgpr_write_b32 a205, v133
    v_mfma_f32_16x16x32_bf16 v[48:51], v[248:251], a[180:183], v[48:51]
    v_accvgpr_write_b32 a206, v134
    v_accvgpr_write_b32 a207, v135
    v_mfma_f32_16x16x32_bf16 v[52:55], v[248:251], a[184:187], v[52:55]
    v_perm_b32 v132, v122, v118, s40
    v_perm_b32 v133, v130, v126, s40
    v_mfma_f32_16x16x32_bf16 v[56:59], v[248:251], a[188:191], v[56:59]
    v_perm_b32 v134, v142, v138, s40
    v_perm_b32 v135, v158, v146, s40
    ds_read_b128 v[248:251], v4 offset:25088
    s_waitcnt lgkmcnt(3)
    v_mfma_f32_16x16x32_bf16 v[60:63], v[252:255], a[168:171], v[60:63]
    v_accvgpr_write_b32 a208, v132
    v_accvgpr_write_b32 a209, v133
    v_mfma_f32_16x16x32_bf16 v[64:67], v[252:255], a[172:175], v[64:67]
    v_accvgpr_write_b32 a210, v134
    v_accvgpr_write_b32 a211, v135
    v_mfma_f32_16x16x32_bf16 v[68:71], v[252:255], a[176:179], v[68:71]
    v_perm_b32 v132, v122, v118, s41
    v_perm_b32 v133, v130, v126, s41
    v_mfma_f32_16x16x32_bf16 v[72:75], v[252:255], a[180:183], v[72:75]
    v_perm_b32 v134, v142, v138, s41
    v_perm_b32 v135, v158, v146, s41
    v_mfma_f32_16x16x32_bf16 v[76:79], v[252:255], a[184:187], v[76:79]
    v_accvgpr_write_b32 a212, v132
    v_accvgpr_write_b32 a213, v133
    v_mfma_f32_16x16x32_bf16 v[80:83], v[252:255], a[188:191], v[80:83]
    v_accvgpr_write_b32 a214, v134
    v_accvgpr_write_b32 a215, v135
    ds_read_b128 v[252:255], v4 offset:37376
    s_mov_b32 s39, 270336
    buffer_load_dwordx3 v[116:118], v10, s[16:19], s39 offen offset:0
    buffer_load_dwordx3 v[120:122], v10, s[16:19], s39 offen offset:768
    buffer_load_dwordx3 v[124:126], v10, s[16:19], s39 offen offset:1536
    buffer_load_dwordx3 v[128:130], v10, s[16:19], s39 offen offset:2304
    buffer_load_dwordx3 v[136:138], v11, s[16:19], s39 offen offset:0
    buffer_load_dwordx3 v[140:142], v11, s[16:19], s39 offen offset:768
    buffer_load_dwordx3 v[144:146], v11, s[16:19], s39 offen offset:1536
    buffer_load_dwordx3 v[156:158], v11, s[16:19], s39 offen offset:2304
    s_waitcnt vmcnt(16)
    s_waitcnt lgkmcnt(3)
    v_mfma_f32_16x16x32_bf16 v[192:195], v[240:243], a[192:195], v[192:195]
    v_perm_b32 v132, v164, v160, s40
    v_perm_b32 v133, v172, v168, s40
    v_mfma_f32_16x16x32_bf16 v[196:199], v[240:243], a[196:199], v[196:199]
    v_perm_b32 v134, v180, v176, s40
    v_perm_b32 v135, v188, v184, s40
    v_mfma_f32_16x16x32_bf16 v[200:203], v[240:243], a[200:203], v[200:203]
    v_accvgpr_write_b32 a216, v132
    v_accvgpr_write_b32 a217, v133
    v_mfma_f32_16x16x32_bf16 v[204:207], v[240:243], a[204:207], v[204:207]
    v_accvgpr_write_b32 a218, v134
    v_accvgpr_write_b32 a219, v135
    v_mfma_f32_16x16x32_bf16 v[208:211], v[240:243], a[208:211], v[208:211]
    v_perm_b32 v132, v164, v160, s41
    v_perm_b32 v133, v172, v168, s41
    v_mfma_f32_16x16x32_bf16 v[212:215], v[240:243], a[212:215], v[212:215]
    v_perm_b32 v134, v180, v176, s41
    v_perm_b32 v135, v188, v184, s41
    ds_read_b128 v[240:243], v5 offset:512
    s_waitcnt lgkmcnt(3)
    v_mfma_f32_16x16x32_bf16 v[216:219], v[244:247], a[192:195], v[216:219]
    v_accvgpr_write_b32 a220, v132
    v_accvgpr_write_b32 a221, v133
    v_mfma_f32_16x16x32_bf16 v[220:223], v[244:247], a[196:199], v[220:223]
    v_accvgpr_write_b32 a222, v134
    v_accvgpr_write_b32 a223, v135
    v_mfma_f32_16x16x32_bf16 v[224:227], v[244:247], a[200:203], v[224:227]
    v_perm_b32 v132, v165, v161, s40
    v_perm_b32 v133, v173, v169, s40
    v_mfma_f32_16x16x32_bf16 v[228:231], v[244:247], a[204:207], v[228:231]
    v_perm_b32 v134, v181, v177, s40
    v_perm_b32 v135, v189, v185, s40
    v_mfma_f32_16x16x32_bf16 v[232:235], v[244:247], a[208:211], v[232:235]
    v_accvgpr_write_b32 a224, v132
    v_accvgpr_write_b32 a225, v133
    v_mfma_f32_16x16x32_bf16 v[236:239], v[244:247], a[212:215], v[236:239]
    v_accvgpr_write_b32 a226, v134
    v_accvgpr_write_b32 a227, v135
    ds_read_b128 v[244:247], v5 offset:12800
    s_waitcnt lgkmcnt(3)
    v_mfma_f32_16x16x32_bf16 v[36:39], v[248:251], a[192:195], v[36:39]
    v_perm_b32 v132, v165, v161, s41
    v_perm_b32 v133, v173, v169, s41
    v_mfma_f32_16x16x32_bf16 v[40:43], v[248:251], a[196:199], v[40:43]
    v_perm_b32 v134, v181, v177, s41
    v_perm_b32 v135, v189, v185, s41
    v_mfma_f32_16x16x32_bf16 v[44:47], v[248:251], a[200:203], v[44:47]
    v_accvgpr_write_b32 a228, v132
    v_accvgpr_write_b32 a229, v133
    v_mfma_f32_16x16x32_bf16 v[48:51], v[248:251], a[204:207], v[48:51]
    v_accvgpr_write_b32 a230, v134
    v_accvgpr_write_b32 a231, v135
    v_mfma_f32_16x16x32_bf16 v[52:55], v[248:251], a[208:211], v[52:55]
    v_perm_b32 v132, v166, v162, s40
    v_perm_b32 v133, v174, v170, s40
    v_mfma_f32_16x16x32_bf16 v[56:59], v[248:251], a[212:215], v[56:59]
    v_perm_b32 v134, v182, v178, s40
    v_perm_b32 v135, v190, v186, s40
    ds_read_b128 v[248:251], v5 offset:25088
    s_waitcnt lgkmcnt(3)
    v_mfma_f32_16x16x32_bf16 v[60:63], v[252:255], a[192:195], v[60:63]
    v_accvgpr_write_b32 a232, v132
    v_accvgpr_write_b32 a233, v133
    v_mfma_f32_16x16x32_bf16 v[64:67], v[252:255], a[196:199], v[64:67]
    v_accvgpr_write_b32 a234, v134
    v_accvgpr_write_b32 a235, v135
    v_mfma_f32_16x16x32_bf16 v[68:71], v[252:255], a[200:203], v[68:71]
    v_perm_b32 v132, v166, v162, s41
    v_perm_b32 v133, v174, v170, s41
    v_mfma_f32_16x16x32_bf16 v[72:75], v[252:255], a[204:207], v[72:75]
    v_perm_b32 v134, v182, v178, s41
    v_perm_b32 v135, v190, v186, s41
    v_mfma_f32_16x16x32_bf16 v[76:79], v[252:255], a[208:211], v[76:79]
    v_accvgpr_write_b32 a236, v132
    v_accvgpr_write_b32 a237, v133
    v_mfma_f32_16x16x32_bf16 v[80:83], v[252:255], a[212:215], v[80:83]
    v_accvgpr_write_b32 a238, v134
    v_accvgpr_write_b32 a239, v135
    ds_read_b128 v[252:255], v5 offset:37376
    s_waitcnt vmcnt(8)
    s_waitcnt lgkmcnt(3)
    v_mfma_f32_16x16x32_bf16 v[192:195], v[240:243], a[216:219], v[192:195]
    v_perm_b32 v132, v88, v84, s40
    v_perm_b32 v133, v96, v92, s40
    v_mfma_f32_16x16x32_bf16 v[196:199], v[240:243], a[220:223], v[196:199]
    v_perm_b32 v134, v104, v100, s40
    v_perm_b32 v135, v112, v108, s40
    v_mfma_f32_16x16x32_bf16 v[200:203], v[240:243], a[224:227], v[200:203]
    v_accvgpr_write_b32 a240, v132
    v_accvgpr_write_b32 a241, v133
    v_mfma_f32_16x16x32_bf16 v[204:207], v[240:243], a[228:231], v[204:207]
    v_accvgpr_write_b32 a242, v134
    v_accvgpr_write_b32 a243, v135
    v_mfma_f32_16x16x32_bf16 v[208:211], v[240:243], a[232:235], v[208:211]
    v_perm_b32 v132, v88, v84, s41
    v_perm_b32 v133, v96, v92, s41
    v_mfma_f32_16x16x32_bf16 v[212:215], v[240:243], a[236:239], v[212:215]
    v_perm_b32 v134, v104, v100, s41
    v_perm_b32 v135, v112, v108, s41
    ds_read_b128 v[240:243], v6 offset:512
    s_waitcnt lgkmcnt(3)
    v_mfma_f32_16x16x32_bf16 v[216:219], v[244:247], a[216:219], v[216:219]
    v_accvgpr_write_b32 a244, v132
    v_accvgpr_write_b32 a245, v133
    v_mfma_f32_16x16x32_bf16 v[220:223], v[244:247], a[220:223], v[220:223]
    v_accvgpr_write_b32 a246, v134
    v_accvgpr_write_b32 a247, v135
    v_mfma_f32_16x16x32_bf16 v[224:227], v[244:247], a[224:227], v[224:227]
    v_perm_b32 v132, v89, v85, s40
    v_perm_b32 v133, v97, v93, s40
    v_mfma_f32_16x16x32_bf16 v[228:231], v[244:247], a[228:231], v[228:231]
    v_perm_b32 v134, v105, v101, s40
    v_perm_b32 v135, v113, v109, s40
    v_mfma_f32_16x16x32_bf16 v[232:235], v[244:247], a[232:235], v[232:235]
    v_accvgpr_write_b32 a248, v132
    v_accvgpr_write_b32 a249, v133
    v_mfma_f32_16x16x32_bf16 v[236:239], v[244:247], a[236:239], v[236:239]
    v_accvgpr_write_b32 a250, v134
    v_accvgpr_write_b32 a251, v135
    ds_read_b128 v[244:247], v6 offset:12800
    s_waitcnt lgkmcnt(3)
    v_mfma_f32_16x16x32_bf16 v[36:39], v[248:251], a[216:219], v[36:39]
    v_perm_b32 v132, v89, v85, s41
    v_perm_b32 v133, v97, v93, s41
    v_mfma_f32_16x16x32_bf16 v[40:43], v[248:251], a[220:223], v[40:43]
    v_perm_b32 v134, v105, v101, s41
    v_perm_b32 v135, v113, v109, s41
    v_mfma_f32_16x16x32_bf16 v[44:47], v[248:251], a[224:227], v[44:47]
    v_accvgpr_write_b32 a252, v132
    v_accvgpr_write_b32 a253, v133
    v_mfma_f32_16x16x32_bf16 v[48:51], v[248:251], a[228:231], v[48:51]
    v_accvgpr_write_b32 a254, v134
    v_accvgpr_write_b32 a255, v135
    v_mfma_f32_16x16x32_bf16 v[52:55], v[248:251], a[232:235], v[52:55]
    v_perm_b32 v160, v90, v86, s40
    v_perm_b32 v161, v98, v94, s40
    v_mfma_f32_16x16x32_bf16 v[56:59], v[248:251], a[236:239], v[56:59]
    v_perm_b32 v162, v106, v102, s40
    v_perm_b32 v163, v114, v110, s40
    ds_read_b128 v[248:251], v6 offset:25088
    s_waitcnt lgkmcnt(3)
    v_mfma_f32_16x16x32_bf16 v[60:63], v[252:255], a[216:219], v[60:63]
    v_perm_b32 v164, v90, v86, s41
    v_perm_b32 v165, v98, v94, s41
    v_mfma_f32_16x16x32_bf16 v[64:67], v[252:255], a[220:223], v[64:67]
    v_perm_b32 v166, v106, v102, s41
    v_perm_b32 v167, v114, v110, s41
    v_mfma_f32_16x16x32_bf16 v[68:71], v[252:255], a[224:227], v[68:71]
    v_mfma_f32_16x16x32_bf16 v[72:75], v[252:255], a[228:231], v[72:75]
    v_mfma_f32_16x16x32_bf16 v[76:79], v[252:255], a[232:235], v[76:79]
    v_mfma_f32_16x16x32_bf16 v[80:83], v[252:255], a[236:239], v[80:83]
    ds_read_b128 v[252:255], v6 offset:37376
    s_waitcnt vmcnt(0)
    s_waitcnt lgkmcnt(3)
    v_mfma_f32_16x16x32_bf16 v[192:195], v[240:243], a[240:243], v[192:195]
    v_perm_b32 v168, v120, v116, s40
    v_mfma_f32_16x16x32_bf16 v[196:199], v[240:243], a[244:247], v[196:199]
    v_perm_b32 v169, v128, v124, s40
    v_mfma_f32_16x16x32_bf16 v[200:203], v[240:243], a[248:251], v[200:203]
    v_perm_b32 v170, v140, v136, s40
    v_mfma_f32_16x16x32_bf16 v[204:207], v[240:243], a[252:255], v[204:207]
    v_perm_b32 v171, v156, v144, s40
    v_mfma_f32_16x16x32_bf16 v[208:211], v[240:243], v[160:163], v[208:211]
    v_perm_b32 v172, v120, v116, s41
    v_mfma_f32_16x16x32_bf16 v[212:215], v[240:243], v[164:167], v[212:215]
    v_perm_b32 v173, v128, v124, s41
    ds_read_b128 v[240:243], v7 offset:512
    s_waitcnt lgkmcnt(3)
    v_mfma_f32_16x16x32_bf16 v[216:219], v[244:247], a[240:243], v[216:219]
    v_perm_b32 v174, v140, v136, s41
    v_mfma_f32_16x16x32_bf16 v[220:223], v[244:247], a[244:247], v[220:223]
    v_perm_b32 v175, v156, v144, s41
    v_mfma_f32_16x16x32_bf16 v[224:227], v[244:247], a[248:251], v[224:227]
    v_perm_b32 v176, v121, v117, s40
    v_mfma_f32_16x16x32_bf16 v[228:231], v[244:247], a[252:255], v[228:231]
    v_perm_b32 v177, v129, v125, s40
    v_mfma_f32_16x16x32_bf16 v[232:235], v[244:247], v[160:163], v[232:235]
    v_perm_b32 v178, v141, v137, s40
    v_mfma_f32_16x16x32_bf16 v[236:239], v[244:247], v[164:167], v[236:239]
    v_perm_b32 v179, v157, v145, s40
    ds_read_b128 v[244:247], v7 offset:12800
    s_waitcnt lgkmcnt(3)
    v_mfma_f32_16x16x32_bf16 v[36:39], v[248:251], a[240:243], v[36:39]
    v_perm_b32 v180, v121, v117, s41
    v_mfma_f32_16x16x32_bf16 v[40:43], v[248:251], a[244:247], v[40:43]
    v_perm_b32 v181, v129, v125, s41
    v_mfma_f32_16x16x32_bf16 v[44:47], v[248:251], a[248:251], v[44:47]
    v_perm_b32 v182, v141, v137, s41
    v_mfma_f32_16x16x32_bf16 v[48:51], v[248:251], a[252:255], v[48:51]
    v_perm_b32 v183, v157, v145, s41
    v_mfma_f32_16x16x32_bf16 v[52:55], v[248:251], v[160:163], v[52:55]
    v_perm_b32 v184, v122, v118, s40
    v_mfma_f32_16x16x32_bf16 v[56:59], v[248:251], v[164:167], v[56:59]
    v_perm_b32 v185, v130, v126, s40
    ds_read_b128 v[248:251], v7 offset:25088
    s_waitcnt lgkmcnt(3)
    v_mfma_f32_16x16x32_bf16 v[60:63], v[252:255], a[240:243], v[60:63]
    v_perm_b32 v186, v142, v138, s40
    v_mfma_f32_16x16x32_bf16 v[64:67], v[252:255], a[244:247], v[64:67]
    v_perm_b32 v187, v158, v146, s40
    v_mfma_f32_16x16x32_bf16 v[68:71], v[252:255], a[248:251], v[68:71]
    v_perm_b32 v188, v122, v118, s41
    v_mfma_f32_16x16x32_bf16 v[72:75], v[252:255], a[252:255], v[72:75]
    v_perm_b32 v189, v130, v126, s41
    v_mfma_f32_16x16x32_bf16 v[76:79], v[252:255], v[160:163], v[76:79]
    v_perm_b32 v190, v142, v138, s41
    v_mfma_f32_16x16x32_bf16 v[80:83], v[252:255], v[164:167], v[80:83]
    v_perm_b32 v191, v158, v146, s41
    ds_read_b128 v[252:255], v7 offset:37376
    s_nop 1
    s_waitcnt lgkmcnt(3)
    v_mfma_f32_16x16x32_bf16 v[192:195], v[240:243], v[168:171], v[192:195]
    v_mfma_f32_16x16x32_bf16 v[196:199], v[240:243], v[172:175], v[196:199]
    v_mfma_f32_16x16x32_bf16 v[200:203], v[240:243], v[176:179], v[200:203]
    v_mfma_f32_16x16x32_bf16 v[204:207], v[240:243], v[180:183], v[204:207]
    v_mfma_f32_16x16x32_bf16 v[208:211], v[240:243], v[184:187], v[208:211]
    v_mfma_f32_16x16x32_bf16 v[212:215], v[240:243], v[188:191], v[212:215]
    s_waitcnt lgkmcnt(2)
    v_mfma_f32_16x16x32_bf16 v[216:219], v[244:247], v[168:171], v[216:219]
    v_mfma_f32_16x16x32_bf16 v[220:223], v[244:247], v[172:175], v[220:223]
    v_mfma_f32_16x16x32_bf16 v[224:227], v[244:247], v[176:179], v[224:227]
    v_mfma_f32_16x16x32_bf16 v[228:231], v[244:247], v[180:183], v[228:231]
    v_mfma_f32_16x16x32_bf16 v[232:235], v[244:247], v[184:187], v[232:235]
    v_mfma_f32_16x16x32_bf16 v[236:239], v[244:247], v[188:191], v[236:239]
    s_waitcnt lgkmcnt(1)
    v_mfma_f32_16x16x32_bf16 v[36:39], v[248:251], v[168:171], v[36:39]
    v_mfma_f32_16x16x32_bf16 v[40:43], v[248:251], v[172:175], v[40:43]
    v_mfma_f32_16x16x32_bf16 v[44:47], v[248:251], v[176:179], v[44:47]
    v_mfma_f32_16x16x32_bf16 v[48:51], v[248:251], v[180:183], v[48:51]
    v_mfma_f32_16x16x32_bf16 v[52:55], v[248:251], v[184:187], v[52:55]
    v_mfma_f32_16x16x32_bf16 v[56:59], v[248:251], v[188:191], v[56:59]
    s_waitcnt lgkmcnt(0)
    v_mfma_f32_16x16x32_bf16 v[60:63], v[252:255], v[168:171], v[60:63]
    v_mfma_f32_16x16x32_bf16 v[64:67], v[252:255], v[172:175], v[64:67]
    v_mfma_f32_16x16x32_bf16 v[68:71], v[252:255], v[176:179], v[68:71]
    v_mfma_f32_16x16x32_bf16 v[72:75], v[252:255], v[180:183], v[72:75]
    v_mfma_f32_16x16x32_bf16 v[76:79], v[252:255], v[184:187], v[76:79]
    v_mfma_f32_16x16x32_bf16 v[80:83], v[252:255], v[188:191], v[80:83]
    v_cvt_pk_bf16_f32 v132, v192, v196
    v_cvt_pk_bf16_f32 v133, v200, v204
    v_cvt_pk_bf16_f32 v134, v208, v212
    buffer_store_dwordx3 v[132:134], v9, s[20:23], s35 offen offset:0 sc1
    v_cvt_pk_bf16_f32 v136, v193, v197
    v_cvt_pk_bf16_f32 v137, v201, v205
    v_cvt_pk_bf16_f32 v138, v209, v213
    buffer_store_dwordx3 v[136:138], v9, s[20:23], s35 offen offset:768 sc1
    v_cvt_pk_bf16_f32 v140, v194, v198
    v_cvt_pk_bf16_f32 v141, v202, v206
    v_cvt_pk_bf16_f32 v142, v210, v214
    buffer_store_dwordx3 v[140:142], v9, s[20:23], s35 offen offset:1536 sc1
    v_cvt_pk_bf16_f32 v144, v195, v199
    v_cvt_pk_bf16_f32 v145, v203, v207
    v_cvt_pk_bf16_f32 v146, v211, v215
    buffer_store_dwordx3 v[144:146], v9, s[20:23], s35 offen offset:2304 sc1
    s_add_u32 s35, s35, s43
    v_cvt_pk_bf16_f32 v132, v216, v220
    v_cvt_pk_bf16_f32 v133, v224, v228
    v_cvt_pk_bf16_f32 v134, v232, v236
    buffer_store_dwordx3 v[132:134], v9, s[20:23], s35 offen offset:0 sc1
    v_cvt_pk_bf16_f32 v136, v217, v221
    v_cvt_pk_bf16_f32 v137, v225, v229
    v_cvt_pk_bf16_f32 v138, v233, v237
    buffer_store_dwordx3 v[136:138], v9, s[20:23], s35 offen offset:768 sc1
    v_cvt_pk_bf16_f32 v140, v218, v222
    v_cvt_pk_bf16_f32 v141, v226, v230
    v_cvt_pk_bf16_f32 v142, v234, v238
    buffer_store_dwordx3 v[140:142], v9, s[20:23], s35 offen offset:1536 sc1
    v_cvt_pk_bf16_f32 v144, v219, v223
    v_cvt_pk_bf16_f32 v145, v227, v231
    v_cvt_pk_bf16_f32 v146, v235, v239
    buffer_store_dwordx3 v[144:146], v9, s[20:23], s35 offen offset:2304 sc1
    s_add_u32 s35, s35, s43
    v_cvt_pk_bf16_f32 v132, v36, v40
    v_cvt_pk_bf16_f32 v133, v44, v48
    v_cvt_pk_bf16_f32 v134, v52, v56
    buffer_store_dwordx3 v[132:134], v9, s[20:23], s35 offen offset:0 sc1
    v_cvt_pk_bf16_f32 v136, v37, v41
    v_cvt_pk_bf16_f32 v137, v45, v49
    v_cvt_pk_bf16_f32 v138, v53, v57
    buffer_store_dwordx3 v[136:138], v9, s[20:23], s35 offen offset:768 sc1
    v_cvt_pk_bf16_f32 v140, v38, v42
    v_cvt_pk_bf16_f32 v141, v46, v50
    v_cvt_pk_bf16_f32 v142, v54, v58
    buffer_store_dwordx3 v[140:142], v9, s[20:23], s35 offen offset:1536 sc1
    v_cvt_pk_bf16_f32 v144, v39, v43
    v_cvt_pk_bf16_f32 v145, v47, v51
    v_cvt_pk_bf16_f32 v146, v55, v59
    buffer_store_dwordx3 v[144:146], v9, s[20:23], s35 offen offset:2304 sc1
    s_add_u32 s35, s35, s43
    v_add_u32 v4, 49152, v8
    s_mov_b32 s37, 61440
    s_mov_b32 s33, 4
    s_waitcnt vmcnt(63)
    s_mov_b32 s72, 0
L_pro_done:
    v_xor_b32 v5, 64, v4
    v_xor_b32 v6, 128, v4
    v_xor_b32 v7, 192, v4
    s_barrier
    ds_read_b128 v[84:87], v4 offset:0
    ds_read_b128 v[88:91], v5 offset:0
    ds_read_b128 v[92:95], v6 offset:0
    ds_read_b128 v[96:99], v7 offset:0
    ds_read_b128 v[100:103], v4 offset:256
    ds_read_b128 v[104:107], v5 offset:256
    ds_read_b128 v[108:111], v6 offset:256
    ds_read_b128 v[112:115], v7 offset:256
    s_mov_b32 s38, -1
    s_mov_b32 s66, 1
    s_mov_b32 s67, 256
    s_and_b32 s39, s2, 3
    s_lshl_b32 s98, 0x1040, s39
    s_or_b32 s62, s62, s98
    s_lshl_b32 s98, s98, 2
    s_mov_b32 s99, 0
    s_and_b32 s75, s75, 0xffff
    s_mov_b32 s44, 0
    s_mov_b32 s53, 0
    s_mov_b32 s51, 0
    s_mov_b32 s52, 0
    s_mov_b32 s54, s34
    s_cmp_eq_u32 s72, 0
    s_cbranch_scc1 L_disp
    s_cmp_eq_u32 s32, 0
    s_cbranch_scc1 L_early0
    s_cmp_eq_u32 s32, 1
    s_cbranch_scc1 L_early1
    s_cmp_eq_u32 s32, 2
    s_cbranch_scc1 L_early2
    s_cmp_eq_u32 s32, 3
    s_cbranch_scc1 L_early3
L_disp:
    s_cmp_eq_u32 s32, 1
    s_cbranch_scc1 L_loop1
    s_cmp_eq_u32 s32, 2
    s_cbranch_scc1 L_loop2
    s_cmp_eq_u32 s32, 3
    s_cbranch_scc1 L_loop3
    .p2align 6
L_loop0:
    s_waitcnt lgkmcnt(6)
    v_mfma_f32_16x16x32_bf16 v[36:39], v[84:87], a[0:3], v[12:15]
    s_add_u32 s55, s33, 63
    s_and_b32 s55, s55, 63
    v_mfma_f32_16x16x32_bf16 v[36:39], v[88:91], a[24:27], v[36:39]
    ds_read_b128 v[116:119], v4 offset:512
    v_mfma_f32_16x16x32_bf16 v[40:43], v[84:87], a[4:7], v[16:19]
    v_readlane_b32 s35, v148, s55
    v_mfma_f32_16x16x32_bf16 v[40:43], v[88:91], a[28:31], v[40:43]
    ds_read_b128 v[120:123], v5 offset:512
    v_mfma_f32_16x16x32_bf16 v[44:47], v[84:87], a[8:11], v[20:23]
    v_mfma_f32_16x16x32_bf16 v[44:47], v[88:91], a[32:35], v[44:47]
    ds_read_b128 v[124:127], v6 offset:512
    v_mfma_f32_16x16x32_bf16 v[48:51], v[84:87], a[12:15], v[24:27]
    v_mfma_f32_16x16x32_bf16 v[48:51], v[88:91], a[36:39], v[48:51]
    ds_read_b128 v[128:131], v7 offset:512
    v_mfma_f32_16x16x32_bf16 v[52:55], v[84:87], a[16:19], v[28:31]
    s_and_b32 m0, s46, 63
    s_and_b32 s39, s53, 12288
    v_mfma_f32_16x16x32_bf16 v[52:55], v[88:91], a[40:43], v[52:55]
    v_writelane_b32 v148, s54, m0
    v_mfma_f32_16x16x32_bf16 v[56:59], v[84:87], a[20:23], v[32:35]
    s_add_u32 s36, s36, s39
    v_mfma_f32_16x16x32_bf16 v[56:59], v[88:91], a[44:47], v[56:59]
    s_waitcnt lgkmcnt(8)
    v_mfma_f32_16x16x32_bf16 v[36:39], v[92:95], a[48:51], v[36:39]
    v_cvt_pk_bf16_f32 v132, v60, v64
    v_cvt_pk_bf16_f32 v133, v68, v72
    v_cvt_pk_bf16_f32 v134, v76, v80
    buffer_store_dwordx3 v[132:134], v9, s[20:23], s35 offen offset:0 sc1
    v_cvt_pk_bf16_f32 v136, v61, v65
    v_cvt_pk_bf16_f32 v137, v69, v73
    v_cvt_pk_bf16_f32 v138, v77, v81
    buffer_store_dwordx3 v[136:138], v9, s[20:23], s35 offen offset:768 sc1
    v_mfma_f32_16x16x32_bf16 v[36:39], v[96:99], a[72:75], v[36:39]
    s_cmp_eq_u32 s36, 159744
    v_mfma_f32_16x16x32_bf16 v[40:43], v[92:95], a[52:55], v[40:43]
    s_cselect_b32 s36, 0, s36
    v_mfma_f32_16x16x32_bf16 v[40:43], v[96:99], a[76:79], v[40:43]
    s_sub_u32 s46, s46, s53
    v_mfma_f32_16x16x32_bf16 v[44:47], v[92:95], a[56:59], v[44:47]
    s_and_b32 s39, s52, s43
    v_mfma_f32_16x16x32_bf16 v[44:47], v[96:99], a[80:83], v[44:47]
    s_add_u32 s34, s34, s39
    v_mfma_f32_16x16x32_bf16 v[48:51], v[92:95], a[60:63], v[48:51]
    s_min_u32 s49, s33, 63
    v_mfma_f32_16x16x32_bf16 v[48:51], v[96:99], a[84:87], v[48:51]
    s_bitcmp1_b64 s[58:59], s49
    v_mfma_f32_16x16x32_bf16 v[52:55], v[92:95], a[64:67], v[52:55]
    s_cselect_b32 s51, -1, 0
    v_mfma_f32_16x16x32_bf16 v[52:55], v[96:99], a[88:91], v[52:55]
    s_cselect_b32 s47, s48, s34
    v_mfma_f32_16x16x32_bf16 v[56:59], v[92:95], a[68:71], v[56:59]
    s_bitcmp1_b64 s[56:57], s49
    v_mfma_f32_16x16x32_bf16 v[56:59], v[96:99], a[92:95], v[56:59]
    s_waitcnt lgkmcnt(6)
    v_mfma_f32_16x16x32_bf16 v[36:39], v[100:103], a[96:99], v[36:39]
    v_cvt_pk_bf16_f32 v140, v62, v66
    v_cvt_pk_bf16_f32 v141, v70, v74
    v_cvt_pk_bf16_f32 v142, v78, v82
    buffer_store_dwordx3 v[140:142], v9, s[20:23], s35 offen offset:1536 sc1
    v_cvt_pk_bf16_f32 v144, v63, v67
    v_cvt_pk_bf16_f32 v145, v71, v75
    v_cvt_pk_bf16_f32 v146, v79, v83
    buffer_store_dwordx3 v[144:146], v9, s[20:23], s35 offen offset:2304 sc1
    v_mfma_f32_16x16x32_bf16 v[36:39], v[104:107], a[120:123], v[36:39]
    s_cselect_b32 s52, -1, 0
    v_mfma_f32_16x16x32_bf16 v[40:43], v[100:103], a[100:103], v[40:43]
    s_cmp_eq_u32 s38, -1
    v_mfma_f32_16x16x32_bf16 v[40:43], v[104:107], a[124:127], v[40:43]
    s_cselect_b32 s50, s51, 0
    v_mfma_f32_16x16x32_bf16 v[44:47], v[100:103], a[104:107], v[44:47]
    s_or_b32 s50, s50, s52
    v_mfma_f32_16x16x32_bf16 v[44:47], v[104:107], a[128:131], v[44:47]
    s_add_u32 m0, s36, s42
    v_mfma_f32_16x16x32_bf16 v[48:51], v[100:103], a[108:111], v[48:51]
    v_add_u32 v4, s37, v8
    v_mfma_f32_16x16x32_bf16 v[48:51], v[104:107], a[132:135], v[48:51]
    s_add_u32 s37, s37, 12288
    v_mfma_f32_16x16x32_bf16 v[52:55], v[100:103], a[112:115], v[52:55]
    v_xor_b32 v5, 64, v4
    v_mfma_f32_16x16x32_bf16 v[52:55], v[104:107], a[136:139], v[52:55]
    v_xor_b32 v6, 128, v4
    v_mfma_f32_16x16x32_bf16 v[56:59], v[100:103], a[116:119], v[56:59]
    v_xor_b32 v7, 192, v4
    v_mfma_f32_16x16x32_bf16 v[56:59], v[104:107], a[140:143], v[56:59]
    s_waitcnt lgkmcnt(4)
    v_mfma_f32_16x16x32_bf16 v[36:39], v[108:111], a[144:147], v[36:39]
    s_cmp_eq_u32 s37, 159744
    v_mfma_f32_16x16x32_bf16 v[36:39], v[112:115], a[168:171], v[36:39]
    s_cselect_b32 s37, 0, s37
    v_mfma_f32_16x16x32_bf16 v[40:43], v[108:111], a[148:151], v[40:43]
    s_bitcmp1_b64 s[98:99], s49
    v_mfma_f32_16x16x32_bf16 v[40:43], v[112:115], a[172:175], v[40:43]
    s_cbranch_scc1 L_ev0
L_evr0:
    v_mfma_f32_16x16x32_bf16 v[44:47], v[108:111], a[152:155], v[44:47]
    s_and_b32 s39, s50, s51
    v_mfma_f32_16x16x32_bf16 v[44:47], v[112:115], a[176:179], v[44:47]
    s_cbranch_scc1 L_k0
L_kr0:
    v_mfma_f32_16x16x32_bf16 v[48:51], v[108:111], a[156:159], v[48:51]
    s_bitcmp1_b64 s[62:63], s49
    v_mfma_f32_16x16x32_bf16 v[48:51], v[112:115], a[180:183], v[48:51]
    s_cselect_b32 s30, s67, 0
    v_mfma_f32_16x16x32_bf16 v[52:55], v[108:111], a[160:163], v[52:55]
    s_cmp_eq_u32 s38, -1
    v_mfma_f32_16x16x32_bf16 v[52:55], v[112:115], a[184:187], v[52:55]
    s_cselect_b32 s30, s30, 0
    v_mfma_f32_16x16x32_bf16 v[56:59], v[108:111], a[164:167], v[56:59]
    s_add_u32 s33, s33, 1
    v_mfma_f32_16x16x32_bf16 v[56:59], v[112:115], a[188:191], v[56:59]
    s_waitcnt vmcnt(12) lgkmcnt(0)
    s_barrier
    ds_read_b32 v154, v153 offset:0
    v_mfma_f32_16x16x32_bf16 v[36:39], v[116:119], a[192:195], v[36:39]
    v_mov_b32 v150, s66
    v_mfma_f32_16x16x32_bf16 v[36:39], v[120:123], a[216:219], v[36:39]
    buffer_atomic_add v150, v149, s[28:31], 0 offen sc0 sc1
    v_mfma_f32_16x16x32_bf16 v[40:43], v[116:119], a[196:199], v[40:43]
    ds_read_b128 v[84:87], v4 offset:0
    v_mfma_f32_16x16x32_bf16 v[40:43], v[120:123], a[220:223], v[40:43]
    ds_read_b128 v[88:91], v5 offset:0
    v_mfma_f32_16x16x32_bf16 v[44:47], v[116:119], a[200:203], v[44:47]
    ds_read_b128 v[92:95], v6 offset:0
    v_mfma_f32_16x16x32_bf16 v[44:47], v[120:123], a[224:227], v[44:47]
    s_waitcnt lgkmcnt(3)
    v_readfirstlane_b32 s44, v154
    v_mfma_f32_16x16x32_bf16 v[48:51], v[116:119], a[204:207], v[48:51]
    ds_read_b128 v[96:99], v7 offset:0
    v_mfma_f32_16x16x32_bf16 v[48:51], v[120:123], a[228:231], v[48:51]
    s_cmp_lt_u32 s44, 6291456
    s_cselect_b32 s53, s50, s52
    v_mfma_f32_16x16x32_bf16 v[52:55], v[116:119], a[208:211], v[52:55]
    s_and_b32 s54, s44, s51
    s_add_u32 s54, s54, s47
    v_mfma_f32_16x16x32_bf16 v[52:55], v[120:123], a[232:235], v[52:55]
    s_and_b32 s14, s53, 113246208
    v_mfma_f32_16x16x32_bf16 v[56:59], v[116:119], a[212:215], v[56:59]
    buffer_load_dwordx4 v1, s[12:15], s54 offen offset:0 nt lds
    v_mfma_f32_16x16x32_bf16 v[56:59], v[120:123], a[236:239], v[56:59]
    ds_read_b128 v[100:103], v4 offset:256
    v_mfma_f32_16x16x32_bf16 v[36:39], v[124:127], a[240:243], v[36:39]
    ds_read_b128 v[104:107], v5 offset:256
    v_mfma_f32_16x16x32_bf16 v[36:39], v[128:131], v[168:171], v[36:39]
    buffer_load_dwordx4 v2, s[12:15], s54 offen offset:1024 nt lds
    v_mfma_f32_16x16x32_bf16 v[40:43], v[124:127], a[244:247], v[40:43]
    ds_read_b128 v[108:111], v6 offset:256
    v_mfma_f32_16x16x32_bf16 v[40:43], v[128:131], v[172:175], v[40:43]
    ds_read_b128 v[112:115], v7 offset:256
    v_mfma_f32_16x16x32_bf16 v[44:47], v[124:127], a[248:251], v[44:47]
    buffer_load_dwordx4 v3, s[12:15], s54 offen offset:2048 nt lds
    v_mfma_f32_16x16x32_bf16 v[44:47], v[128:131], v[176:179], v[44:47]
    v_mfma_f32_16x16x32_bf16 v[48:51], v[124:127], a[252:255], v[48:51]
    s_andn2_b32 s39, s51, s53
    v_mfma_f32_16x16x32_bf16 v[48:51], v[128:131], v[180:183], v[48:51]
    s_cselect_b32 s39, s46, -1
    v_mfma_f32_16x16x32_bf16 v[52:55], v[124:127], v[160:163], v[52:55]
    s_min_u32 s38, s38, s39
    v_mfma_f32_16x16x32_bf16 v[52:55], v[128:131], v[184:187], v[52:55]
    s_add_u32 s39, s33, 2
    v_mfma_f32_16x16x32_bf16 v[56:59], v[124:127], v[164:167], v[56:59]
    s_cmp_ge_u32 s39, s38
    v_mfma_f32_16x16x32_bf16 v[56:59], v[128:131], v[188:191], v[56:59]
    s_cbranch_scc1 L_drain1
    s_waitcnt lgkmcnt(6)
    v_mfma_f32_16x16x32_bf16 v[60:63], v[84:87], a[0:3], v[12:15]
    s_add_u32 s55, s33, 63
    s_and_b32 s55, s55, 63
    v_mfma_f32_16x16x32_bf16 v[60:63], v[88:91], a[24:27], v[60:63]
    ds_read_b128 v[116:119], v4 offset:512
    v_mfma_f32_16x16x32_bf16 v[64:67], v[84:87], a[4:7], v[16:19]
    v_readlane_b32 s35, v148, s55
    v_mfma_f32_16x16x32_bf16 v[64:67], v[88:91], a[28:31], v[64:67]
    ds_read_b128 v[120:123], v5 offset:512
    v_mfma_f32_16x16x32_bf16 v[68:71], v[84:87], a[8:11], v[20:23]
    v_mfma_f32_16x16x32_bf16 v[68:71], v[88:91], a[32:35], v[68:71]
    ds_read_b128 v[124:127], v6 offset:512
    v_mfma_f32_16x16x32_bf16 v[72:75], v[84:87], a[12:15], v[24:27]
    v_mfma_f32_16x16x32_bf16 v[72:75], v[88:91], a[36:39], v[72:75]
    ds_read_b128 v[128:131], v7 offset:512
    v_mfma_f32_16x16x32_bf16 v[76:79], v[84:87], a[16:19], v[28:31]
    s_and_b32 m0, s46, 63
    s_and_b32 s39, s53, 12288
    v_mfma_f32_16x16x32_bf16 v[76:79], v[88:91], a[40:43], v[76:79]
    v_writelane_b32 v148, s54, m0
    v_mfma_f32_16x16x32_bf16 v[80:83], v[84:87], a[20:23], v[32:35]
    s_add_u32 s36, s36, s39
    v_mfma_f32_16x16x32_bf16 v[80:83], v[88:91], a[44:47], v[80:83]
    s_waitcnt lgkmcnt(8)
    v_mfma_f32_16x16x32_bf16 v[60:63], v[92:95], a[48:51], v[60:63]
    v_cvt_pk_bf16_f32 v132, v36, v40
    v_cvt_pk_bf16_f32 v133, v44, v48
    v_cvt_pk_bf16_f32 v134, v52, v56
    buffer_store_dwordx3 v[132:134], v9, s[20:23], s35 offen offset:0 sc1
    v_cvt_pk_bf16_f32 v136, v37, v41
    v_cvt_pk_bf16_f32 v137, v45, v49
    v_cvt_pk_bf16_f32 v138, v53, v57
    buffer_store_dwordx3 v[136:138], v9, s[20:23], s35 offen offset:768 sc1
    v_mfma_f32_16x16x32_bf16 v[60:63], v[96:99], a[72:75], v[60:63]
    s_cmp_eq_u32 s36, 159744
    v_mfma_f32_16x16x32_bf16 v[64:67], v[92:95], a[52:55], v[64:67]
    s_cselect_b32 s36, 0, s36
    v_mfma_f32_16x16x32_bf16 v[64:67], v[96:99], a[76:79], v[64:67]
    s_sub_u32 s46, s46, s53
    v_mfma_f32_16x16x32_bf16 v[68:71], v[92:95], a[56:59], v[68:71]
    s_and_b32 s39, s52, s43
    v_mfma_f32_16x16x32_bf16 v[68:71], v[96:99], a[80:83], v[68:71]
    s_add_u32 s34, s34, s39
    v_mfma_f32_16x16x32_bf16 v[72:75], v[92:95], a[60:63], v[72:75]
    s_min_u32 s49, s33, 63
    v_mfma_f32_16x16x32_bf16 v[72:75], v[96:99], a[84:87], v[72:75]
    s_bitcmp1_b64 s[58:59], s49
    v_mfma_f32_16x16x32_bf16 v[76:79], v[92:95], a[64:67], v[76:79]
    s_cselect_b32 s51, -1, 0
    v_mfma_f32_16x16x32_bf16 v[76:79], v[96:99], a[88:91], v[76:79]
    s_cselect_b32 s47, s48, s34
    v_mfma_f32_16x16x32_bf16 v[80:83], v[92:95], a[68:71], v[80:83]
    s_bitcmp1_b64 s[56:57], s49
    v_mfma_f32_16x16x32_bf16 v[80:83], v[96:99], a[92:95], v[80:83]
    s_waitcnt lgkmcnt(6)
    v_mfma_f32_16x16x32_bf16 v[60:63], v[100:103], a[96:99], v[60:63]
    v_cvt_pk_bf16_f32 v140, v38, v42
    v_cvt_pk_bf16_f32 v141, v46, v50
    v_cvt_pk_bf16_f32 v142, v54, v58
    buffer_store_dwordx3 v[140:142], v9, s[20:23], s35 offen offset:1536 sc1
    v_cvt_pk_bf16_f32 v144, v39, v43
    v_cvt_pk_bf16_f32 v145, v47, v51
    v_cvt_pk_bf16_f32 v146, v55, v59
    buffer_store_dwordx3 v[144:146], v9, s[20:23], s35 offen offset:2304 sc1
    v_mfma_f32_16x16x32_bf16 v[60:63], v[104:107], a[120:123], v[60:63]
    s_cselect_b32 s52, -1, 0
    v_mfma_f32_16x16x32_bf16 v[64:67], v[100:103], a[100:103], v[64:67]
    s_cmp_eq_u32 s38, -1
    v_mfma_f32_16x16x32_bf16 v[64:67], v[104:107], a[124:127], v[64:67]
    s_cselect_b32 s50, s51, 0
    v_mfma_f32_16x16x32_bf16 v[68:71], v[100:103], a[104:107], v[68:71]
    s_or_b32 s50, s50, s52
    v_mfma_f32_16x16x32_bf16 v[68:71], v[104:107], a[128:131], v[68:71]
    s_add_u32 m0, s36, s42
    v_mfma_f32_16x16x32_bf16 v[72:75], v[100:103], a[108:111], v[72:75]
    v_add_u32 v4, s37, v8
    v_mfma_f32_16x16x32_bf16 v[72:75], v[104:107], a[132:135], v[72:75]
    s_add_u32 s37, s37, 12288
    v_mfma_f32_16x16x32_bf16 v[76:79], v[100:103], a[112:115], v[76:79]
    v_xor_b32 v5, 64, v4
    v_mfma_f32_16x16x32_bf16 v[76:79], v[104:107], a[136:139], v[76:79]
    v_xor_b32 v6, 128, v4
    v_mfma_f32_16x16x32_bf16 v[80:83], v[100:103], a[116:119], v[80:83]
    v_xor_b32 v7, 192, v4
    v_mfma_f32_16x16x32_bf16 v[80:83], v[104:107], a[140:143], v[80:83]
    s_waitcnt lgkmcnt(4)
    v_mfma_f32_16x16x32_bf16 v[60:63], v[108:111], a[144:147], v[60:63]
    s_cmp_eq_u32 s37, 159744
    v_mfma_f32_16x16x32_bf16 v[60:63], v[112:115], a[168:171], v[60:63]
    s_cselect_b32 s37, 0, s37
    v_mfma_f32_16x16x32_bf16 v[64:67], v[108:111], a[148:151], v[64:67]
    s_bitcmp1_b64 s[98:99], s49
    v_mfma_f32_16x16x32_bf16 v[64:67], v[112:115], a[172:175], v[64:67]
    s_cbranch_scc1 L_ev1
L_evr1:
    v_mfma_f32_16x16x32_bf16 v[68:71], v[108:111], a[152:155], v[68:71]
    s_and_b32 s39, s50, s51
    v_mfma_f32_16x16x32_bf16 v[68:71], v[112:115], a[176:179], v[68:71]
    s_cbranch_scc1 L_k1
L_kr1:
    v_mfma_f32_16x16x32_bf16 v[72:75], v[108:111], a[156:159], v[72:75]
    s_bitcmp1_b64 s[62:63], s49
    v_mfma_f32_16x16x32_bf16 v[72:75], v[112:115], a[180:183], v[72:75]
    s_cselect_b32 s30, s67, 0
    v_mfma_f32_16x16x32_bf16 v[76:79], v[108:111], a[160:163], v[76:79]
    s_cmp_eq_u32 s38, -1
    v_mfma_f32_16x16x32_bf16 v[76:79], v[112:115], a[184:187], v[76:79]
    s_cselect_b32 s30, s30, 0
    v_mfma_f32_16x16x32_bf16 v[80:83], v[108:111], a[164:167], v[80:83]
    s_add_u32 s33, s33, 1
    v_mfma_f32_16x16x32_bf16 v[80:83], v[112:115], a[188:191], v[80:83]
    s_waitcnt vmcnt(12) lgkmcnt(0)
    s_barrier
    ds_read_b32 v154, v153 offset:256
    v_mfma_f32_16x16x32_bf16 v[60:63], v[116:119], a[192:195], v[60:63]
    v_mov_b32 v151, s66
    v_mfma_f32_16x16x32_bf16 v[60:63], v[120:123], a[216:219], v[60:63]
    buffer_atomic_add v151, v149, s[28:31], 0 offen sc0 sc1
    v_mfma_f32_16x16x32_bf16 v[64:67], v[116:119], a[196:199], v[64:67]
    ds_read_b128 v[84:87], v4 offset:0
    v_mfma_f32_16x16x32_bf16 v[64:67], v[120:123], a[220:223], v[64:67]
    ds_read_b128 v[88:91], v5 offset:0
    v_mfma_f32_16x16x32_bf16 v[68:71], v[116:119], a[200:203], v[68:71]
    ds_read_b128 v[92:95], v6 offset:0
    v_mfma_f32_16x16x32_bf16 v[68:71], v[120:123], a[224:227], v[68:71]
    s_waitcnt lgkmcnt(3)
    v_readfirstlane_b32 s44, v154
    v_mfma_f32_16x16x32_bf16 v[72:75], v[116:119], a[204:207], v[72:75]
    ds_read_b128 v[96:99], v7 offset:0
    v_mfma_f32_16x16x32_bf16 v[72:75], v[120:123], a[228:231], v[72:75]
    s_cmp_lt_u32 s44, 6291456
    s_cselect_b32 s53, s50, s52
    v_mfma_f32_16x16x32_bf16 v[76:79], v[116:119], a[208:211], v[76:79]
    s_and_b32 s54, s44, s51
    s_add_u32 s54, s54, s47
    v_mfma_f32_16x16x32_bf16 v[76:79], v[120:123], a[232:235], v[76:79]
    s_and_b32 s14, s53, 113246208
    v_mfma_f32_16x16x32_bf16 v[80:83], v[116:119], a[212:215], v[80:83]
    buffer_load_dwordx4 v1, s[12:15], s54 offen offset:0 nt lds
    v_mfma_f32_16x16x32_bf16 v[80:83], v[120:123], a[236:239], v[80:83]
    ds_read_b128 v[100:103], v4 offset:256
    v_mfma_f32_16x16x32_bf16 v[60:63], v[124:127], a[240:243], v[60:63]
    ds_read_b128 v[104:107], v5 offset:256
    v_mfma_f32_16x16x32_bf16 v[60:63], v[128:131], v[168:171], v[60:63]
    buffer_load_dwordx4 v2, s[12:15], s54 offen offset:1024 nt lds
    v_mfma_f32_16x16x32_bf16 v[64:67], v[124:127], a[244:247], v[64:67]
    ds_read_b128 v[108:111], v6 offset:256
    v_mfma_f32_16x16x32_bf16 v[64:67], v[128:131], v[172:175], v[64:67]
    ds_read_b128 v[112:115], v7 offset:256
    v_mfma_f32_16x16x32_bf16 v[68:71], v[124:127], a[248:251], v[68:71]
    buffer_load_dwordx4 v3, s[12:15], s54 offen offset:2048 nt lds
    v_mfma_f32_16x16x32_bf16 v[68:71], v[128:131], v[176:179], v[68:71]
    v_mfma_f32_16x16x32_bf16 v[72:75], v[124:127], a[252:255], v[72:75]
    s_andn2_b32 s39, s51, s53
    v_mfma_f32_16x16x32_bf16 v[72:75], v[128:131], v[180:183], v[72:75]
    s_cselect_b32 s39, s46, -1
    v_mfma_f32_16x16x32_bf16 v[76:79], v[124:127], v[160:163], v[76:79]
    s_min_u32 s38, s38, s39
    v_mfma_f32_16x16x32_bf16 v[76:79], v[128:131], v[184:187], v[76:79]
    s_add_u32 s39, s33, 2
    v_mfma_f32_16x16x32_bf16 v[80:83], v[124:127], v[164:167], v[80:83]
    s_cmp_ge_u32 s39, s38
    v_mfma_f32_16x16x32_bf16 v[80:83], v[128:131], v[188:191], v[80:83]
    s_cbranch_scc1 L_drain0
    s_branch L_loop0
    .p2align 6
L_loop1:
    s_waitcnt lgkmcnt(6)
    v_mfma_f32_16x16x32_bf16 v[36:39], v[84:87], a[0:3], v[12:15]
    s_add_u32 s55, s33, 63
    s_and_b32 s55, s55, 63
    v_mfma_f32_16x16x32_bf16 v[36:39], v[88:91], a[24:27], v[36:39]
    ds_read_b128 v[116:119], v4 offset:512
    v_mfma_f32_16x16x32_bf16 v[40:43], v[84:87], a[4:7], v[16:19]
    v_readlane_b32 s35, v148, s55
    v_mfma_f32_16x16x32_bf16 v[40:43], v[88:91], a[28:31], v[40:43]
    ds_read_b128 v[120:123], v5 offset:512
    v_mfma_f32_16x16x32_bf16 v[44:47], v[84:87], a[8:11], v[20:23]
    v_mfma_f32_16x16x32_bf16 v[44:47], v[88:91], a[32:35], v[44:47]
    ds_read_b128 v[124:127], v6 offset:512
    v_mfma_f32_16x16x32_bf16 v[48:51], v[84:87], a[12:15], v[24:27]
    v_mfma_f32_16x16x32_bf16 v[48:51], v[88:91], a[36:39], v[48:51]
    ds_read_b128 v[128:131], v7 offset:512
    v_mfma_f32_16x16x32_bf16 v[52:55], v[84:87], a[16:19], v[28:31]
    s_and_b32 m0, s46, 63
    v_mfma_f32_16x16x32_bf16 v[52:55], v[88:91], a[40:43], v[52:55]
    s_and_b32 s39, s53, 12288
    v_mfma_f32_16x16x32_bf16 v[56:59], v[84:87], a[20:23], v[32:35]
    v_writelane_b32 v148, s54, m0
    v_mfma_f32_16x16x32_bf16 v[56:59], v[88:91], a[44:47], v[56:59]
    s_waitcnt lgkmcnt(8)
    v_mfma_f32_16x16x32_bf16 v[36:39], v[92:95], a[48:51], v[36:39]
    s_add_u32 s36, s36, s39
    v_mfma_f32_16x16x32_bf16 v[36:39], v[96:99], a[72:75], v[36:39]
    v_mfma_f32_16x16x32_bf16 v[40:43], v[92:95], a[52:55], v[40:43]
    s_cmp_eq_u32 s36, 159744
    v_mfma_f32_16x16x32_bf16 v[40:43], v[96:99], a[76:79], v[40:43]
    v_cvt_pk_bf16_f32 v132, v60, v64
    v_cvt_pk_bf16_f32 v133, v68, v72
    v_cvt_pk_bf16_f32 v134, v76, v80
    buffer_store_dwordx3 v[132:134], v9, s[20:23], s35 offen offset:0 sc1
    v_cvt_pk_bf16_f32 v136, v61, v65
    v_cvt_pk_bf16_f32 v137, v69, v73
    v_cvt_pk_bf16_f32 v138, v77, v81
    buffer_store_dwordx3 v[136:138], v9, s[20:23], s35 offen offset:768 sc1
    v_mfma_f32_16x16x32_bf16 v[44:47], v[92:95], a[56:59], v[44:47]
    s_cselect_b32 s36, 0, s36
    v_mfma_f32_16x16x32_bf16 v[44:47], v[96:99], a[80:83], v[44:47]
    s_sub_u32 s46, s46, s53
    v_mfma_f32_16x16x32_bf16 v[48:51], v[92:95], a[60:63], v[48:51]
    s_and_b32 s39, s52, s43
    v_mfma_f32_16x16x32_bf16 v[48:51], v[96:99], a[84:87], v[48:51]
    v_mfma_f32_16x16x32_bf16 v[52:55], v[92:95], a[64:67], v[52:55]
    s_add_u32 s34, s34, s39
    v_mfma_f32_16x16x32_bf16 v[52:55], v[96:99], a[88:91], v[52:55]
    s_min_u32 s49, s33, 63
    v_mfma_f32_16x16x32_bf16 v[56:59], v[92:95], a[68:71], v[56:59]
    s_bitcmp1_b64 s[58:59], s49
    v_mfma_f32_16x16x32_bf16 v[56:59], v[96:99], a[92:95], v[56:59]
    s_waitcnt lgkmcnt(6)
    v_mfma_f32_16x16x32_bf16 v[36:39], v[100:103], a[96:99], v[36:39]
    s_cselect_b32 s51, -1, 0
    v_mfma_f32_16x16x32_bf16 v[36:39], v[104:107], a[120:123], v[36:39]
    v_mfma_f32_16x16x32_bf16 v[40:43], v[100:103], a[100:103], v[40:43]
    s_cselect_b32 s47, s48, s34
    v_mfma_f32_16x16x32_bf16 v[40:43], v[104:107], a[124:127], v[40:43]
    v_cvt_pk_bf16_f32 v140, v62, v66
    v_cvt_pk_bf16_f32 v141, v70, v74
    v_cvt_pk_bf16_f32 v142, v78, v82
    buffer_store_dwordx3 v[140:142], v9, s[20:23], s35 offen offset:1536 sc1
    v_cvt_pk_bf16_f32 v144, v63, v67
    v_cvt_pk_bf16_f32 v145, v71, v75
    v_cvt_pk_bf16_f32 v146, v79, v83
    buffer_store_dwordx3 v[144:146], v9, s[20:23], s35 offen offset:2304 sc1
    v_mfma_f32_16x16x32_bf16 v[44:47], v[100:103], a[104:107], v[44:47]
    s_bitcmp1_b64 s[56:57], s49
    v_mfma_f32_16x16x32_bf16 v[44:47], v[104:107], a[128:131], v[44:47]
    s_cselect_b32 s52, -1, 0
    v_mfma_f32_16x16x32_bf16 v[48:51], v[100:103], a[108:111], v[48:51]
    v_mfma_f32_16x16x32_bf16 v[48:51], v[104:107], a[132:135], v[48:51]
    s_cmp_eq_u32 s38, -1
    v_mfma_f32_16x16x32_bf16 v[52:55], v[100:103], a[112:115], v[52:55]
    s_cselect_b32 s50, s51, 0
    v_mfma_f32_16x16x32_bf16 v[52:55], v[104:107], a[136:139], v[52:55]
    s_or_b32 s50, s50, s52
    v_mfma_f32_16x16x32_bf16 v[56:59], v[100:103], a[116:119], v[56:59]
    s_add_u32 m0, s36, s42
    v_mfma_f32_16x16x32_bf16 v[56:59], v[104:107], a[140:143], v[56:59]
    s_waitcnt lgkmcnt(4)
    v_mfma_f32_16x16x32_bf16 v[36:39], v[108:111], a[144:147], v[36:39]
    v_mfma_f32_16x16x32_bf16 v[36:39], v[112:115], a[168:171], v[36:39]
    v_add_u32 v4, s37, v8
    v_mfma_f32_16x16x32_bf16 v[40:43], v[108:111], a[148:151], v[40:43]
    s_add_u32 s37, s37, 12288
    v_mfma_f32_16x16x32_bf16 v[40:43], v[112:115], a[172:175], v[40:43]
    v_xor_b32 v5, 64, v4
    v_mfma_f32_16x16x32_bf16 v[44:47], v[108:111], a[152:155], v[44:47]
    v_xor_b32 v6, 128, v4
    v_mfma_f32_16x16x32_bf16 v[44:47], v[112:115], a[176:179], v[44:47]
    v_mfma_f32_16x16x32_bf16 v[48:51], v[108:111], a[156:159], v[48:51]
    v_xor_b32 v7, 192, v4
    v_mfma_f32_16x16x32_bf16 v[48:51], v[112:115], a[180:183], v[48:51]
    s_cmp_eq_u32 s37, 159744
    v_mfma_f32_16x16x32_bf16 v[52:55], v[108:111], a[160:163], v[52:55]
    s_cselect_b32 s37, 0, s37
    v_mfma_f32_16x16x32_bf16 v[52:55], v[112:115], a[184:187], v[52:55]
    v_mfma_f32_16x16x32_bf16 v[56:59], v[108:111], a[164:167], v[56:59]
    s_add_u32 s33, s33, 1
    v_mfma_f32_16x16x32_bf16 v[56:59], v[112:115], a[188:191], v[56:59]
    s_waitcnt vmcnt(11) lgkmcnt(0)
    s_barrier
    ds_read_b32 v154, v153 offset:0
    v_mfma_f32_16x16x32_bf16 v[36:39], v[116:119], a[192:195], v[36:39]
    ds_read_b128 v[84:87], v4 offset:0
    v_mfma_f32_16x16x32_bf16 v[36:39], v[120:123], a[216:219], v[36:39]
    ds_read_b128 v[88:91], v5 offset:0
    v_mfma_f32_16x16x32_bf16 v[40:43], v[116:119], a[196:199], v[40:43]
    ds_read_b128 v[92:95], v6 offset:0
    v_mfma_f32_16x16x32_bf16 v[40:43], v[120:123], a[220:223], v[40:43]
    ds_read_b128 v[96:99], v7 offset:0
    v_mfma_f32_16x16x32_bf16 v[44:47], v[116:119], a[200:203], v[44:47]
    ds_read_b128 v[100:103], v4 offset:256
    v_mfma_f32_16x16x32_bf16 v[44:47], v[120:123], a[224:227], v[44:47]
    s_waitcnt lgkmcnt(5)
    v_readfirstlane_b32 s44, v154
    v_mfma_f32_16x16x32_bf16 v[48:51], v[116:119], a[204:207], v[48:51]
    ds_read_b128 v[104:107], v5 offset:256
    v_mfma_f32_16x16x32_bf16 v[48:51], v[120:123], a[228:231], v[48:51]
    s_cmp_lt_u32 s44, 6291456
    s_cselect_b32 s53, s50, s52
    v_mfma_f32_16x16x32_bf16 v[52:55], v[116:119], a[208:211], v[52:55]
    s_and_b32 s54, s44, s51
    s_add_u32 s54, s54, s47
    v_mfma_f32_16x16x32_bf16 v[52:55], v[120:123], a[232:235], v[52:55]
    s_and_b32 s14, s53, 113246208
    v_mfma_f32_16x16x32_bf16 v[56:59], v[116:119], a[212:215], v[56:59]
    ds_read_b128 v[108:111], v6 offset:256
    v_mfma_f32_16x16x32_bf16 v[56:59], v[120:123], a[236:239], v[56:59]
    buffer_load_dwordx4 v1, s[12:15], s54 offen offset:0 nt lds
    v_mfma_f32_16x16x32_bf16 v[36:39], v[124:127], a[240:243], v[36:39]
    ds_read_b128 v[112:115], v7 offset:256
    v_mfma_f32_16x16x32_bf16 v[36:39], v[128:131], v[168:171], v[36:39]
    v_mfma_f32_16x16x32_bf16 v[40:43], v[124:127], a[244:247], v[40:43]
    buffer_load_dwordx4 v2, s[12:15], s54 offen offset:1024 nt lds
    v_mfma_f32_16x16x32_bf16 v[40:43], v[128:131], v[172:175], v[40:43]
    v_mfma_f32_16x16x32_bf16 v[44:47], v[124:127], a[248:251], v[44:47]
    v_mfma_f32_16x16x32_bf16 v[44:47], v[128:131], v[176:179], v[44:47]
    buffer_load_dwordx4 v3, s[12:15], s54 offen offset:2048 nt lds
    v_mfma_f32_16x16x32_bf16 v[48:51], v[124:127], a[252:255], v[48:51]
    s_andn2_b32 s39, s51, s53
    v_mfma_f32_16x16x32_bf16 v[48:51], v[128:131], v[180:183], v[48:51]
    s_cselect_b32 s39, s46, -1
    v_mfma_f32_16x16x32_bf16 v[52:55], v[124:127], v[160:163], v[52:55]
    s_min_u32 s38, s38, s39
    v_mfma_f32_16x16x32_bf16 v[52:55], v[128:131], v[184:187], v[52:55]
    s_add_u32 s39, s33, 2
    v_mfma_f32_16x16x32_bf16 v[56:59], v[124:127], v[164:167], v[56:59]
    s_cmp_ge_u32 s39, s38
    v_mfma_f32_16x16x32_bf16 v[56:59], v[128:131], v[188:191], v[56:59]
    s_cbranch_scc1 L_drain1
    s_waitcnt lgkmcnt(6)
    v_mfma_f32_16x16x32_bf16 v[60:63], v[84:87], a[0:3], v[12:15]
    s_add_u32 s55, s33, 63
    s_and_b32 s55, s55, 63
    v_mfma_f32_16x16x32_bf16 v[60:63], v[88:91], a[24:27], v[60:63]
    ds_read_b128 v[116:119], v4 offset:512
    v_mfma_f32_16x16x32_bf16 v[64:67], v[84:87], a[4:7], v[16:19]
    v_readlane_b32 s35, v148, s55
    v_mfma_f32_16x16x32_bf16 v[64:67], v[88:91], a[28:31], v[64:67]
    ds_read_b128 v[120:123], v5 offset:512
    v_mfma_f32_16x16x32_bf16 v[68:71], v[84:87], a[8:11], v[20:23]
    v_mfma_f32_16x16x32_bf16 v[68:71], v[88:91], a[32:35], v[68:71]
    ds_read_b128 v[124:127], v6 offset:512
    v_mfma_f32_16x16x32_bf16 v[72:75], v[84:87], a[12:15], v[24:27]
    v_mfma_f32_16x16x32_bf16 v[72:75], v[88:91], a[36:39], v[72:75]
    ds_read_b128 v[128:131], v7 offset:512
    v_mfma_f32_16x16x32_bf16 v[76:79], v[84:87], a[16:19], v[28:31]
    s_and_b32 m0, s46, 63
    v_mfma_f32_16x16x32_bf16 v[76:79], v[88:91], a[40:43], v[76:79]
    s_and_b32 s39, s53, 12288
    v_mfma_f32_16x16x32_bf16 v[80:83], v[84:87], a[20:23], v[32:35]
    v_writelane_b32 v148, s54, m0
    v_mfma_f32_16x16x32_bf16 v[80:83], v[88:91], a[44:47], v[80:83]
    s_waitcnt lgkmcnt(8)
    v_mfma_f32_16x16x32_bf16 v[60:63], v[92:95], a[48:51], v[60:63]
    s_add_u32 s36, s36, s39
    v_mfma_f32_16x16x32_bf16 v[60:63], v[96:99], a[72:75], v[60:63]
    v_mfma_f32_16x16x32_bf16 v[64:67], v[92:95], a[52:55], v[64:67]
    s_cmp_eq_u32 s36, 159744
    v_mfma_f32_16x16x32_bf16 v[64:67], v[96:99], a[76:79], v[64:67]
    v_cvt_pk_bf16_f32 v132, v36, v40
    v_cvt_pk_bf16_f32 v133, v44, v48
    v_cvt_pk_bf16_f32 v134, v52, v56
    buffer_store_dwordx3 v[132:134], v9, s[20:23], s35 offen offset:0 sc1
    v_cvt_pk_bf16_f32 v136, v37, v41
    v_cvt_pk_bf16_f32 v137, v45, v49
    v_cvt_pk_bf16_f32 v138, v53, v57
    buffer_store_dwordx3 v[136:138], v9, s[20:23], s35 offen offset:768 sc1
    v_mfma_f32_16x16x32_bf16 v[68:71], v[92:95], a[56:59], v[68:71]
    s_cselect_b32 s36, 0, s36
    v_mfma_f32_16x16x32_bf16 v[68:71], v[96:99], a[80:83], v[68:71]
    s_sub_u32 s46, s46, s53
    v_mfma_f32_16x16x32_bf16 v[72:75], v[92:95], a[60:63], v[72:75]
    s_and_b32 s39, s52, s43
    v_mfma_f32_16x16x32_bf16 v[72:75], v[96:99], a[84:87], v[72:75]
    v_mfma_f32_16x16x32_bf16 v[76:79], v[92:95], a[64:67], v[76:79]
    s_add_u32 s34, s34, s39
    v_mfma_f32_16x16x32_bf16 v[76:79], v[96:99], a[88:91], v[76:79]
    s_min_u32 s49, s33, 63
    v_mfma_f32_16x16x32_bf16 v[80:83], v[92:95], a[68:71], v[80:83]
    s_bitcmp1_b64 s[58:59], s49
    v_mfma_f32_16x16x32_bf16 v[80:83], v[96:99], a[92:95], v[80:83]
    s_waitcnt lgkmcnt(6)
    v_mfma_f32_16x16x32_bf16 v[60:63], v[100:103], a[96:99], v[60:63]
    s_cselect_b32 s51, -1, 0
    v_mfma_f32_16x16x32_bf16 v[60:63], v[104:107], a[120:123], v[60:63]
    v_mfma_f32_16x16x32_bf16 v[64:67], v[100:103], a[100:103], v[64:67]
    s_cselect_b32 s47, s48, s34
    v_mfma_f32_16x16x32_bf16 v[64:67], v[104:107], a[124:127], v[64:67]
    v_cvt_pk_bf16_f32 v140, v38, v42
    v_cvt_pk_bf16_f32 v141, v46, v50
    v_cvt_pk_bf16_f32 v142, v54, v58
    buffer_store_dwordx3 v[140:142], v9, s[20:23], s35 offen offset:1536 sc1
    v_cvt_pk_bf16_f32 v144, v39, v43
    v_cvt_pk_bf16_f32 v145, v47, v51
    v_cvt_pk_bf16_f32 v146, v55, v59
    buffer_store_dwordx3 v[144:146], v9, s[20:23], s35 offen offset:2304 sc1
    v_mfma_f32_16x16x32_bf16 v[68:71], v[100:103], a[104:107], v[68:71]
    s_bitcmp1_b64 s[56:57], s49
    v_mfma_f32_16x16x32_bf16 v[68:71], v[104:107], a[128:131], v[68:71]
    s_cselect_b32 s52, -1, 0
    v_mfma_f32_16x16x32_bf16 v[72:75], v[100:103], a[108:111], v[72:75]
    v_mfma_f32_16x16x32_bf16 v[72:75], v[104:107], a[132:135], v[72:75]
    s_cmp_eq_u32 s38, -1
    v_mfma_f32_16x16x32_bf16 v[76:79], v[100:103], a[112:115], v[76:79]
    s_cselect_b32 s50, s51, 0
    v_mfma_f32_16x16x32_bf16 v[76:79], v[104:107], a[136:139], v[76:79]
    s_or_b32 s50, s50, s52
    v_mfma_f32_16x16x32_bf16 v[80:83], v[100:103], a[116:119], v[80:83]
    s_add_u32 m0, s36, s42
    v_mfma_f32_16x16x32_bf16 v[80:83], v[104:107], a[140:143], v[80:83]
    s_waitcnt lgkmcnt(4)
    v_mfma_f32_16x16x32_bf16 v[60:63], v[108:111], a[144:147], v[60:63]
    v_mfma_f32_16x16x32_bf16 v[60:63], v[112:115], a[168:171], v[60:63]
    v_add_u32 v4, s37, v8
    v_mfma_f32_16x16x32_bf16 v[64:67], v[108:111], a[148:151], v[64:67]
    s_add_u32 s37, s37, 12288
    v_mfma_f32_16x16x32_bf16 v[64:67], v[112:115], a[172:175], v[64:67]
    v_xor_b32 v5, 64, v4
    v_mfma_f32_16x16x32_bf16 v[68:71], v[108:111], a[152:155], v[68:71]
    v_xor_b32 v6, 128, v4
    v_mfma_f32_16x16x32_bf16 v[68:71], v[112:115], a[176:179], v[68:71]
    v_mfma_f32_16x16x32_bf16 v[72:75], v[108:111], a[156:159], v[72:75]
    v_xor_b32 v7, 192, v4
    v_mfma_f32_16x16x32_bf16 v[72:75], v[112:115], a[180:183], v[72:75]
    s_cmp_eq_u32 s37, 159744
    v_mfma_f32_16x16x32_bf16 v[76:79], v[108:111], a[160:163], v[76:79]
    s_cselect_b32 s37, 0, s37
    v_mfma_f32_16x16x32_bf16 v[76:79], v[112:115], a[184:187], v[76:79]
    v_mfma_f32_16x16x32_bf16 v[80:83], v[108:111], a[164:167], v[80:83]
    s_add_u32 s33, s33, 1
    v_mfma_f32_16x16x32_bf16 v[80:83], v[112:115], a[188:191], v[80:83]
    s_waitcnt vmcnt(11) lgkmcnt(0)
    s_barrier
    ds_read_b32 v154, v153 offset:256
    v_mfma_f32_16x16x32_bf16 v[60:63], v[116:119], a[192:195], v[60:63]
    ds_read_b128 v[84:87], v4 offset:0
    v_mfma_f32_16x16x32_bf16 v[60:63], v[120:123], a[216:219], v[60:63]
    ds_read_b128 v[88:91], v5 offset:0
    v_mfma_f32_16x16x32_bf16 v[64:67], v[116:119], a[196:199], v[64:67]
    ds_read_b128 v[92:95], v6 offset:0
    v_mfma_f32_16x16x32_bf16 v[64:67], v[120:123], a[220:223], v[64:67]
    ds_read_b128 v[96:99], v7 offset:0
    v_mfma_f32_16x16x32_bf16 v[68:71], v[116:119], a[200:203], v[68:71]
    ds_read_b128 v[100:103], v4 offset:256
    v_mfma_f32_16x16x32_bf16 v[68:71], v[120:123], a[224:227], v[68:71]
    s_waitcnt lgkmcnt(5)
    v_readfirstlane_b32 s44, v154
    v_mfma_f32_16x16x32_bf16 v[72:75], v[116:119], a[204:207], v[72:75]
    ds_read_b128 v[104:107], v5 offset:256
    v_mfma_f32_16x16x32_bf16 v[72:75], v[120:123], a[228:231], v[72:75]
    s_cmp_lt_u32 s44, 6291456
    s_cselect_b32 s53, s50, s52
    v_mfma_f32_16x16x32_bf16 v[76:79], v[116:119], a[208:211], v[76:79]
    s_and_b32 s54, s44, s51
    s_add_u32 s54, s54, s47
    v_mfma_f32_16x16x32_bf16 v[76:79], v[120:123], a[232:235], v[76:79]
    s_and_b32 s14, s53, 113246208
    v_mfma_f32_16x16x32_bf16 v[80:83], v[116:119], a[212:215], v[80:83]
    ds_read_b128 v[108:111], v6 offset:256
    v_mfma_f32_16x16x32_bf16 v[80:83], v[120:123], a[236:239], v[80:83]
    buffer_load_dwordx4 v1, s[12:15], s54 offen offset:0 nt lds
    v_mfma_f32_16x16x32_bf16 v[60:63], v[124:127], a[240:243], v[60:63]
    ds_read_b128 v[112:115], v7 offset:256
    v_mfma_f32_16x16x32_bf16 v[60:63], v[128:131], v[168:171], v[60:63]
    v_mfma_f32_16x16x32_bf16 v[64:67], v[124:127], a[244:247], v[64:67]
    buffer_load_dwordx4 v2, s[12:15], s54 offen offset:1024 nt lds
    v_mfma_f32_16x16x32_bf16 v[64:67], v[128:131], v[172:175], v[64:67]
    v_mfma_f32_16x16x32_bf16 v[68:71], v[124:127], a[248:251], v[68:71]
    v_mfma_f32_16x16x32_bf16 v[68:71], v[128:131], v[176:179], v[68:71]
    buffer_load_dwordx4 v3, s[12:15], s54 offen offset:2048 nt lds
    v_mfma_f32_16x16x32_bf16 v[72:75], v[124:127], a[252:255], v[72:75]
    s_andn2_b32 s39, s51, s53
    v_mfma_f32_16x16x32_bf16 v[72:75], v[128:131], v[180:183], v[72:75]
    s_cselect_b32 s39, s46, -1
    v_mfma_f32_16x16x32_bf16 v[76:79], v[124:127], v[160:163], v[76:79]
    s_min_u32 s38, s38, s39
    v_mfma_f32_16x16x32_bf16 v[76:79], v[128:131], v[184:187], v[76:79]
    s_add_u32 s39, s33, 2
    v_mfma_f32_16x16x32_bf16 v[80:83], v[124:127], v[164:167], v[80:83]
    s_cmp_ge_u32 s39, s38
    v_mfma_f32_16x16x32_bf16 v[80:83], v[128:131], v[188:191], v[80:83]
    s_cbranch_scc1 L_drain0
    s_branch L_loop1
    .p2align 6
L_loop2:
    s_waitcnt lgkmcnt(6)
    v_mfma_f32_16x16x32_bf16 v[36:39], v[84:87], a[0:3], v[12:15]
    s_add_u32 s55, s33, 63
    s_and_b32 s55, s55, 63
    v_mfma_f32_16x16x32_bf16 v[36:39], v[88:91], a[24:27], v[36:39]
    ds_read_b128 v[116:119], v4 offset:512
    v_mfma_f32_16x16x32_bf16 v[40:43], v[84:87], a[4:7], v[16:19]
    v_readlane_b32 s35, v148, s55
    v_mfma_f32_16x16x32_bf16 v[40:43], v[88:91], a[28:31], v[40:43]
    ds_read_b128 v[120:123], v5 offset:512
    v_mfma_f32_16x16x32_bf16 v[44:47], v[84:87], a[8:11], v[20:23]
    v_mfma_f32_16x16x32_bf16 v[44:47], v[88:91], a[32:35], v[44:47]
    ds_read_b128 v[124:127], v6 offset:512
    v_mfma_f32_16x16x32_bf16 v[48:51], v[84:87], a[12:15], v[24:27]
    v_mfma_f32_16x16x32_bf16 v[48:51], v[88:91], a[36:39], v[48:51]
    ds_read_b128 v[128:131], v7 offset:512
    v_mfma_f32_16x16x32_bf16 v[52:55], v[84:87], a[16:19], v[28:31]
    s_and_b32 m0, s46, 63
    v_mfma_f32_16x16x32_bf16 v[52:55], v[88:91], a[40:43], v[52:55]
    s_and_b32 s39, s53, 12288
    v_mfma_f32_16x16x32_bf16 v[56:59], v[84:87], a[20:23], v[32:35]
    v_writelane_b32 v148, s54, m0
    v_mfma_f32_16x16x32_bf16 v[56:59], v[88:91], a[44:47], v[56:59]
    s_waitcnt lgkmcnt(8)
    v_mfma_f32_16x16x32_bf16 v[36:39], v[92:95], a[48:51], v[36:39]
    s_add_u32 s36, s36, s39
    v_mfma_f32_16x16x32_bf16 v[36:39], v[96:99], a[72:75], v[36:39]
    v_mfma_f32_16x16x32_bf16 v[40:43], v[92:95], a[52:55], v[40:43]
    s_cmp_eq_u32 s36, 159744
    v_mfma_f32_16x16x32_bf16 v[40:43], v[96:99], a[76:79], v[40:43]
    s_cselect_b32 s36, 0, s36
    v_mfma_f32_16x16x32_bf16 v[44:47], v[92:95], a[56:59], v[44:47]
    s_sub_u32 s46, s46, s53
    v_mfma_f32_16x16x32_bf16 v[44:47], v[96:99], a[80:83], v[44:47]
    s_and_b32 s39, s52, s43
    v_mfma_f32_16x16x32_bf16 v[48:51], v[92:95], a[60:63], v[48:51]
    v_cvt_pk_bf16_f32 v132, v60, v64
    v_cvt_pk_bf16_f32 v133, v68, v72
    v_cvt_pk_bf16_f32 v134, v76, v80
    buffer_store_dwordx3 v[132:134], v9, s[20:23], s35 offen offset:0 sc1
    v_cvt_pk_bf16_f32 v136, v61, v65
    v_cvt_pk_bf16_f32 v137, v69, v73
    v_cvt_pk_bf16_f32 v138, v77, v81
    buffer_store_dwordx3 v[136:138], v9, s[20:23], s35 offen offset:768 sc1
    v_mfma_f32_16x16x32_bf16 v[48:51], v[96:99], a[84:87], v[48:51]
    v_mfma_f32_16x16x32_bf16 v[52:55], v[92:95], a[64:67], v[52:55]
    s_add_u32 s34, s34, s39
    v_mfma_f32_16x16x32_bf16 v[52:55], v[96:99], a[88:91], v[52:55]
    s_min_u32 s49, s33, 63
    v_mfma_f32_16x16x32_bf16 v[56:59], v[92:95], a[68:71], v[56:59]
    s_bitcmp1_b64 s[58:59], s49
    v_mfma_f32_16x16x32_bf16 v[56:59], v[96:99], a[92:95], v[56:59]
    s_waitcnt lgkmcnt(6)
    v_mfma_f32_16x16x32_bf16 v[36:39], v[100:103], a[96:99], v[36:39]
    s_cselect_b32 s51, -1, 0
    v_mfma_f32_16x16x32_bf16 v[36:39], v[104:107], a[120:123], v[36:39]
    v_mfma_f32_16x16x32_bf16 v[40:43], v[100:103], a[100:103], v[40:43]
    s_cselect_b32 s47, s48, s34
    v_mfma_f32_16x16x32_bf16 v[40:43], v[104:107], a[124:127], v[40:43]
    s_bitcmp1_b64 s[56:57], s49
    v_mfma_f32_16x16x32_bf16 v[44:47], v[100:103], a[104:107], v[44:47]
    s_cselect_b32 s52, -1, 0
    v_mfma_f32_16x16x32_bf16 v[44:47], v[104:107], a[128:131], v[44:47]
    v_mfma_f32_16x16x32_bf16 v[48:51], v[100:103], a[108:111], v[48:51]
    v_cvt_pk_bf16_f32 v140, v62, v66
    v_cvt_pk_bf16_f32 v141, v70, v74
    v_cvt_pk_bf16_f32 v142, v78, v82
    buffer_store_dwordx3 v[140:142], v9, s[20:23], s35 offen offset:1536 sc1
    v_cvt_pk_bf16_f32 v144, v63, v67
    v_cvt_pk_bf16_f32 v145, v71, v75
    v_cvt_pk_bf16_f32 v146, v79, v83
    buffer_store_dwordx3 v[144:146], v9, s[20:23], s35 offen offset:2304 sc1
    v_mfma_f32_16x16x32_bf16 v[48:51], v[104:107], a[132:135], v[48:51]
    s_cmp_eq_u32 s38, -1
    v_mfma_f32_16x16x32_bf16 v[52:55], v[100:103], a[112:115], v[52:55]
    s_cselect_b32 s50, s51, 0
    v_mfma_f32_16x16x32_bf16 v[52:55], v[104:107], a[136:139], v[52:55]
    s_or_b32 s50, s50, s52
    v_mfma_f32_16x16x32_bf16 v[56:59], v[100:103], a[116:119], v[56:59]
    s_add_u32 m0, s36, s42
    v_mfma_f32_16x16x32_bf16 v[56:59], v[104:107], a[140:143], v[56:59]
    s_waitcnt lgkmcnt(4)
    v_mfma_f32_16x16x32_bf16 v[36:39], v[108:111], a[144:147], v[36:39]
    v_mfma_f32_16x16x32_bf16 v[36:39], v[112:115], a[168:171], v[36:39]
    v_add_u32 v4, s37, v8
    v_mfma_f32_16x16x32_bf16 v[40:43], v[108:111], a[148:151], v[40:43]
    s_add_u32 s37, s37, 12288
    v_mfma_f32_16x16x32_bf16 v[40:43], v[112:115], a[172:175], v[40:43]
    v_xor_b32 v5, 64, v4
    v_mfma_f32_16x16x32_bf16 v[44:47], v[108:111], a[152:155], v[44:47]
    v_xor_b32 v6, 128, v4
    v_mfma_f32_16x16x32_bf16 v[44:47], v[112:115], a[176:179], v[44:47]
    v_mfma_f32_16x16x32_bf16 v[48:51], v[108:111], a[156:159], v[48:51]
    v_xor_b32 v7, 192, v4
    v_mfma_f32_16x16x32_bf16 v[48:51], v[112:115], a[180:183], v[48:51]
    s_cmp_eq_u32 s37, 159744
    v_mfma_f32_16x16x32_bf16 v[52:55], v[108:111], a[160:163], v[52:55]
    s_cselect_b32 s37, 0, s37
    v_mfma_f32_16x16x32_bf16 v[52:55], v[112:115], a[184:187], v[52:55]
    v_mfma_f32_16x16x32_bf16 v[56:59], v[108:111], a[164:167], v[56:59]
    s_add_u32 s33, s33, 1
    v_mfma_f32_16x16x32_bf16 v[56:59], v[112:115], a[188:191], v[56:59]
    s_waitcnt vmcnt(11) lgkmcnt(0)
    s_barrier
    ds_read_b32 v154, v153 offset:0
    v_mfma_f32_16x16x32_bf16 v[36:39], v[116:119], a[192:195], v[36:39]
    ds_read_b128 v[84:87], v4 offset:0
    v_mfma_f32_16x16x32_bf16 v[36:39], v[120:123], a[216:219], v[36:39]
    ds_read_b128 v[88:91], v5 offset:0
    v_mfma_f32_16x16x32_bf16 v[40:43], v[116:119], a[196:199], v[40:43]
    ds_read_b128 v[92:95], v6 offset:0
    v_mfma_f32_16x16x32_bf16 v[40:43], v[120:123], a[220:223], v[40:43]
    ds_read_b128 v[96:99], v7 offset:0
    v_mfma_f32_16x16x32_bf16 v[44:47], v[116:119], a[200:203], v[44:47]
    ds_read_b128 v[100:103], v4 offset:256
    v_mfma_f32_16x16x32_bf16 v[44:47], v[120:123], a[224:227], v[44:47]
    s_waitcnt lgkmcnt(5)
    v_readfirstlane_b32 s44, v154
    v_mfma_f32_16x16x32_bf16 v[48:51], v[116:119], a[204:207], v[48:51]
    ds_read_b128 v[104:107], v5 offset:256
    v_mfma_f32_16x16x32_bf16 v[48:51], v[120:123], a[228:231], v[48:51]
    s_cmp_lt_u32 s44, 6291456
    s_cselect_b32 s53, s50, s52
    v_mfma_f32_16x16x32_bf16 v[52:55], v[116:119], a[208:211], v[52:55]
    s_and_b32 s54, s44, s51
    s_add_u32 s54, s54, s47
    v_mfma_f32_16x16x32_bf16 v[52:55], v[120:123], a[232:235], v[52:55]
    s_and_b32 s14, s53, 113246208
    v_mfma_f32_16x16x32_bf16 v[56:59], v[116:119], a[212:215], v[56:59]
    ds_read_b128 v[108:111], v6 offset:256
    v_mfma_f32_16x16x32_bf16 v[56:59], v[120:123], a[236:239], v[56:59]
    ds_read_b128 v[112:115], v7 offset:256
    v_mfma_f32_16x16x32_bf16 v[36:39], v[124:127], a[240:243], v[36:39]
    buffer_load_dwordx4 v1, s[12:15], s54 offen offset:0 nt lds
    v_mfma_f32_16x16x32_bf16 v[36:39], v[128:131], v[168:171], v[36:39]
    v_mfma_f32_16x16x32_bf16 v[40:43], v[124:127], a[244:247], v[40:43]
    v_mfma_f32_16x16x32_bf16 v[40:43], v[128:131], v[172:175], v[40:43]
    buffer_load_dwordx4 v2, s[12:15], s54 offen offset:1024 nt lds
    v_mfma_f32_16x16x32_bf16 v[44:47], v[124:127], a[248:251], v[44:47]
    v_mfma_f32_16x16x32_bf16 v[44:47], v[128:131], v[176:179], v[44:47]
    v_mfma_f32_16x16x32_bf16 v[48:51], v[124:127], a[252:255], v[48:51]
    buffer_load_dwordx4 v3, s[12:15], s54 offen offset:2048 nt lds
    s_andn2_b32 s39, s51, s53
    v_mfma_f32_16x16x32_bf16 v[48:51], v[128:131], v[180:183], v[48:51]
    s_cselect_b32 s39, s46, -1
    v_mfma_f32_16x16x32_bf16 v[52:55], v[124:127], v[160:163], v[52:55]
    s_min_u32 s38, s38, s39
    v_mfma_f32_16x16x32_bf16 v[52:55], v[128:131], v[184:187], v[52:55]
    s_add_u32 s39, s33, 2
    v_mfma_f32_16x16x32_bf16 v[56:59], v[124:127], v[164:167], v[56:59]
    s_cmp_ge_u32 s39, s38
    v_mfma_f32_16x16x32_bf16 v[56:59], v[128:131], v[188:191], v[56:59]
    s_cbranch_scc1 L_drain1
    s_waitcnt lgkmcnt(6)
    v_mfma_f32_16x16x32_bf16 v[60:63], v[84:87], a[0:3], v[12:15]
    s_add_u32 s55, s33, 63
    s_and_b32 s55, s55, 63
    v_mfma_f32_16x16x32_bf16 v[60:63], v[88:91], a[24:27], v[60:63]
    ds_read_b128 v[116:119], v4 offset:512
    v_mfma_f32_16x16x32_bf16 v[64:67], v[84:87], a[4:7], v[16:19]
    v_readlane_b32 s35, v148, s55
    v_mfma_f32_16x16x32_bf16 v[64:67], v[88:91], a[28:31], v[64:67]
    ds_read_b128 v[120:123], v5 offset:512
    v_mfma_f32_16x16x32_bf16 v[68:71], v[84:87], a[8:11], v[20:23]
    v_mfma_f32_16x16x32_bf16 v[68:71], v[88:91], a[32:35], v[68:71]
    ds_read_b128 v[124:127], v6 offset:512
    v_mfma_f32_16x16x32_bf16 v[72:75], v[84:87], a[12:15], v[24:27]
    v_mfma_f32_16x16x32_bf16 v[72:75], v[88:91], a[36:39], v[72:75]
    ds_read_b128 v[128:131], v7 offset:512
    v_mfma_f32_16x16x32_bf16 v[76:79], v[84:87], a[16:19], v[28:31]
    s_and_b32 m0, s46, 63
    v_mfma_f32_16x16x32_bf16 v[76:79], v[88:91], a[40:43], v[76:79]
    s_and_b32 s39, s53, 12288
    v_mfma_f32_16x16x32_bf16 v[80:83], v[84:87], a[20:23], v[32:35]
    v_writelane_b32 v148, s54, m0
    v_mfma_f32_16x16x32_bf16 v[80:83], v[88:91], a[44:47], v[80:83]
    s_waitcnt lgkmcnt(8)
    v_mfma_f32_16x16x32_bf16 v[60:63], v[92:95], a[48:51], v[60:63]
    s_add_u32 s36, s36, s39
    v_mfma_f32_16x16x32_bf16 v[60:63], v[96:99], a[72:75], v[60:63]
    v_mfma_f32_16x16x32_bf16 v[64:67], v[92:95], a[52:55], v[64:67]
    s_cmp_eq_u32 s36, 159744
    v_mfma_f32_16x16x32_bf16 v[64:67], v[96:99], a[76:79], v[64:67]
    s_cselect_b32 s36, 0, s36
    v_mfma_f32_16x16x32_bf16 v[68:71], v[92:95], a[56:59], v[68:71]
    s_sub_u32 s46, s46, s53
    v_mfma_f32_16x16x32_bf16 v[68:71], v[96:99], a[80:83], v[68:71]
    s_and_b32 s39, s52, s43
    v_mfma_f32_16x16x32_bf16 v[72:75], v[92:95], a[60:63], v[72:75]
    v_cvt_pk_bf16_f32 v132, v36, v40
    v_cvt_pk_bf16_f32 v133, v44, v48
    v_cvt_pk_bf16_f32 v134, v52, v56
    buffer_store_dwordx3 v[132:134], v9, s[20:23], s35 offen offset:0 sc1
    v_cvt_pk_bf16_f32 v136, v37, v41
    v_cvt_pk_bf16_f32 v137, v45, v49
    v_cvt_pk_bf16_f32 v138, v53, v57
    buffer_store_dwordx3 v[136:138], v9, s[20:23], s35 offen offset:768 sc1
    v_mfma_f32_16x16x32_bf16 v[72:75], v[96:99], a[84:87], v[72:75]
    v_mfma_f32_16x16x32_bf16 v[76:79], v[92:95], a[64:67], v[76:79]
    s_add_u32 s34, s34, s39
    v_mfma_f32_16x16x32_bf16 v[76:79], v[96:99], a[88:91], v[76:79]
    s_min_u32 s49, s33, 63
    v_mfma_f32_16x16x32_bf16 v[80:83], v[92:95], a[68:71], v[80:83]
    s_bitcmp1_b64 s[58:59], s49
    v_mfma_f32_16x16x32_bf16 v[80:83], v[96:99], a[92:95], v[80:83]
    s_waitcnt lgkmcnt(6)
    v_mfma_f32_16x16x32_bf16 v[60:63], v[100:103], a[96:99], v[60:63]
    s_cselect_b32 s51, -1, 0
    v_mfma_f32_16x16x32_bf16 v[60:63], v[104:107], a[120:123], v[60:63]
    v_mfma_f32_16x16x32_bf16 v[64:67], v[100:103], a[100:103], v[64:67]
    s_cselect_b32 s47, s48, s34
    v_mfma_f32_16x16x32_bf16 v[64:67], v[104:107], a[124:127], v[64:67]
    s_bitcmp1_b64 s[56:57], s49
    v_mfma_f32_16x16x32_bf16 v[68:71], v[100:103], a[104:107], v[68:71]
    s_cselect_b32 s52, -1, 0
    v_mfma_f32_16x16x32_bf16 v[68:71], v[104:107], a[128:131], v[68:71]
    v_mfma_f32_16x16x32_bf16 v[72:75], v[100:103], a[108:111], v[72:75]
    v_cvt_pk_bf16_f32 v140, v38, v42
    v_cvt_pk_bf16_f32 v141, v46, v50
    v_cvt_pk_bf16_f32 v142, v54, v58
    buffer_store_dwordx3 v[140:142], v9, s[20:23], s35 offen offset:1536 sc1
    v_cvt_pk_bf16_f32 v144, v39, v43
    v_cvt_pk_bf16_f32 v145, v47, v51
    v_cvt_pk_bf16_f32 v146, v55, v59
    buffer_store_dwordx3 v[144:146], v9, s[20:23], s35 offen offset:2304 sc1
    v_mfma_f32_16x16x32_bf16 v[72:75], v[104:107], a[132:135], v[72:75]
    s_cmp_eq_u32 s38, -1
    v_mfma_f32_16x16x32_bf16 v[76:79], v[100:103], a[112:115], v[76:79]
    s_cselect_b32 s50, s51, 0
    v_mfma_f32_16x16x32_bf16 v[76:79], v[104:107], a[136:139], v[76:79]
    s_or_b32 s50, s50, s52
    v_mfma_f32_16x16x32_bf16 v[80:83], v[100:103], a[116:119], v[80:83]
    s_add_u32 m0, s36, s42
    v_mfma_f32_16x16x32_bf16 v[80:83], v[104:107], a[140:143], v[80:83]
    s_waitcnt lgkmcnt(4)
    v_mfma_f32_16x16x32_bf16 v[60:63], v[108:111], a[144:147], v[60:63]
    v_mfma_f32_16x16x32_bf16 v[60:63], v[112:115], a[168:171], v[60:63]
    v_add_u32 v4, s37, v8
    v_mfma_f32_16x16x32_bf16 v[64:67], v[108:111], a[148:151], v[64:67]
    s_add_u32 s37, s37, 12288
    v_mfma_f32_16x16x32_bf16 v[64:67], v[112:115], a[172:175], v[64:67]
    v_xor_b32 v5, 64, v4
    v_mfma_f32_16x16x32_bf16 v[68:71], v[108:111], a[152:155], v[68:71]
    v_xor_b32 v6, 128, v4
    v_mfma_f32_16x16x32_bf16 v[68:71], v[112:115], a[176:179], v[68:71]
    v_mfma_f32_16x16x32_bf16 v[72:75], v[108:111], a[156:159], v[72:75]
    v_xor_b32 v7, 192, v4
    v_mfma_f32_16x16x32_bf16 v[72:75], v[112:115], a[180:183], v[72:75]
    s_cmp_eq_u32 s37, 159744
    v_mfma_f32_16x16x32_bf16 v[76:79], v[108:111], a[160:163], v[76:79]
    s_cselect_b32 s37, 0, s37
    v_mfma_f32_16x16x32_bf16 v[76:79], v[112:115], a[184:187], v[76:79]
    v_mfma_f32_16x16x32_bf16 v[80:83], v[108:111], a[164:167], v[80:83]
    s_add_u32 s33, s33, 1
    v_mfma_f32_16x16x32_bf16 v[80:83], v[112:115], a[188:191], v[80:83]
    s_waitcnt vmcnt(11) lgkmcnt(0)
    s_barrier
    ds_read_b32 v154, v153 offset:256
    v_mfma_f32_16x16x32_bf16 v[60:63], v[116:119], a[192:195], v[60:63]
    ds_read_b128 v[84:87], v4 offset:0
    v_mfma_f32_16x16x32_bf16 v[60:63], v[120:123], a[216:219], v[60:63]
    ds_read_b128 v[88:91], v5 offset:0
    v_mfma_f32_16x16x32_bf16 v[64:67], v[116:119], a[196:199], v[64:67]
    ds_read_b128 v[92:95], v6 offset:0
    v_mfma_f32_16x16x32_bf16 v[64:67], v[120:123], a[220:223], v[64:67]
    ds_read_b128 v[96:99], v7 offset:0
    v_mfma_f32_16x16x32_bf16 v[68:71], v[116:119], a[200:203], v[68:71]
    ds_read_b128 v[100:103], v4 offset:256
    v_mfma_f32_16x16x32_bf16 v[68:71], v[120:123], a[224:227], v[68:71]
    s_waitcnt lgkmcnt(5)
    v_readfirstlane_b32 s44, v154
    v_mfma_f32_16x16x32_bf16 v[72:75], v[116:119], a[204:207], v[72:75]
    ds_read_b128 v[104:107], v5 offset:256
    v_mfma_f32_16x16x32_bf16 v[72:75], v[120:123], a[228:231], v[72:75]
    s_cmp_lt_u32 s44, 6291456
    s_cselect_b32 s53, s50, s52
    v_mfma_f32_16x16x32_bf16 v[76:79], v[116:119], a[208:211], v[76:79]
    s_and_b32 s54, s44, s51
    s_add_u32 s54, s54, s47
    v_mfma_f32_16x16x32_bf16 v[76:79], v[120:123], a[232:235], v[76:79]
    s_and_b32 s14, s53, 113246208
    v_mfma_f32_16x16x32_bf16 v[80:83], v[116:119], a[212:215], v[80:83]
    ds_read_b128 v[108:111], v6 offset:256
    v_mfma_f32_16x16x32_bf16 v[80:83], v[120:123], a[236:239], v[80:83]
    ds_read_b128 v[112:115], v7 offset:256
    v_mfma_f32_16x16x32_bf16 v[60:63], v[124:127], a[240:243], v[60:63]
    buffer_load_dwordx4 v1, s[12:15], s54 offen offset:0 nt lds
    v_mfma_f32_16x16x32_bf16 v[60:63], v[128:131], v[168:171], v[60:63]
    v_mfma_f32_16x16x32_bf16 v[64:67], v[124:127], a[244:247], v[64:67]
    v_mfma_f32_16x16x32_bf16 v[64:67], v[128:131], v[172:175], v[64:67]
    buffer_load_dwordx4 v2, s[12:15], s54 offen offset:1024 nt lds
    v_mfma_f32_16x16x32_bf16 v[68:71], v[124:127], a[248:251], v[68:71]
    v_mfma_f32_16x16x32_bf16 v[68:71], v[128:131], v[176:179], v[68:71]
    v_mfma_f32_16x16x32_bf16 v[72:75], v[124:127], a[252:255], v[72:75]
    buffer_load_dwordx4 v3, s[12:15], s54 offen offset:2048 nt lds
    s_andn2_b32 s39, s51, s53
    v_mfma_f32_16x16x32_bf16 v[72:75], v[128:131], v[180:183], v[72:75]
    s_cselect_b32 s39, s46, -1
    v_mfma_f32_16x16x32_bf16 v[76:79], v[124:127], v[160:163], v[76:79]
    s_min_u32 s38, s38, s39
    v_mfma_f32_16x16x32_bf16 v[76:79], v[128:131], v[184:187], v[76:79]
    s_add_u32 s39, s33, 2
    v_mfma_f32_16x16x32_bf16 v[80:83], v[124:127], v[164:167], v[80:83]
    s_cmp_ge_u32 s39, s38
    v_mfma_f32_16x16x32_bf16 v[80:83], v[128:131], v[188:191], v[80:83]
    s_cbranch_scc1 L_drain0
    s_branch L_loop2
    .p2align 6
L_loop3:
    s_waitcnt lgkmcnt(6)
    v_mfma_f32_16x16x32_bf16 v[36:39], v[84:87], a[0:3], v[12:15]
    s_add_u32 s55, s33, 63
    s_and_b32 s55, s55, 63
    v_mfma_f32_16x16x32_bf16 v[36:39], v[88:91], a[24:27], v[36:39]
    ds_read_b128 v[116:119], v4 offset:512
    v_mfma_f32_16x16x32_bf16 v[40:43], v[84:87], a[4:7], v[16:19]
    v_readlane_b32 s35, v148, s55
    v_mfma_f32_16x16x32_bf16 v[40:43], v[88:91], a[28:31], v[40:43]
    ds_read_b128 v[120:123], v5 offset:512
    v_mfma_f32_16x16x32_bf16 v[44:47], v[84:87], a[8:11], v[20:23]
    v_mfma_f32_16x16x32_bf16 v[44:47], v[88:91], a[32:35], v[44:47]
    ds_read_b128 v[124:127], v6 offset:512
    v_mfma_f32_16x16x32_bf16 v[48:51], v[84:87], a[12:15], v[24:27]
    v_mfma_f32_16x16x32_bf16 v[48:51], v[88:91], a[36:39], v[48:51]
    ds_read_b128 v[128:131], v7 offset:512
    v_mfma_f32_16x16x32_bf16 v[52:55], v[84:87], a[16:19], v[28:31]
    s_and_b32 m0, s46, 63
    v_mfma_f32_16x16x32_bf16 v[52:55], v[88:91], a[40:43], v[52:55]
    s_and_b32 s39, s53, 12288
    v_mfma_f32_16x16x32_bf16 v[56:59], v[84:87], a[20:23], v[32:35]
    v_writelane_b32 v148, s54, m0
    v_mfma_f32_16x16x32_bf16 v[56:59], v[88:91], a[44:47], v[56:59]
    s_waitcnt lgkmcnt(8)
    v_mfma_f32_16x16x32_bf16 v[36:39], v[92:95], a[48:51], v[36:39]
    s_add_u32 s36, s36, s39
    v_mfma_f32_16x16x32_bf16 v[36:39], v[96:99], a[72:75], v[36:39]
    v_mfma_f32_16x16x32_bf16 v[40:43], v[92:95], a[52:55], v[40:43]
    s_cmp_eq_u32 s36, 159744
    v_mfma_f32_16x16x32_bf16 v[40:43], v[96:99], a[76:79], v[40:43]
    s_cselect_b32 s36, 0, s36
    v_mfma_f32_16x16x32_bf16 v[44:47], v[92:95], a[56:59], v[44:47]
    s_sub_u32 s46, s46, s53
    v_mfma_f32_16x16x32_bf16 v[44:47], v[96:99], a[80:83], v[44:47]
    s_and_b32 s39, s52, s43
    v_mfma_f32_16x16x32_bf16 v[48:51], v[92:95], a[60:63], v[48:51]
    v_mfma_f32_16x16x32_bf16 v[48:51], v[96:99], a[84:87], v[48:51]
    s_add_u32 s34, s34, s39
    v_mfma_f32_16x16x32_bf16 v[52:55], v[92:95], a[64:67], v[52:55]
    s_min_u32 s49, s33, 63
    v_mfma_f32_16x16x32_bf16 v[52:55], v[96:99], a[88:91], v[52:55]
    v_cvt_pk_bf16_f32 v132, v60, v64
    v_cvt_pk_bf16_f32 v133, v68, v72
    v_cvt_pk_bf16_f32 v134, v76, v80
    buffer_store_dwordx3 v[132:134], v9, s[20:23], s35 offen offset:0 sc1
    v_cvt_pk_bf16_f32 v136, v61, v65
    v_cvt_pk_bf16_f32 v137, v69, v73
    v_cvt_pk_bf16_f32 v138, v77, v81
    buffer_store_dwordx3 v[136:138], v9, s[20:23], s35 offen offset:768 sc1
    v_mfma_f32_16x16x32_bf16 v[56:59], v[92:95], a[68:71], v[56:59]
    s_bitcmp1_b64 s[58:59], s49
    v_mfma_f32_16x16x32_bf16 v[56:59], v[96:99], a[92:95], v[56:59]
    s_waitcnt lgkmcnt(6)
    v_mfma_f32_16x16x32_bf16 v[36:39], v[100:103], a[96:99], v[36:39]
    s_cselect_b32 s51, -1, 0
    v_mfma_f32_16x16x32_bf16 v[36:39], v[104:107], a[120:123], v[36:39]
    v_mfma_f32_16x16x32_bf16 v[40:43], v[100:103], a[100:103], v[40:43]
    s_cselect_b32 s47, s48, s34
    v_mfma_f32_16x16x32_bf16 v[40:43], v[104:107], a[124:127], v[40:43]
    s_bitcmp1_b64 s[56:57], s49
    v_mfma_f32_16x16x32_bf16 v[44:47], v[100:103], a[104:107], v[44:47]
    s_cselect_b32 s52, -1, 0
    v_mfma_f32_16x16x32_bf16 v[44:47], v[104:107], a[128:131], v[44:47]
    v_mfma_f32_16x16x32_bf16 v[48:51], v[100:103], a[108:111], v[48:51]
    s_cmp_eq_u32 s38, -1
    v_mfma_f32_16x16x32_bf16 v[48:51], v[104:107], a[132:135], v[48:51]
    s_cselect_b32 s50, s51, 0
    v_mfma_f32_16x16x32_bf16 v[52:55], v[100:103], a[112:115], v[52:55]
    s_or_b32 s50, s50, s52
    v_mfma_f32_16x16x32_bf16 v[52:55], v[104:107], a[136:139], v[52:55]
    v_cvt_pk_bf16_f32 v140, v62, v66
    v_cvt_pk_bf16_f32 v141, v70, v74
    v_cvt_pk_bf16_f32 v142, v78, v82
    buffer_store_dwordx3 v[140:142], v9, s[20:23], s35 offen offset:1536 sc1
    v_cvt_pk_bf16_f32 v144, v63, v67
    v_cvt_pk_bf16_f32 v145, v71, v75
    v_cvt_pk_bf16_f32 v146, v79, v83
    buffer_store_dwordx3 v[144:146], v9, s[20:23], s35 offen offset:2304 sc1
    v_mfma_f32_16x16x32_bf16 v[56:59], v[100:103], a[116:119], v[56:59]
    s_add_u32 m0, s36, s42
    v_mfma_f32_16x16x32_bf16 v[56:59], v[104:107], a[140:143], v[56:59]
    s_waitcnt lgkmcnt(4)
    v_mfma_f32_16x16x32_bf16 v[36:39], v[108:111], a[144:147], v[36:39]
    v_mfma_f32_16x16x32_bf16 v[36:39], v[112:115], a[168:171], v[36:39]
    v_add_u32 v4, s37, v8
    v_mfma_f32_16x16x32_bf16 v[40:43], v[108:111], a[148:151], v[40:43]
    s_add_u32 s37, s37, 12288
    v_mfma_f32_16x16x32_bf16 v[40:43], v[112:115], a[172:175], v[40:43]
    v_xor_b32 v5, 64, v4
    v_mfma_f32_16x16x32_bf16 v[44:47], v[108:111], a[152:155], v[44:47]
    v_xor_b32 v6, 128, v4
    v_mfma_f32_16x16x32_bf16 v[44:47], v[112:115], a[176:179], v[44:47]
    v_mfma_f32_16x16x32_bf16 v[48:51], v[108:111], a[156:159], v[48:51]
    v_xor_b32 v7, 192, v4
    v_mfma_f32_16x16x32_bf16 v[48:51], v[112:115], a[180:183], v[48:51]
    s_cmp_eq_u32 s37, 159744
    v_mfma_f32_16x16x32_bf16 v[52:55], v[108:111], a[160:163], v[52:55]
    s_cselect_b32 s37, 0, s37
    v_mfma_f32_16x16x32_bf16 v[52:55], v[112:115], a[184:187], v[52:55]
    v_mfma_f32_16x16x32_bf16 v[56:59], v[108:111], a[164:167], v[56:59]
    s_add_u32 s33, s33, 1
    v_mfma_f32_16x16x32_bf16 v[56:59], v[112:115], a[188:191], v[56:59]
    s_waitcnt vmcnt(11) lgkmcnt(0)
    s_barrier
    ds_read_b32 v154, v153 offset:0
    v_mfma_f32_16x16x32_bf16 v[36:39], v[116:119], a[192:195], v[36:39]
    ds_read_b128 v[84:87], v4 offset:0
    v_mfma_f32_16x16x32_bf16 v[36:39], v[120:123], a[216:219], v[36:39]
    ds_read_b128 v[88:91], v5 offset:0
    v_mfma_f32_16x16x32_bf16 v[40:43], v[116:119], a[196:199], v[40:43]
    ds_read_b128 v[92:95], v6 offset:0
    v_mfma_f32_16x16x32_bf16 v[40:43], v[120:123], a[220:223], v[40:43]
    ds_read_b128 v[96:99], v7 offset:0
    v_mfma_f32_16x16x32_bf16 v[44:47], v[116:119], a[200:203], v[44:47]
    ds_read_b128 v[100:103], v4 offset:256
    v_mfma_f32_16x16x32_bf16 v[44:47], v[120:123], a[224:227], v[44:47]
    s_waitcnt lgkmcnt(5)
    v_readfirstlane_b32 s44, v154
    v_mfma_f32_16x16x32_bf16 v[48:51], v[116:119], a[204:207], v[48:51]
    ds_read_b128 v[104:107], v5 offset:256
    v_mfma_f32_16x16x32_bf16 v[48:51], v[120:123], a[228:231], v[48:51]
    s_cmp_lt_u32 s44, 6291456
    s_cselect_b32 s53, s50, s52
    v_mfma_f32_16x16x32_bf16 v[52:55], v[116:119], a[208:211], v[52:55]
    s_and_b32 s54, s44, s51
    s_add_u32 s54, s54, s47
    v_mfma_f32_16x16x32_bf16 v[52:55], v[120:123], a[232:235], v[52:55]
    s_and_b32 s14, s53, 113246208
    v_mfma_f32_16x16x32_bf16 v[56:59], v[116:119], a[212:215], v[56:59]
    ds_read_b128 v[108:111], v6 offset:256
    v_mfma_f32_16x16x32_bf16 v[56:59], v[120:123], a[236:239], v[56:59]
    ds_read_b128 v[112:115], v7 offset:256
    v_mfma_f32_16x16x32_bf16 v[36:39], v[124:127], a[240:243], v[36:39]
    v_mfma_f32_16x16x32_bf16 v[36:39], v[128:131], v[168:171], v[36:39]
    buffer_load_dwordx4 v1, s[12:15], s54 offen offset:0 nt lds
    v_mfma_f32_16x16x32_bf16 v[40:43], v[124:127], a[244:247], v[40:43]
    v_mfma_f32_16x16x32_bf16 v[40:43], v[128:131], v[172:175], v[40:43]
    v_mfma_f32_16x16x32_bf16 v[44:47], v[124:127], a[248:251], v[44:47]
    buffer_load_dwordx4 v2, s[12:15], s54 offen offset:1024 nt lds
    v_mfma_f32_16x16x32_bf16 v[44:47], v[128:131], v[176:179], v[44:47]
    v_mfma_f32_16x16x32_bf16 v[48:51], v[124:127], a[252:255], v[48:51]
    s_andn2_b32 s39, s51, s53
    v_mfma_f32_16x16x32_bf16 v[48:51], v[128:131], v[180:183], v[48:51]
    buffer_load_dwordx4 v3, s[12:15], s54 offen offset:2048 nt lds
    s_cselect_b32 s39, s46, -1
    v_mfma_f32_16x16x32_bf16 v[52:55], v[124:127], v[160:163], v[52:55]
    s_min_u32 s38, s38, s39
    v_mfma_f32_16x16x32_bf16 v[52:55], v[128:131], v[184:187], v[52:55]
    s_add_u32 s39, s33, 2
    v_mfma_f32_16x16x32_bf16 v[56:59], v[124:127], v[164:167], v[56:59]
    s_cmp_ge_u32 s39, s38
    v_mfma_f32_16x16x32_bf16 v[56:59], v[128:131], v[188:191], v[56:59]
    s_cbranch_scc1 L_drain1
    s_waitcnt lgkmcnt(6)
    v_mfma_f32_16x16x32_bf16 v[60:63], v[84:87], a[0:3], v[12:15]
    s_add_u32 s55, s33, 63
    s_and_b32 s55, s55, 63
    v_mfma_f32_16x16x32_bf16 v[60:63], v[88:91], a[24:27], v[60:63]
    ds_read_b128 v[116:119], v4 offset:512
    v_mfma_f32_16x16x32_bf16 v[64:67], v[84:87], a[4:7], v[16:19]
    v_readlane_b32 s35, v148, s55
    v_mfma_f32_16x16x32_bf16 v[64:67], v[88:91], a[28:31], v[64:67]
    ds_read_b128 v[120:123], v5 offset:512
    v_mfma_f32_16x16x32_bf16 v[68:71], v[84:87], a[8:11], v[20:23]
    v_mfma_f32_16x16x32_bf16 v[68:71], v[88:91], a[32:35], v[68:71]
    ds_read_b128 v[124:127], v6 offset:512
    v_mfma_f32_16x16x32_bf16 v[72:75], v[84:87], a[12:15], v[24:27]
    v_mfma_f32_16x16x32_bf16 v[72:75], v[88:91], a[36:39], v[72:75]
    ds_read_b128 v[128:131], v7 offset:512
    v_mfma_f32_16x16x32_bf16 v[76:79], v[84:87], a[16:19], v[28:31]
    s_and_b32 m0, s46, 63
    v_mfma_f32_16x16x32_bf16 v[76:79], v[88:91], a[40:43], v[76:79]
    s_and_b32 s39, s53, 12288
    v_mfma_f32_16x16x32_bf16 v[80:83], v[84:87], a[20:23], v[32:35]
    v_writelane_b32 v148, s54, m0
    v_mfma_f32_16x16x32_bf16 v[80:83], v[88:91], a[44:47], v[80:83]
    s_waitcnt lgkmcnt(8)
    v_mfma_f32_16x16x32_bf16 v[60:63], v[92:95], a[48:51], v[60:63]
    s_add_u32 s36, s36, s39
    v_mfma_f32_16x16x32_bf16 v[60:63], v[96:99], a[72:75], v[60:63]
    v_mfma_f32_16x16x32_bf16 v[64:67], v[92:95], a[52:55], v[64:67]
    s_cmp_eq_u32 s36, 159744
    v_mfma_f32_16x16x32_bf16 v[64:67], v[96:99], a[76:79], v[64:67]
    s_cselect_b32 s36, 0, s36
    v_mfma_f32_16x16x32_bf16 v[68:71], v[92:95], a[56:59], v[68:71]
    s_sub_u32 s46, s46, s53
    v_mfma_f32_16x16x32_bf16 v[68:71], v[96:99], a[80:83], v[68:71]
    s_and_b32 s39, s52, s43
    v_mfma_f32_16x16x32_bf16 v[72:75], v[92:95], a[60:63], v[72:75]
    v_mfma_f32_16x16x32_bf16 v[72:75], v[96:99], a[84:87], v[72:75]
    s_add_u32 s34, s34, s39
    v_mfma_f32_16x16x32_bf16 v[76:79], v[92:95], a[64:67], v[76:79]
    s_min_u32 s49, s33, 63
    v_mfma_f32_16x16x32_bf16 v[76:79], v[96:99], a[88:91], v[76:79]
    v_cvt_pk_bf16_f32 v132, v36, v40
    v_cvt_pk_bf16_f32 v133, v44, v48
    v_cvt_pk_bf16_f32 v134, v52, v56
    buffer_store_dwordx3 v[132:134], v9, s[20:23], s35 offen offset:0 sc1
    v_cvt_pk_bf16_f32 v136, v37, v41
    v_cvt_pk_bf16_f32 v137, v45, v49
    v_cvt_pk_bf16_f32 v138, v53, v57
    buffer_store_dwordx3 v[136:138], v9, s[20:23], s35 offen offset:768 sc1
    v_mfma_f32_16x16x32_bf16 v[80:83], v[92:95], a[68:71], v[80:83]
    s_bitcmp1_b64 s[58:59], s49
    v_mfma_f32_16x16x32_bf16 v[80:83], v[96:99], a[92:95], v[80:83]
    s_waitcnt lgkmcnt(6)
    v_mfma_f32_16x16x32_bf16 v[60:63], v[100:103], a[96:99], v[60:63]
    s_cselect_b32 s51, -1, 0
    v_mfma_f32_16x16x32_bf16 v[60:63], v[104:107], a[120:123], v[60:63]
    v_mfma_f32_16x16x32_bf16 v[64:67], v[100:103], a[100:103], v[64:67]
    s_cselect_b32 s47, s48, s34
    v_mfma_f32_16x16x32_bf16 v[64:67], v[104:107], a[124:127], v[64:67]
    s_bitcmp1_b64 s[56:57], s49
    v_mfma_f32_16x16x32_bf16 v[68:71], v[100:103], a[104:107], v[68:71]
    s_cselect_b32 s52, -1, 0
    v_mfma_f32_16x16x32_bf16 v[68:71], v[104:107], a[128:131], v[68:71]
    v_mfma_f32_16x16x32_bf16 v[72:75], v[100:103], a[108:111], v[72:75]
    s_cmp_eq_u32 s38, -1
    v_mfma_f32_16x16x32_bf16 v[72:75], v[104:107], a[132:135], v[72:75]
    s_cselect_b32 s50, s51, 0
    v_mfma_f32_16x16x32_bf16 v[76:79], v[100:103], a[112:115], v[76:79]
    s_or_b32 s50, s50, s52
    v_mfma_f32_16x16x32_bf16 v[76:79], v[104:107], a[136:139], v[76:79]
    v_cvt_pk_bf16_f32 v140, v38, v42
    v_cvt_pk_bf16_f32 v141, v46, v50
    v_cvt_pk_bf16_f32 v142, v54, v58
    buffer_store_dwordx3 v[140:142], v9, s[20:23], s35 offen offset:1536 sc1
    v_cvt_pk_bf16_f32 v144, v39, v43
    v_cvt_pk_bf16_f32 v145, v47, v51
    v_cvt_pk_bf16_f32 v146, v55, v59
    buffer_store_dwordx3 v[144:146], v9, s[20:23], s35 offen offset:2304 sc1
    v_mfma_f32_16x16x32_bf16 v[80:83], v[100:103], a[116:119], v[80:83]
    s_add_u32 m0, s36, s42
    v_mfma_f32_16x16x32_bf16 v[80:83], v[104:107], a[140:143], v[80:83]
    s_waitcnt lgkmcnt(4)
    v_mfma_f32_16x16x32_bf16 v[60:63], v[108:111], a[144:147], v[60:63]
    v_mfma_f32_16x16x32_bf16 v[60:63], v[112:115], a[168:171], v[60:63]
    v_add_u32 v4, s37, v8
    v_mfma_f32_16x16x32_bf16 v[64:67], v[108:111], a[148:151], v[64:67]
    s_add_u32 s37, s37, 12288
    v_mfma_f32_16x16x32_bf16 v[64:67], v[112:115], a[172:175], v[64:67]
    v_xor_b32 v5, 64, v4
    v_mfma_f32_16x16x32_bf16 v[68:71], v[108:111], a[152:155], v[68:71]
    v_xor_b32 v6, 128, v4
    v_mfma_f32_16x16x32_bf16 v[68:71], v[112:115], a[176:179], v[68:71]
    v_mfma_f32_16x16x32_bf16 v[72:75], v[108:111], a[156:159], v[72:75]
    v_xor_b32 v7, 192, v4
    v_mfma_f32_16x16x32_bf16 v[72:75], v[112:115], a[180:183], v[72:75]
    s_cmp_eq_u32 s37, 159744
    v_mfma_f32_16x16x32_bf16 v[76:79], v[108:111], a[160:163], v[76:79]
    s_cselect_b32 s37, 0, s37
    v_mfma_f32_16x16x32_bf16 v[76:79], v[112:115], a[184:187], v[76:79]
    v_mfma_f32_16x16x32_bf16 v[80:83], v[108:111], a[164:167], v[80:83]
    s_add_u32 s33, s33, 1
    v_mfma_f32_16x16x32_bf16 v[80:83], v[112:115], a[188:191], v[80:83]
    s_waitcnt vmcnt(11) lgkmcnt(0)
    s_barrier
    ds_read_b32 v154, v153 offset:256
    v_mfma_f32_16x16x32_bf16 v[60:63], v[116:119], a[192:195], v[60:63]
    ds_read_b128 v[84:87], v4 offset:0
    v_mfma_f32_16x16x32_bf16 v[60:63], v[120:123], a[216:219], v[60:63]
    ds_read_b128 v[88:91], v5 offset:0
    v_mfma_f32_16x16x32_bf16 v[64:67], v[116:119], a[196:199], v[64:67]
    ds_read_b128 v[92:95], v6 offset:0
    v_mfma_f32_16x16x32_bf16 v[64:67], v[120:123], a[220:223], v[64:67]
    ds_read_b128 v[96:99], v7 offset:0
    v_mfma_f32_16x16x32_bf16 v[68:71], v[116:119], a[200:203], v[68:71]
    ds_read_b128 v[100:103], v4 offset:256
    v_mfma_f32_16x16x32_bf16 v[68:71], v[120:123], a[224:227], v[68:71]
    s_waitcnt lgkmcnt(5)
    v_readfirstlane_b32 s44, v154
    v_mfma_f32_16x16x32_bf16 v[72:75], v[116:119], a[204:207], v[72:75]
    ds_read_b128 v[104:107], v5 offset:256
    v_mfma_f32_16x16x32_bf16 v[72:75], v[120:123], a[228:231], v[72:75]
    s_cmp_lt_u32 s44, 6291456
    s_cselect_b32 s53, s50, s52
    v_mfma_f32_16x16x32_bf16 v[76:79], v[116:119], a[208:211], v[76:79]
    s_and_b32 s54, s44, s51
    s_add_u32 s54, s54, s47
    v_mfma_f32_16x16x32_bf16 v[76:79], v[120:123], a[232:235], v[76:79]
    s_and_b32 s14, s53, 113246208
    v_mfma_f32_16x16x32_bf16 v[80:83], v[116:119], a[212:215], v[80:83]
    ds_read_b128 v[108:111], v6 offset:256
    v_mfma_f32_16x16x32_bf16 v[80:83], v[120:123], a[236:239], v[80:83]
    ds_read_b128 v[112:115], v7 offset:256
    v_mfma_f32_16x16x32_bf16 v[60:63], v[124:127], a[240:243], v[60:63]
    v_mfma_f32_16x16x32_bf16 v[60:63], v[128:131], v[168:171], v[60:63]
    buffer_load_dwordx4 v1, s[12:15], s54 offen offset:0 nt lds
    v_mfma_f32_16x16x32_bf16 v[64:67], v[124:127], a[244:247], v[64:67]
    v_mfma_f32_16x16x32_bf16 v[64:67], v[128:131], v[172:175], v[64:67]
    v_mfma_f32_16x16x32_bf16 v[68:71], v[124:127], a[248:251], v[68:71]
    buffer_load_dwordx4 v2, s[12:15], s54 offen offset:1024 nt lds
    v_mfma_f32_16x16x32_bf16 v[68:71], v[128:131], v[176:179], v[68:71]
    v_mfma_f32_16x16x32_bf16 v[72:75], v[124:127], a[252:255], v[72:75]
    s_andn2_b32 s39, s51, s53
    v_mfma_f32_16x16x32_bf16 v[72:75], v[128:131], v[180:183], v[72:75]
    buffer_load_dwordx4 v3, s[12:15], s54 offen offset:2048 nt lds
    s_cselect_b32 s39, s46, -1
    v_mfma_f32_16x16x32_bf16 v[76:79], v[124:127], v[160:163], v[76:79]
    s_min_u32 s38, s38, s39
    v_mfma_f32_16x16x32_bf16 v[76:79], v[128:131], v[184:187], v[76:79]
    s_add_u32 s39, s33, 2
    v_mfma_f32_16x16x32_bf16 v[80:83], v[124:127], v[164:167], v[80:83]
    s_cmp_ge_u32 s39, s38
    v_mfma_f32_16x16x32_bf16 v[80:83], v[128:131], v[188:191], v[80:83]
    s_cbranch_scc1 L_drain0
    s_branch L_loop3
    .p2align 6
L_early0:
    s_waitcnt lgkmcnt(6)
    v_mfma_f32_16x16x32_bf16 v[36:39], v[84:87], a[0:3], v[12:15]
    s_add_u32 s55, s33, 63
    s_and_b32 s55, s55, 63
    v_mfma_f32_16x16x32_bf16 v[36:39], v[88:91], a[24:27], v[36:39]
    ds_read_b128 v[116:119], v4 offset:512
    v_mfma_f32_16x16x32_bf16 v[40:43], v[84:87], a[4:7], v[16:19]
    v_readlane_b32 s35, v148, s55
    v_mfma_f32_16x16x32_bf16 v[40:43], v[88:91], a[28:31], v[40:43]
    ds_read_b128 v[120:123], v5 offset:512
    v_mfma_f32_16x16x32_bf16 v[44:47], v[84:87], a[8:11], v[20:23]
    v_mfma_f32_16x16x32_bf16 v[44:47], v[88:91], a[32:35], v[44:47]
    ds_read_b128 v[124:127], v6 offset:512
    v_mfma_f32_16x16x32_bf16 v[48:51], v[84:87], a[12:15], v[24:27]
    v_mfma_f32_16x16x32_bf16 v[48:51], v[88:91], a[36:39], v[48:51]
    ds_read_b128 v[128:131], v7 offset:512
    v_mfma_f32_16x16x32_bf16 v[52:55], v[84:87], a[16:19], v[28:31]
    s_and_b32 m0, s46, 63
    s_and_b32 s39, s53, 12288
    v_mfma_f32_16x16x32_bf16 v[52:55], v[88:91], a[40:43], v[52:55]
    v_writelane_b32 v148, s54, m0
    s_add_u32 s36, s36, s39
    v_mfma_f32_16x16x32_bf16 v[56:59], v[84:87], a[20:23], v[32:35]
    s_cmp_eq_u32 s36, 159744
    s_cselect_b32 s36, 0, s36
    v_mfma_f32_16x16x32_bf16 v[56:59], v[88:91], a[44:47], v[56:59]
    s_sub_u32 s46, s46, s53
    s_waitcnt lgkmcnt(8)
    v_mfma_f32_16x16x32_bf16 v[36:39], v[92:95], a[48:51], v[36:39]
    v_cvt_pk_bf16_f32 v132, v60, v64
    v_cvt_pk_bf16_f32 v133, v68, v72
    v_cvt_pk_bf16_f32 v134, v76, v80
    buffer_store_dwordx3 v[132:134], v9, s[20:23], s35 offen offset:0 sc1
    v_cvt_pk_bf16_f32 v136, v61, v65
    v_cvt_pk_bf16_f32 v137, v69, v73
    v_cvt_pk_bf16_f32 v138, v77, v81
    buffer_store_dwordx3 v[136:138], v9, s[20:23], s35 offen offset:768 sc1
    v_mfma_f32_16x16x32_bf16 v[36:39], v[96:99], a[72:75], v[36:39]
    s_and_b32 s39, s52, s43
    s_add_u32 s34, s34, s39
    v_mfma_f32_16x16x32_bf16 v[40:43], v[92:95], a[52:55], v[40:43]
    s_min_u32 s49, s33, 63
    s_add_u32 m0, s36, s42
    v_mfma_f32_16x16x32_bf16 v[40:43], v[96:99], a[76:79], v[40:43]
    s_mov_b32 s14, 113246208
    v_mfma_f32_16x16x32_bf16 v[44:47], v[92:95], a[56:59], v[44:47]
    buffer_load_dwordx4 v1, s[12:15], s34 offen offset:0 nt lds
    buffer_load_dwordx4 v2, s[12:15], s34 offen offset:1024 nt lds
    v_mfma_f32_16x16x32_bf16 v[44:47], v[96:99], a[80:83], v[44:47]
    buffer_load_dwordx4 v3, s[12:15], s34 offen offset:2048 nt lds
    s_add_u32 s34, s34, s43
    v_mfma_f32_16x16x32_bf16 v[48:51], v[92:95], a[60:63], v[48:51]
    s_add_u32 s36, s36, 12288
    s_add_u32 s46, s46, 1
    v_mfma_f32_16x16x32_bf16 v[48:51], v[96:99], a[84:87], v[48:51]
    s_cmp_eq_u32 s36, 159744
    s_cselect_b32 s36, 0, s36
    v_mfma_f32_16x16x32_bf16 v[52:55], v[92:95], a[64:67], v[52:55]
    s_add_u32 m0, s36, s42
    s_mov_b32 s14, 113246208
    v_mfma_f32_16x16x32_bf16 v[52:55], v[96:99], a[88:91], v[52:55]
    buffer_load_dwordx4 v1, s[12:15], s34 offen offset:0 nt lds
    v_mfma_f32_16x16x32_bf16 v[56:59], v[92:95], a[68:71], v[56:59]
    buffer_load_dwordx4 v2, s[12:15], s34 offen offset:1024 nt lds
    buffer_load_dwordx4 v3, s[12:15], s34 offen offset:2048 nt lds
    v_mfma_f32_16x16x32_bf16 v[56:59], v[96:99], a[92:95], v[56:59]
    s_add_u32 s34, s34, s43
    s_waitcnt lgkmcnt(6)
    v_mfma_f32_16x16x32_bf16 v[36:39], v[100:103], a[96:99], v[36:39]
    v_cvt_pk_bf16_f32 v140, v62, v66
    v_cvt_pk_bf16_f32 v141, v70, v74
    v_cvt_pk_bf16_f32 v142, v78, v82
    buffer_store_dwordx3 v[140:142], v9, s[20:23], s35 offen offset:1536 sc1
    v_cvt_pk_bf16_f32 v144, v63, v67
    v_cvt_pk_bf16_f32 v145, v71, v75
    v_cvt_pk_bf16_f32 v146, v79, v83
    buffer_store_dwordx3 v[144:146], v9, s[20:23], s35 offen offset:2304 sc1
    v_mfma_f32_16x16x32_bf16 v[36:39], v[104:107], a[120:123], v[36:39]
    s_add_u32 s36, s36, 12288
    s_add_u32 s46, s46, 1
    v_mfma_f32_16x16x32_bf16 v[40:43], v[100:103], a[100:103], v[40:43]
    s_cmp_eq_u32 s36, 159744
    s_cselect_b32 s36, 0, s36
    v_mfma_f32_16x16x32_bf16 v[40:43], v[104:107], a[124:127], v[40:43]
    s_add_u32 m0, s36, s42
    s_mov_b32 s14, 113246208
    v_mfma_f32_16x16x32_bf16 v[44:47], v[100:103], a[104:107], v[44:47]
    buffer_load_dwordx4 v1, s[12:15], s34 offen offset:0 nt lds
    buffer_load_dwordx4 v2, s[12:15], s34 offen offset:1024 nt lds
    v_mfma_f32_16x16x32_bf16 v[44:47], v[104:107], a[128:131], v[44:47]
    buffer_load_dwordx4 v3, s[12:15], s34 offen offset:2048 nt lds
    v_mfma_f32_16x16x32_bf16 v[48:51], v[100:103], a[108:111], v[48:51]
    s_add_u32 s34, s34, s43
    s_add_u32 s36, s36, 12288
    v_mfma_f32_16x16x32_bf16 v[48:51], v[104:107], a[132:135], v[48:51]
    s_add_u32 s46, s46, 1
    s_cmp_eq_u32 s36, 159744
    v_mfma_f32_16x16x32_bf16 v[52:55], v[100:103], a[112:115], v[52:55]
    s_cselect_b32 s36, 0, s36
    s_bitcmp1_b64 s[58:59], s49
    v_mfma_f32_16x16x32_bf16 v[52:55], v[104:107], a[136:139], v[52:55]
    s_cselect_b32 s51, -1, 0
    s_cselect_b32 s47, s48, s34
    v_mfma_f32_16x16x32_bf16 v[56:59], v[100:103], a[116:119], v[56:59]
    s_bitcmp1_b64 s[56:57], s49
    s_cselect_b32 s52, -1, 0
    v_mfma_f32_16x16x32_bf16 v[56:59], v[104:107], a[140:143], v[56:59]
    s_waitcnt lgkmcnt(4)
    v_mfma_f32_16x16x32_bf16 v[36:39], v[108:111], a[144:147], v[36:39]
    s_cmp_eq_u32 s38, -1
    s_cselect_b32 s50, s51, 0
    v_mfma_f32_16x16x32_bf16 v[36:39], v[112:115], a[168:171], v[36:39]
    s_or_b32 s50, s50, s52
    s_add_u32 m0, s36, s42
    v_mfma_f32_16x16x32_bf16 v[40:43], v[108:111], a[148:151], v[40:43]
    v_add_u32 v4, s37, v8
    s_add_u32 s37, s37, 12288
    v_mfma_f32_16x16x32_bf16 v[40:43], v[112:115], a[172:175], v[40:43]
    v_xor_b32 v5, 64, v4
    v_xor_b32 v6, 128, v4
    v_mfma_f32_16x16x32_bf16 v[44:47], v[108:111], a[152:155], v[44:47]
    v_xor_b32 v7, 192, v4
    s_cmp_eq_u32 s37, 159744
    v_mfma_f32_16x16x32_bf16 v[44:47], v[112:115], a[176:179], v[44:47]
    s_cselect_b32 s37, 0, s37
    v_mfma_f32_16x16x32_bf16 v[48:51], v[108:111], a[156:159], v[48:51]
    s_bitcmp1_b64 s[62:63], s49
    v_mfma_f32_16x16x32_bf16 v[48:51], v[112:115], a[180:183], v[48:51]
    s_cselect_b32 s30, s67, 0
    v_mfma_f32_16x16x32_bf16 v[52:55], v[108:111], a[160:163], v[52:55]
    s_cmp_eq_u32 s38, -1
    v_mfma_f32_16x16x32_bf16 v[52:55], v[112:115], a[184:187], v[52:55]
    s_cselect_b32 s30, s30, 0
    v_mfma_f32_16x16x32_bf16 v[56:59], v[108:111], a[164:167], v[56:59]
    s_add_u32 s33, s33, 1
    v_mfma_f32_16x16x32_bf16 v[56:59], v[112:115], a[188:191], v[56:59]
    s_waitcnt vmcnt(23) lgkmcnt(0)
    s_barrier
    ds_read_b32 v154, v153 offset:0
    v_mfma_f32_16x16x32_bf16 v[36:39], v[116:119], a[192:195], v[36:39]
    v_mov_b32 v150, s66
    v_mfma_f32_16x16x32_bf16 v[36:39], v[120:123], a[216:219], v[36:39]
    buffer_atomic_add v150, v149, s[28:31], 0 offen sc0 sc1
    v_mfma_f32_16x16x32_bf16 v[40:43], v[116:119], a[196:199], v[40:43]
    ds_read_b128 v[84:87], v4 offset:0
    v_mfma_f32_16x16x32_bf16 v[40:43], v[120:123], a[220:223], v[40:43]
    ds_read_b128 v[88:91], v5 offset:0
    v_mfma_f32_16x16x32_bf16 v[44:47], v[116:119], a[200:203], v[44:47]
    ds_read_b128 v[92:95], v6 offset:0
    v_mfma_f32_16x16x32_bf16 v[44:47], v[120:123], a[224:227], v[44:47]
    s_waitcnt lgkmcnt(3)
    v_readfirstlane_b32 s44, v154
    v_mfma_f32_16x16x32_bf16 v[48:51], v[116:119], a[204:207], v[48:51]
    ds_read_b128 v[96:99], v7 offset:0
    v_mfma_f32_16x16x32_bf16 v[48:51], v[120:123], a[228:231], v[48:51]
    s_cmp_lt_u32 s44, 6291456
    s_cselect_b32 s53, s50, s52
    v_mfma_f32_16x16x32_bf16 v[52:55], v[116:119], a[208:211], v[52:55]
    s_and_b32 s54, s44, s51
    s_add_u32 s54, s54, s47
    v_mfma_f32_16x16x32_bf16 v[52:55], v[120:123], a[232:235], v[52:55]
    s_and_b32 s14, s53, 113246208
    v_mfma_f32_16x16x32_bf16 v[56:59], v[116:119], a[212:215], v[56:59]
    buffer_load_dwordx4 v1, s[12:15], s54 offen offset:0 nt lds
    v_mfma_f32_16x16x32_bf16 v[56:59], v[120:123], a[236:239], v[56:59]
    ds_read_b128 v[100:103], v4 offset:256
    v_mfma_f32_16x16x32_bf16 v[36:39], v[124:127], a[240:243], v[36:39]
    ds_read_b128 v[104:107], v5 offset:256
    v_mfma_f32_16x16x32_bf16 v[36:39], v[128:131], v[168:171], v[36:39]
    buffer_load_dwordx4 v2, s[12:15], s54 offen offset:1024 nt lds
    v_mfma_f32_16x16x32_bf16 v[40:43], v[124:127], a[244:247], v[40:43]
    ds_read_b128 v[108:111], v6 offset:256
    v_mfma_f32_16x16x32_bf16 v[40:43], v[128:131], v[172:175], v[40:43]
    ds_read_b128 v[112:115], v7 offset:256
    v_mfma_f32_16x16x32_bf16 v[44:47], v[124:127], a[248:251], v[44:47]
    buffer_load_dwordx4 v3, s[12:15], s54 offen offset:2048 nt lds
    v_mfma_f32_16x16x32_bf16 v[44:47], v[128:131], v[176:179], v[44:47]
    v_mfma_f32_16x16x32_bf16 v[48:51], v[124:127], a[252:255], v[48:51]
    v_mfma_f32_16x16x32_bf16 v[48:51], v[128:131], v[180:183], v[48:51]
    v_mfma_f32_16x16x32_bf16 v[52:55], v[124:127], v[160:163], v[52:55]
    v_mfma_f32_16x16x32_bf16 v[52:55], v[128:131], v[184:187], v[52:55]
    v_mfma_f32_16x16x32_bf16 v[56:59], v[124:127], v[164:167], v[56:59]
    v_mfma_f32_16x16x32_bf16 v[56:59], v[128:131], v[188:191], v[56:59]
    s_waitcnt lgkmcnt(6)
    v_mfma_f32_16x16x32_bf16 v[60:63], v[84:87], a[0:3], v[12:15]
    s_add_u32 s55, s33, 63
    s_and_b32 s55, s55, 63
    v_mfma_f32_16x16x32_bf16 v[60:63], v[88:91], a[24:27], v[60:63]
    ds_read_b128 v[116:119], v4 offset:512
    v_mfma_f32_16x16x32_bf16 v[64:67], v[84:87], a[4:7], v[16:19]
    v_readlane_b32 s35, v148, s55
    v_mfma_f32_16x16x32_bf16 v[64:67], v[88:91], a[28:31], v[64:67]
    ds_read_b128 v[120:123], v5 offset:512
    v_mfma_f32_16x16x32_bf16 v[68:71], v[84:87], a[8:11], v[20:23]
    v_mfma_f32_16x16x32_bf16 v[68:71], v[88:91], a[32:35], v[68:71]
    ds_read_b128 v[124:127], v6 offset:512
    v_mfma_f32_16x16x32_bf16 v[72:75], v[84:87], a[12:15], v[24:27]
    v_mfma_f32_16x16x32_bf16 v[72:75], v[88:91], a[36:39], v[72:75]
    ds_read_b128 v[128:131], v7 offset:512
    v_mfma_f32_16x16x32_bf16 v[76:79], v[84:87], a[16:19], v[28:31]
    s_and_b32 m0, s46, 63
    s_and_b32 s39, s53, 12288
    v_mfma_f32_16x16x32_bf16 v[76:79], v[88:91], a[40:43], v[76:79]
    v_writelane_b32 v148, s54, m0
    s_add_u32 s36, s36, s39
    v_mfma_f32_16x16x32_bf16 v[80:83], v[84:87], a[20:23], v[32:35]
    s_cmp_eq_u32 s36, 159744
    s_cselect_b32 s36, 0, s36
    v_mfma_f32_16x16x32_bf16 v[80:83], v[88:91], a[44:47], v[80:83]
    s_sub_u32 s46, s46, s53
    s_waitcnt lgkmcnt(8)
    v_mfma_f32_16x16x32_bf16 v[60:63], v[92:95], a[48:51], v[60:63]
    v_cvt_pk_bf16_f32 v132, v36, v40
    v_cvt_pk_bf16_f32 v133, v44, v48
    v_cvt_pk_bf16_f32 v134, v52, v56
    buffer_store_dwordx3 v[132:134], v9, s[20:23], s35 offen offset:0 sc1
    v_cvt_pk_bf16_f32 v136, v37, v41
    v_cvt_pk_bf16_f32 v137, v45, v49
    v_cvt_pk_bf16_f32 v138, v53, v57
    buffer_store_dwordx3 v[136:138], v9, s[20:23], s35 offen offset:768 sc1
    v_mfma_f32_16x16x32_bf16 v[60:63], v[96:99], a[72:75], v[60:63]
    s_and_b32 s39, s52, s43
    s_add_u32 s34, s34, s39
    v_mfma_f32_16x16x32_bf16 v[64:67], v[92:95], a[52:55], v[64:67]
    s_min_u32 s49, s33, 63
    s_add_u32 m0, s36, s42
    v_mfma_f32_16x16x32_bf16 v[64:67], v[96:99], a[76:79], v[64:67]
    s_mov_b32 s14, 113246208
    v_mfma_f32_16x16x32_bf16 v[68:71], v[92:95], a[56:59], v[68:71]
    buffer_load_dwordx4 v1, s[12:15], s34 offen offset:0 nt lds
    buffer_load_dwordx4 v2, s[12:15], s34 offen offset:1024 nt lds
    v_mfma_f32_16x16x32_bf16 v[68:71], v[96:99], a[80:83], v[68:71]
    buffer_load_dwordx4 v3, s[12:15], s34 offen offset:2048 nt lds
    s_add_u32 s34, s34, s43
    v_mfma_f32_16x16x32_bf16 v[72:75], v[92:95], a[60:63], v[72:75]
    s_add_u32 s36, s36, 12288
    s_add_u32 s46, s46, 1
    v_mfma_f32_16x16x32_bf16 v[72:75], v[96:99], a[84:87], v[72:75]
    s_cmp_eq_u32 s36, 159744
    s_cselect_b32 s36, 0, s36
    v_mfma_f32_16x16x32_bf16 v[76:79], v[92:95], a[64:67], v[76:79]
    s_add_u32 m0, s36, s42
    s_mov_b32 s14, 113246208
    v_mfma_f32_16x16x32_bf16 v[76:79], v[96:99], a[88:91], v[76:79]
    buffer_load_dwordx4 v1, s[12:15], s34 offen offset:0 nt lds
    v_mfma_f32_16x16x32_bf16 v[80:83], v[92:95], a[68:71], v[80:83]
    buffer_load_dwordx4 v2, s[12:15], s34 offen offset:1024 nt lds
    buffer_load_dwordx4 v3, s[12:15], s34 offen offset:2048 nt lds
    v_mfma_f32_16x16x32_bf16 v[80:83], v[96:99], a[92:95], v[80:83]
    s_add_u32 s34, s34, s43
    s_waitcnt lgkmcnt(6)
    v_mfma_f32_16x16x32_bf16 v[60:63], v[100:103], a[96:99], v[60:63]
    v_cvt_pk_bf16_f32 v140, v38, v42
    v_cvt_pk_bf16_f32 v141, v46, v50
    v_cvt_pk_bf16_f32 v142, v54, v58
    buffer_store_dwordx3 v[140:142], v9, s[20:23], s35 offen offset:1536 sc1
    v_cvt_pk_bf16_f32 v144, v39, v43
    v_cvt_pk_bf16_f32 v145, v47, v51
    v_cvt_pk_bf16_f32 v146, v55, v59
    buffer_store_dwordx3 v[144:146], v9, s[20:23], s35 offen offset:2304 sc1
    v_mfma_f32_16x16x32_bf16 v[60:63], v[104:107], a[120:123], v[60:63]
    s_add_u32 s36, s36, 12288
    s_add_u32 s46, s46, 1
    v_mfma_f32_16x16x32_bf16 v[64:67], v[100:103], a[100:103], v[64:67]
    s_cmp_eq_u32 s36, 159744
    s_cselect_b32 s36, 0, s36
    v_mfma_f32_16x16x32_bf16 v[64:67], v[104:107], a[124:127], v[64:67]
    s_add_u32 m0, s36, s42
    s_mov_b32 s14, 113246208
    v_mfma_f32_16x16x32_bf16 v[68:71], v[100:103], a[104:107], v[68:71]
    buffer_load_dwordx4 v1, s[12:15], s34 offen offset:0 nt lds
    buffer_load_dwordx4 v2, s[12:15], s34 offen offset:1024 nt lds
    v_mfma_f32_16x16x32_bf16 v[68:71], v[104:107], a[128:131], v[68:71]
    buffer_load_dwordx4 v3, s[12:15], s34 offen offset:2048 nt lds
    v_mfma_f32_16x16x32_bf16 v[72:75], v[100:103], a[108:111], v[72:75]
    s_add_u32 s34, s34, s43
    s_add_u32 s36, s36, 12288
    v_mfma_f32_16x16x32_bf16 v[72:75], v[104:107], a[132:135], v[72:75]
    s_add_u32 s46, s46, 1
    s_cmp_eq_u32 s36, 159744
    v_mfma_f32_16x16x32_bf16 v[76:79], v[100:103], a[112:115], v[76:79]
    s_cselect_b32 s36, 0, s36
    s_bitcmp1_b64 s[58:59], s49
    v_mfma_f32_16x16x32_bf16 v[76:79], v[104:107], a[136:139], v[76:79]
    s_cselect_b32 s51, -1, 0
    s_cselect_b32 s47, s48, s34
    v_mfma_f32_16x16x32_bf16 v[80:83], v[100:103], a[116:119], v[80:83]
    s_bitcmp1_b64 s[56:57], s49
    s_cselect_b32 s52, -1, 0
    v_mfma_f32_16x16x32_bf16 v[80:83], v[104:107], a[140:143], v[80:83]
    s_waitcnt lgkmcnt(4)
    v_mfma_f32_16x16x32_bf16 v[60:63], v[108:111], a[144:147], v[60:63]
    s_cmp_eq_u32 s38, -1
    s_cselect_b32 s50, s51, 0
    v_mfma_f32_16x16x32_bf16 v[60:63], v[112:115], a[168:171], v[60:63]
    s_or_b32 s50, s50, s52
    s_add_u32 m0, s36, s42
    v_mfma_f32_16x16x32_bf16 v[64:67], v[108:111], a[148:151], v[64:67]
    v_add_u32 v4, s37, v8
    s_add_u32 s37, s37, 12288
    v_mfma_f32_16x16x32_bf16 v[64:67], v[112:115], a[172:175], v[64:67]
    v_xor_b32 v5, 64, v4
    v_xor_b32 v6, 128, v4
    v_mfma_f32_16x16x32_bf16 v[68:71], v[108:111], a[152:155], v[68:71]
    v_xor_b32 v7, 192, v4
    s_cmp_eq_u32 s37, 159744
    v_mfma_f32_16x16x32_bf16 v[68:71], v[112:115], a[176:179], v[68:71]
    s_cselect_b32 s37, 0, s37
    v_mfma_f32_16x16x32_bf16 v[72:75], v[108:111], a[156:159], v[72:75]
    s_bitcmp1_b64 s[62:63], s49
    v_mfma_f32_16x16x32_bf16 v[72:75], v[112:115], a[180:183], v[72:75]
    s_cselect_b32 s30, s67, 0
    v_mfma_f32_16x16x32_bf16 v[76:79], v[108:111], a[160:163], v[76:79]
    s_cmp_eq_u32 s38, -1
    v_mfma_f32_16x16x32_bf16 v[76:79], v[112:115], a[184:187], v[76:79]
    s_cselect_b32 s30, s30, 0
    v_mfma_f32_16x16x32_bf16 v[80:83], v[108:111], a[164:167], v[80:83]
    s_add_u32 s33, s33, 1
    v_mfma_f32_16x16x32_bf16 v[80:83], v[112:115], a[188:191], v[80:83]
    s_waitcnt vmcnt(23) lgkmcnt(0)
    s_barrier
    ds_read_b32 v154, v153 offset:256
    v_mfma_f32_16x16x32_bf16 v[60:63], v[116:119], a[192:195], v[60:63]
    v_mov_b32 v151, s66
    v_mfma_f32_16x16x32_bf16 v[60:63], v[120:123], a[216:219], v[60:63]
    buffer_atomic_add v151, v149, s[28:31], 0 offen sc0 sc1
    v_mfma_f32_16x16x32_bf16 v[64:67], v[116:119], a[196:199], v[64:67]
    ds_read_b128 v[84:87], v4 offset:0
    v_mfma_f32_16x16x32_bf16 v[64:67], v[120:123], a[220:223], v[64:67]
    ds_read_b128 v[88:91], v5 offset:0
    v_mfma_f32_16x16x32_bf16 v[68:71], v[116:119], a[200:203], v[68:71]
    ds_read_b128 v[92:95], v6 offset:0
    v_mfma_f32_16x16x32_bf16 v[68:71], v[120:123], a[224:227], v[68:71]
    s_waitcnt lgkmcnt(3)
    v_readfirstlane_b32 s44, v154
    v_mfma_f32_16x16x32_bf16 v[72:75], v[116:119], a[204:207], v[72:75]
    ds_read_b128 v[96:99], v7 offset:0
    v_mfma_f32_16x16x32_bf16 v[72:75], v[120:123], a[228:231], v[72:75]
    s_cmp_lt_u32 s44, 6291456
    s_cselect_b32 s53, s50, s52
    v_mfma_f32_16x16x32_bf16 v[76:79], v[116:119], a[208:211], v[76:79]
    s_and_b32 s54, s44, s51
    s_add_u32 s54, s54, s47
    v_mfma_f32_16x16x32_bf16 v[76:79], v[120:123], a[232:235], v[76:79]
    s_and_b32 s14, s53, 113246208
    v_mfma_f32_16x16x32_bf16 v[80:83], v[116:119], a[212:215], v[80:83]
    buffer_load_dwordx4 v1, s[12:15], s54 offen offset:0 nt lds
    v_mfma_f32_16x16x32_bf16 v[80:83], v[120:123], a[236:239], v[80:83]
    ds_read_b128 v[100:103], v4 offset:256
    v_mfma_f32_16x16x32_bf16 v[60:63], v[124:127], a[240:243], v[60:63]
    ds_read_b128 v[104:107], v5 offset:256
    v_mfma_f32_16x16x32_bf16 v[60:63], v[128:131], v[168:171], v[60:63]
    buffer_load_dwordx4 v2, s[12:15], s54 offen offset:1024 nt lds
    v_mfma_f32_16x16x32_bf16 v[64:67], v[124:127], a[244:247], v[64:67]
    ds_read_b128 v[108:111], v6 offset:256
    v_mfma_f32_16x16x32_bf16 v[64:67], v[128:131], v[172:175], v[64:67]
    ds_read_b128 v[112:115], v7 offset:256
    v_mfma_f32_16x16x32_bf16 v[68:71], v[124:127], a[248:251], v[68:71]
    buffer_load_dwordx4 v3, s[12:15], s54 offen offset:2048 nt lds
    v_mfma_f32_16x16x32_bf16 v[68:71], v[128:131], v[176:179], v[68:71]
    v_mfma_f32_16x16x32_bf16 v[72:75], v[124:127], a[252:255], v[72:75]
    v_mfma_f32_16x16x32_bf16 v[72:75], v[128:131], v[180:183], v[72:75]
    v_mfma_f32_16x16x32_bf16 v[76:79], v[124:127], v[160:163], v[76:79]
    v_mfma_f32_16x16x32_bf16 v[76:79], v[128:131], v[184:187], v[76:79]
    v_mfma_f32_16x16x32_bf16 v[80:83], v[124:127], v[164:167], v[80:83]
    s_cmp_lt_u32 s33, 4
    v_mfma_f32_16x16x32_bf16 v[80:83], v[128:131], v[188:191], v[80:83]
    s_cbranch_scc1 L_early0
    s_branch L_loop0
    .p2align 6
L_early1:
    s_waitcnt lgkmcnt(6)
    v_mfma_f32_16x16x32_bf16 v[36:39], v[84:87], a[0:3], v[12:15]
    s_add_u32 s55, s33, 63
    s_and_b32 s55, s55, 63
    v_mfma_f32_16x16x32_bf16 v[36:39], v[88:91], a[24:27], v[36:39]
    ds_read_b128 v[116:119], v4 offset:512
    v_mfma_f32_16x16x32_bf16 v[40:43], v[84:87], a[4:7], v[16:19]
    v_readlane_b32 s35, v148, s55
    v_mfma_f32_16x16x32_bf16 v[40:43], v[88:91], a[28:31], v[40:43]
    ds_read_b128 v[120:123], v5 offset:512
    v_mfma_f32_16x16x32_bf16 v[44:47], v[84:87], a[8:11], v[20:23]
    v_mfma_f32_16x16x32_bf16 v[44:47], v[88:91], a[32:35], v[44:47]
    ds_read_b128 v[124:127], v6 offset:512
    v_mfma_f32_16x16x32_bf16 v[48:51], v[84:87], a[12:15], v[24:27]
    v_mfma_f32_16x16x32_bf16 v[48:51], v[88:91], a[36:39], v[48:51]
    ds_read_b128 v[128:131], v7 offset:512
    v_mfma_f32_16x16x32_bf16 v[52:55], v[84:87], a[16:19], v[28:31]
    s_and_b32 m0, s46, 63
    s_and_b32 s39, s53, 12288
    v_mfma_f32_16x16x32_bf16 v[52:55], v[88:91], a[40:43], v[52:55]
    v_writelane_b32 v148, s54, m0
    s_add_u32 s36, s36, s39
    v_mfma_f32_16x16x32_bf16 v[56:59], v[84:87], a[20:23], v[32:35]
    s_cmp_eq_u32 s36, 159744
    v_mfma_f32_16x16x32_bf16 v[56:59], v[88:91], a[44:47], v[56:59]
    s_cselect_b32 s36, 0, s36
    s_waitcnt lgkmcnt(8)
    v_mfma_f32_16x16x32_bf16 v[36:39], v[92:95], a[48:51], v[36:39]
    s_sub_u32 s46, s46, s53
    s_and_b32 s39, s52, s43
    v_mfma_f32_16x16x32_bf16 v[36:39], v[96:99], a[72:75], v[36:39]
    s_add_u32 s34, s34, s39
    v_mfma_f32_16x16x32_bf16 v[40:43], v[92:95], a[52:55], v[40:43]
    s_min_u32 s49, s33, 63
    s_add_u32 m0, s36, s42
    v_mfma_f32_16x16x32_bf16 v[40:43], v[96:99], a[76:79], v[40:43]
    v_cvt_pk_bf16_f32 v132, v60, v64
    v_cvt_pk_bf16_f32 v133, v68, v72
    v_cvt_pk_bf16_f32 v134, v76, v80
    buffer_store_dwordx3 v[132:134], v9, s[20:23], s35 offen offset:0 sc1
    v_cvt_pk_bf16_f32 v136, v61, v65
    v_cvt_pk_bf16_f32 v137, v69, v73
    v_cvt_pk_bf16_f32 v138, v77, v81
    buffer_store_dwordx3 v[136:138], v9, s[20:23], s35 offen offset:768 sc1
    v_mfma_f32_16x16x32_bf16 v[44:47], v[92:95], a[56:59], v[44:47]
    s_mov_b32 s14, 113246208
    buffer_load_dwordx4 v1, s[12:15], s34 offen offset:0 nt lds
    v_mfma_f32_16x16x32_bf16 v[44:47], v[96:99], a[80:83], v[44:47]
    buffer_load_dwordx4 v2, s[12:15], s34 offen offset:1024 nt lds
    v_mfma_f32_16x16x32_bf16 v[48:51], v[92:95], a[60:63], v[48:51]
    buffer_load_dwordx4 v3, s[12:15], s34 offen offset:2048 nt lds
    s_add_u32 s34, s34, s43
    v_mfma_f32_16x16x32_bf16 v[48:51], v[96:99], a[84:87], v[48:51]
    s_add_u32 s36, s36, 12288
    s_add_u32 s46, s46, 1
    v_mfma_f32_16x16x32_bf16 v[52:55], v[92:95], a[64:67], v[52:55]
    s_cmp_eq_u32 s36, 159744
    v_mfma_f32_16x16x32_bf16 v[52:55], v[96:99], a[88:91], v[52:55]
    s_cselect_b32 s36, 0, s36
    s_add_u32 m0, s36, s42
    v_mfma_f32_16x16x32_bf16 v[56:59], v[92:95], a[68:71], v[56:59]
    s_mov_b32 s14, 113246208
    v_mfma_f32_16x16x32_bf16 v[56:59], v[96:99], a[92:95], v[56:59]
    buffer_load_dwordx4 v1, s[12:15], s34 offen offset:0 nt lds
    s_waitcnt lgkmcnt(6)
    v_mfma_f32_16x16x32_bf16 v[36:39], v[100:103], a[96:99], v[36:39]
    buffer_load_dwordx4 v2, s[12:15], s34 offen offset:1024 nt lds
    buffer_load_dwordx4 v3, s[12:15], s34 offen offset:2048 nt lds
    v_mfma_f32_16x16x32_bf16 v[36:39], v[104:107], a[120:123], v[36:39]
    s_add_u32 s34, s34, s43
    v_mfma_f32_16x16x32_bf16 v[40:43], v[100:103], a[100:103], v[40:43]
    s_add_u32 s36, s36, 12288
    s_add_u32 s46, s46, 1
    v_mfma_f32_16x16x32_bf16 v[40:43], v[104:107], a[124:127], v[40:43]
    v_cvt_pk_bf16_f32 v140, v62, v66
    v_cvt_pk_bf16_f32 v141, v70, v74
    v_cvt_pk_bf16_f32 v142, v78, v82
    buffer_store_dwordx3 v[140:142], v9, s[20:23], s35 offen offset:1536 sc1
    v_cvt_pk_bf16_f32 v144, v63, v67
    v_cvt_pk_bf16_f32 v145, v71, v75
    v_cvt_pk_bf16_f32 v146, v79, v83
    buffer_store_dwordx3 v[144:146], v9, s[20:23], s35 offen offset:2304 sc1
    v_mfma_f32_16x16x32_bf16 v[44:47], v[100:103], a[104:107], v[44:47]
    s_cmp_eq_u32 s36, 159744
    s_cselect_b32 s36, 0, s36
    v_mfma_f32_16x16x32_bf16 v[44:47], v[104:107], a[128:131], v[44:47]
    s_add_u32 m0, s36, s42
    v_mfma_f32_16x16x32_bf16 v[48:51], v[100:103], a[108:111], v[48:51]
    s_mov_b32 s14, 113246208
    buffer_load_dwordx4 v1, s[12:15], s34 offen offset:0 nt lds
    v_mfma_f32_16x16x32_bf16 v[48:51], v[104:107], a[132:135], v[48:51]
    buffer_load_dwordx4 v2, s[12:15], s34 offen offset:1024 nt lds
    buffer_load_dwordx4 v3, s[12:15], s34 offen offset:2048 nt lds
    v_mfma_f32_16x16x32_bf16 v[52:55], v[100:103], a[112:115], v[52:55]
    s_add_u32 s34, s34, s43
    v_mfma_f32_16x16x32_bf16 v[52:55], v[104:107], a[136:139], v[52:55]
    s_add_u32 s36, s36, 12288
    s_add_u32 s46, s46, 1
    v_mfma_f32_16x16x32_bf16 v[56:59], v[100:103], a[116:119], v[56:59]
    s_cmp_eq_u32 s36, 159744
    v_mfma_f32_16x16x32_bf16 v[56:59], v[104:107], a[140:143], v[56:59]
    s_cselect_b32 s36, 0, s36
    s_waitcnt lgkmcnt(4)
    v_mfma_f32_16x16x32_bf16 v[36:39], v[108:111], a[144:147], v[36:39]
    s_bitcmp1_b64 s[58:59], s49
    s_cselect_b32 s51, -1, 0
    v_mfma_f32_16x16x32_bf16 v[36:39], v[112:115], a[168:171], v[36:39]
    s_cselect_b32 s47, s48, s34
    v_mfma_f32_16x16x32_bf16 v[40:43], v[108:111], a[148:151], v[40:43]
    s_bitcmp1_b64 s[56:57], s49
    s_cselect_b32 s52, -1, 0
    v_mfma_f32_16x16x32_bf16 v[40:43], v[112:115], a[172:175], v[40:43]
    s_cmp_eq_u32 s38, -1
    s_cselect_b32 s50, s51, 0
    v_mfma_f32_16x16x32_bf16 v[44:47], v[108:111], a[152:155], v[44:47]
    s_or_b32 s50, s50, s52
    v_mfma_f32_16x16x32_bf16 v[44:47], v[112:115], a[176:179], v[44:47]
    s_add_u32 m0, s36, s42
    v_add_u32 v4, s37, v8
    v_mfma_f32_16x16x32_bf16 v[48:51], v[108:111], a[156:159], v[48:51]
    s_add_u32 s37, s37, 12288
    v_xor_b32 v5, 64, v4
    v_mfma_f32_16x16x32_bf16 v[48:51], v[112:115], a[180:183], v[48:51]
    v_xor_b32 v6, 128, v4
    v_mfma_f32_16x16x32_bf16 v[52:55], v[108:111], a[160:163], v[52:55]
    v_xor_b32 v7, 192, v4
    s_cmp_eq_u32 s37, 159744
    v_mfma_f32_16x16x32_bf16 v[52:55], v[112:115], a[184:187], v[52:55]
    s_cselect_b32 s37, 0, s37
    v_mfma_f32_16x16x32_bf16 v[56:59], v[108:111], a[164:167], v[56:59]
    s_add_u32 s33, s33, 1
    v_mfma_f32_16x16x32_bf16 v[56:59], v[112:115], a[188:191], v[56:59]
    s_waitcnt vmcnt(23) lgkmcnt(0)
    s_barrier
    ds_read_b32 v154, v153 offset:0
    v_mfma_f32_16x16x32_bf16 v[36:39], v[116:119], a[192:195], v[36:39]
    ds_read_b128 v[84:87], v4 offset:0
    v_mfma_f32_16x16x32_bf16 v[36:39], v[120:123], a[216:219], v[36:39]
    ds_read_b128 v[88:91], v5 offset:0
    v_mfma_f32_16x16x32_bf16 v[40:43], v[116:119], a[196:199], v[40:43]
    ds_read_b128 v[92:95], v6 offset:0
    v_mfma_f32_16x16x32_bf16 v[40:43], v[120:123], a[220:223], v[40:43]
    ds_read_b128 v[96:99], v7 offset:0
    v_mfma_f32_16x16x32_bf16 v[44:47], v[116:119], a[200:203], v[44:47]
    ds_read_b128 v[100:103], v4 offset:256
    v_mfma_f32_16x16x32_bf16 v[44:47], v[120:123], a[224:227], v[44:47]
    s_waitcnt lgkmcnt(5)
    v_readfirstlane_b32 s44, v154
    v_mfma_f32_16x16x32_bf16 v[48:51], v[116:119], a[204:207], v[48:51]
    ds_read_b128 v[104:107], v5 offset:256
    v_mfma_f32_16x16x32_bf16 v[48:51], v[120:123], a[228:231], v[48:51]
    s_cmp_lt_u32 s44, 6291456
    s_cselect_b32 s53, s50, s52
    v_mfma_f32_16x16x32_bf16 v[52:55], v[116:119], a[208:211], v[52:55]
    s_and_b32 s54, s44, s51
    s_add_u32 s54, s54, s47
    v_mfma_f32_16x16x32_bf16 v[52:55], v[120:123], a[232:235], v[52:55]
    s_and_b32 s14, s53, 113246208
    v_mfma_f32_16x16x32_bf16 v[56:59], v[116:119], a[212:215], v[56:59]
    ds_read_b128 v[108:111], v6 offset:256
    v_mfma_f32_16x16x32_bf16 v[56:59], v[120:123], a[236:239], v[56:59]
    buffer_load_dwordx4 v1, s[12:15], s54 offen offset:0 nt lds
    v_mfma_f32_16x16x32_bf16 v[36:39], v[124:127], a[240:243], v[36:39]
    ds_read_b128 v[112:115], v7 offset:256
    v_mfma_f32_16x16x32_bf16 v[36:39], v[128:131], v[168:171], v[36:39]
    v_mfma_f32_16x16x32_bf16 v[40:43], v[124:127], a[244:247], v[40:43]
    buffer_load_dwordx4 v2, s[12:15], s54 offen offset:1024 nt lds
    v_mfma_f32_16x16x32_bf16 v[40:43], v[128:131], v[172:175], v[40:43]
    v_mfma_f32_16x16x32_bf16 v[44:47], v[124:127], a[248:251], v[44:47]
    v_mfma_f32_16x16x32_bf16 v[44:47], v[128:131], v[176:179], v[44:47]
    buffer_load_dwordx4 v3, s[12:15], s54 offen offset:2048 nt lds
    v_mfma_f32_16x16x32_bf16 v[48:51], v[124:127], a[252:255], v[48:51]
    v_mfma_f32_16x16x32_bf16 v[48:51], v[128:131], v[180:183], v[48:51]
    v_mfma_f32_16x16x32_bf16 v[52:55], v[124:127], v[160:163], v[52:55]
    v_mfma_f32_16x16x32_bf16 v[52:55], v[128:131], v[184:187], v[52:55]
    v_mfma_f32_16x16x32_bf16 v[56:59], v[124:127], v[164:167], v[56:59]
    v_mfma_f32_16x16x32_bf16 v[56:59], v[128:131], v[188:191], v[56:59]
    s_waitcnt lgkmcnt(6)
    v_mfma_f32_16x16x32_bf16 v[60:63], v[84:87], a[0:3], v[12:15]
    s_add_u32 s55, s33, 63
    s_and_b32 s55, s55, 63
    v_mfma_f32_16x16x32_bf16 v[60:63], v[88:91], a[24:27], v[60:63]
    ds_read_b128 v[116:119], v4 offset:512
    v_mfma_f32_16x16x32_bf16 v[64:67], v[84:87], a[4:7], v[16:19]
    v_readlane_b32 s35, v148, s55
    v_mfma_f32_16x16x32_bf16 v[64:67], v[88:91], a[28:31], v[64:67]
    ds_read_b128 v[120:123], v5 offset:512
    v_mfma_f32_16x16x32_bf16 v[68:71], v[84:87], a[8:11], v[20:23]
    v_mfma_f32_16x16x32_bf16 v[68:71], v[88:91], a[32:35], v[68:71]
    ds_read_b128 v[124:127], v6 offset:512
    v_mfma_f32_16x16x32_bf16 v[72:75], v[84:87], a[12:15], v[24:27]
    v_mfma_f32_16x16x32_bf16 v[72:75], v[88:91], a[36:39], v[72:75]
    ds_read_b128 v[128:131], v7 offset:512
    v_mfma_f32_16x16x32_bf16 v[76:79], v[84:87], a[16:19], v[28:31]
    s_and_b32 m0, s46, 63
    s_and_b32 s39, s53, 12288
    v_mfma_f32_16x16x32_bf16 v[76:79], v[88:91], a[40:43], v[76:79]
    v_writelane_b32 v148, s54, m0
    s_add_u32 s36, s36, s39
    v_mfma_f32_16x16x32_bf16 v[80:83], v[84:87], a[20:23], v[32:35]
    s_cmp_eq_u32 s36, 159744
    v_mfma_f32_16x16x32_bf16 v[80:83], v[88:91], a[44:47], v[80:83]
    s_cselect_b32 s36, 0, s36
    s_waitcnt lgkmcnt(8)
    v_mfma_f32_16x16x32_bf16 v[60:63], v[92:95], a[48:51], v[60:63]
    s_sub_u32 s46, s46, s53
    s_and_b32 s39, s52, s43
    v_mfma_f32_16x16x32_bf16 v[60:63], v[96:99], a[72:75], v[60:63]
    s_add_u32 s34, s34, s39
    v_mfma_f32_16x16x32_bf16 v[64:67], v[92:95], a[52:55], v[64:67]
    s_min_u32 s49, s33, 63
    s_add_u32 m0, s36, s42
    v_mfma_f32_16x16x32_bf16 v[64:67], v[96:99], a[76:79], v[64:67]
    v_cvt_pk_bf16_f32 v132, v36, v40
    v_cvt_pk_bf16_f32 v133, v44, v48
    v_cvt_pk_bf16_f32 v134, v52, v56
    buffer_store_dwordx3 v[132:134], v9, s[20:23], s35 offen offset:0 sc1
    v_cvt_pk_bf16_f32 v136, v37, v41
    v_cvt_pk_bf16_f32 v137, v45, v49
    v_cvt_pk_bf16_f32 v138, v53, v57
    buffer_store_dwordx3 v[136:138], v9, s[20:23], s35 offen offset:768 sc1
    v_mfma_f32_16x16x32_bf16 v[68:71], v[92:95], a[56:59], v[68:71]
    s_mov_b32 s14, 113246208
    buffer_load_dwordx4 v1, s[12:15], s34 offen offset:0 nt lds
    v_mfma_f32_16x16x32_bf16 v[68:71], v[96:99], a[80:83], v[68:71]
    buffer_load_dwordx4 v2, s[12:15], s34 offen offset:1024 nt lds
    v_mfma_f32_16x16x32_bf16 v[72:75], v[92:95], a[60:63], v[72:75]
    buffer_load_dwordx4 v3, s[12:15], s34 offen offset:2048 nt lds
    s_add_u32 s34, s34, s43
    v_mfma_f32_16x16x32_bf16 v[72:75], v[96:99], a[84:87], v[72:75]
    s_add_u32 s36, s36, 12288
    s_add_u32 s46, s46, 1
    v_mfma_f32_16x16x32_bf16 v[76:79], v[92:95], a[64:67], v[76:79]
    s_cmp_eq_u32 s36, 159744
    v_mfma_f32_16x16x32_bf16 v[76:79], v[96:99], a[88:91], v[76:79]
    s_cselect_b32 s36, 0, s36
    s_add_u32 m0, s36, s42
    v_mfma_f32_16x16x32_bf16 v[80:83], v[92:95], a[68:71], v[80:83]
    s_mov_b32 s14, 113246208
    v_mfma_f32_16x16x32_bf16 v[80:83], v[96:99], a[92:95], v[80:83]
    buffer_load_dwordx4 v1, s[12:15], s34 offen offset:0 nt lds
    s_waitcnt lgkmcnt(6)
    v_mfma_f32_16x16x32_bf16 v[60:63], v[100:103], a[96:99], v[60:63]
    buffer_load_dwordx4 v2, s[12:15], s34 offen offset:1024 nt lds
    buffer_load_dwordx4 v3, s[12:15], s34 offen offset:2048 nt lds
    v_mfma_f32_16x16x32_bf16 v[60:63], v[104:107], a[120:123], v[60:63]
    s_add_u32 s34, s34, s43
    v_mfma_f32_16x16x32_bf16 v[64:67], v[100:103], a[100:103], v[64:67]
    s_add_u32 s36, s36, 12288
    s_add_u32 s46, s46, 1
    v_mfma_f32_16x16x32_bf16 v[64:67], v[104:107], a[124:127], v[64:67]
    v_cvt_pk_bf16_f32 v140, v38, v42
    v_cvt_pk_bf16_f32 v141, v46, v50
    v_cvt_pk_bf16_f32 v142, v54, v58
    buffer_store_dwordx3 v[140:142], v9, s[20:23], s35 offen offset:1536 sc1
    v_cvt_pk_bf16_f32 v144, v39, v43
    v_cvt_pk_bf16_f32 v145, v47, v51
    v_cvt_pk_bf16_f32 v146, v55, v59
    buffer_store_dwordx3 v[144:146], v9, s[20:23], s35 offen offset:2304 sc1
    v_mfma_f32_16x16x32_bf16 v[68:71], v[100:103], a[104:107], v[68:71]
    s_cmp_eq_u32 s36, 159744
    s_cselect_b32 s36, 0, s36
    v_mfma_f32_16x16x32_bf16 v[68:71], v[104:107], a[128:131], v[68:71]
    s_add_u32 m0, s36, s42
    v_mfma_f32_16x16x32_bf16 v[72:75], v[100:103], a[108:111], v[72:75]
    s_mov_b32 s14, 113246208
    buffer_load_dwordx4 v1, s[12:15], s34 offen offset:0 nt lds
    v_mfma_f32_16x16x32_bf16 v[72:75], v[104:107], a[132:135], v[72:75]
    buffer_load_dwordx4 v2, s[12:15], s34 offen offset:1024 nt lds
    buffer_load_dwordx4 v3, s[12:15], s34 offen offset:2048 nt lds
    v_mfma_f32_16x16x32_bf16 v[76:79], v[100:103], a[112:115], v[76:79]
    s_add_u32 s34, s34, s43
    v_mfma_f32_16x16x32_bf16 v[76:79], v[104:107], a[136:139], v[76:79]
    s_add_u32 s36, s36, 12288
    s_add_u32 s46, s46, 1
    v_mfma_f32_16x16x32_bf16 v[80:83], v[100:103], a[116:119], v[80:83]
    s_cmp_eq_u32 s36, 159744
    v_mfma_f32_16x16x32_bf16 v[80:83], v[104:107], a[140:143], v[80:83]
    s_cselect_b32 s36, 0, s36
    s_waitcnt lgkmcnt(4)
    v_mfma_f32_16x16x32_bf16 v[60:63], v[108:111], a[144:147], v[60:63]
    s_bitcmp1_b64 s[58:59], s49
    s_cselect_b32 s51, -1, 0
    v_mfma_f32_16x16x32_bf16 v[60:63], v[112:115], a[168:171], v[60:63]
    s_cselect_b32 s47, s48, s34
    v_mfma_f32_16x16x32_bf16 v[64:67], v[108:111], a[148:151], v[64:67]
    s_bitcmp1_b64 s[56:57], s49
    s_cselect_b32 s52, -1, 0
    v_mfma_f32_16x16x32_bf16 v[64:67], v[112:115], a[172:175], v[64:67]
    s_cmp_eq_u32 s38, -1
    s_cselect_b32 s50, s51, 0
    v_mfma_f32_16x16x32_bf16 v[68:71], v[108:111], a[152:155], v[68:71]
    s_or_b32 s50, s50, s52
    v_mfma_f32_16x16x32_bf16 v[68:71], v[112:115], a[176:179], v[68:71]
    s_add_u32 m0, s36, s42
    v_add_u32 v4, s37, v8
    v_mfma_f32_16x16x32_bf16 v[72:75], v[108:111], a[156:159], v[72:75]
    s_add_u32 s37, s37, 12288
    v_xor_b32 v5, 64, v4
    v_mfma_f32_16x16x32_bf16 v[72:75], v[112:115], a[180:183], v[72:75]
    v_xor_b32 v6, 128, v4
    v_mfma_f32_16x16x32_bf16 v[76:79], v[108:111], a[160:163], v[76:79]
    v_xor_b32 v7, 192, v4
    s_cmp_eq_u32 s37, 159744
    v_mfma_f32_16x16x32_bf16 v[76:79], v[112:115], a[184:187], v[76:79]
    s_cselect_b32 s37, 0, s37
    v_mfma_f32_16x16x32_bf16 v[80:83], v[108:111], a[164:167], v[80:83]
    s_add_u32 s33, s33, 1
    v_mfma_f32_16x16x32_bf16 v[80:83], v[112:115], a[188:191], v[80:83]
    s_waitcnt vmcnt(23) lgkmcnt(0)
    s_barrier
    ds_read_b32 v154, v153 offset:256
    v_mfma_f32_16x16x32_bf16 v[60:63], v[116:119], a[192:195], v[60:63]
    ds_read_b128 v[84:87], v4 offset:0
    v_mfma_f32_16x16x32_bf16 v[60:63], v[120:123], a[216:219], v[60:63]
    ds_read_b128 v[88:91], v5 offset:0
    v_mfma_f32_16x16x32_bf16 v[64:67], v[116:119], a[196:199], v[64:67]
    ds_read_b128 v[92:95], v6 offset:0
    v_mfma_f32_16x16x32_bf16 v[64:67], v[120:123], a[220:223], v[64:67]
    ds_read_b128 v[96:99], v7 offset:0
    v_mfma_f32_16x16x32_bf16 v[68:71], v[116:119], a[200:203], v[68:71]
    ds_read_b128 v[100:103], v4 offset:256
    v_mfma_f32_16x16x32_bf16 v[68:71], v[120:123], a[224:227], v[68:71]
    s_waitcnt lgkmcnt(5)
    v_readfirstlane_b32 s44, v154
    v_mfma_f32_16x16x32_bf16 v[72:75], v[116:119], a[204:207], v[72:75]
    ds_read_b128 v[104:107], v5 offset:256
    v_mfma_f32_16x16x32_bf16 v[72:75], v[120:123], a[228:231], v[72:75]
    s_cmp_lt_u32 s44, 6291456
    s_cselect_b32 s53, s50, s52
    v_mfma_f32_16x16x32_bf16 v[76:79], v[116:119], a[208:211], v[76:79]
    s_and_b32 s54, s44, s51
    s_add_u32 s54, s54, s47
    v_mfma_f32_16x16x32_bf16 v[76:79], v[120:123], a[232:235], v[76:79]
    s_and_b32 s14, s53, 113246208
    v_mfma_f32_16x16x32_bf16 v[80:83], v[116:119], a[212:215], v[80:83]
    ds_read_b128 v[108:111], v6 offset:256
    v_mfma_f32_16x16x32_bf16 v[80:83], v[120:123], a[236:239], v[80:83]
    buffer_load_dwordx4 v1, s[12:15], s54 offen offset:0 nt lds
    v_mfma_f32_16x16x32_bf16 v[60:63], v[124:127], a[240:243], v[60:63]
    ds_read_b128 v[112:115], v7 offset:256
    v_mfma_f32_16x16x32_bf16 v[60:63], v[128:131], v[168:171], v[60:63]
    v_mfma_f32_16x16x32_bf16 v[64:67], v[124:127], a[244:247], v[64:67]
    buffer_load_dwordx4 v2, s[12:15], s54 offen offset:1024 nt lds
    v_mfma_f32_16x16x32_bf16 v[64:67], v[128:131], v[172:175], v[64:67]
    v_mfma_f32_16x16x32_bf16 v[68:71], v[124:127], a[248:251], v[68:71]
    v_mfma_f32_16x16x32_bf16 v[68:71], v[128:131], v[176:179], v[68:71]
    buffer_load_dwordx4 v3, s[12:15], s54 offen offset:2048 nt lds
    v_mfma_f32_16x16x32_bf16 v[72:75], v[124:127], a[252:255], v[72:75]
    v_mfma_f32_16x16x32_bf16 v[72:75], v[128:131], v[180:183], v[72:75]
    v_mfma_f32_16x16x32_bf16 v[76:79], v[124:127], v[160:163], v[76:79]
    v_mfma_f32_16x16x32_bf16 v[76:79], v[128:131], v[184:187], v[76:79]
    v_mfma_f32_16x16x32_bf16 v[80:83], v[124:127], v[164:167], v[80:83]
    s_cmp_lt_u32 s33, 4
    v_mfma_f32_16x16x32_bf16 v[80:83], v[128:131], v[188:191], v[80:83]
    s_cbranch_scc1 L_early1
    s_branch L_loop1
    .p2align 6
L_early2:
    s_waitcnt lgkmcnt(6)
    v_mfma_f32_16x16x32_bf16 v[36:39], v[84:87], a[0:3], v[12:15]
    s_add_u32 s55, s33, 63
    s_and_b32 s55, s55, 63
    v_mfma_f32_16x16x32_bf16 v[36:39], v[88:91], a[24:27], v[36:39]
    ds_read_b128 v[116:119], v4 offset:512
    v_mfma_f32_16x16x32_bf16 v[40:43], v[84:87], a[4:7], v[16:19]
    v_readlane_b32 s35, v148, s55
    v_mfma_f32_16x16x32_bf16 v[40:43], v[88:91], a[28:31], v[40:43]
    ds_read_b128 v[120:123], v5 offset:512
    v_mfma_f32_16x16x32_bf16 v[44:47], v[84:87], a[8:11], v[20:23]
    v_mfma_f32_16x16x32_bf16 v[44:47], v[88:91], a[32:35], v[44:47]
    ds_read_b128 v[124:127], v6 offset:512
    v_mfma_f32_16x16x32_bf16 v[48:51], v[84:87], a[12:15], v[24:27]
    v_mfma_f32_16x16x32_bf16 v[48:51], v[88:91], a[36:39], v[48:51]
    ds_read_b128 v[128:131], v7 offset:512
    v_mfma_f32_16x16x32_bf16 v[52:55], v[84:87], a[16:19], v[28:31]
    s_and_b32 m0, s46, 63
    s_and_b32 s39, s53, 12288
    v_mfma_f32_16x16x32_bf16 v[52:55], v[88:91], a[40:43], v[52:55]
    v_writelane_b32 v148, s54, m0
    s_add_u32 s36, s36, s39
    v_mfma_f32_16x16x32_bf16 v[56:59], v[84:87], a[20:23], v[32:35]
    s_cmp_eq_u32 s36, 159744
    v_mfma_f32_16x16x32_bf16 v[56:59], v[88:91], a[44:47], v[56:59]
    s_cselect_b32 s36, 0, s36
    s_waitcnt lgkmcnt(8)
    v_mfma_f32_16x16x32_bf16 v[36:39], v[92:95], a[48:51], v[36:39]
    s_sub_u32 s46, s46, s53
    s_and_b32 s39, s52, s43
    v_mfma_f32_16x16x32_bf16 v[36:39], v[96:99], a[72:75], v[36:39]
    s_add_u32 s34, s34, s39
    v_mfma_f32_16x16x32_bf16 v[40:43], v[92:95], a[52:55], v[40:43]
    s_min_u32 s49, s33, 63
    s_add_u32 m0, s36, s42
    v_mfma_f32_16x16x32_bf16 v[40:43], v[96:99], a[76:79], v[40:43]
    s_mov_b32 s14, 113246208
    buffer_load_dwordx4 v1, s[12:15], s34 offen offset:0 nt lds
    v_mfma_f32_16x16x32_bf16 v[44:47], v[92:95], a[56:59], v[44:47]
    buffer_load_dwordx4 v2, s[12:15], s34 offen offset:1024 nt lds
    v_mfma_f32_16x16x32_bf16 v[44:47], v[96:99], a[80:83], v[44:47]
    buffer_load_dwordx4 v3, s[12:15], s34 offen offset:2048 nt lds
    s_add_u32 s34, s34, s43
    v_mfma_f32_16x16x32_bf16 v[48:51], v[92:95], a[60:63], v[48:51]
    v_cvt_pk_bf16_f32 v132, v60, v64
    v_cvt_pk_bf16_f32 v133, v68, v72
    v_cvt_pk_bf16_f32 v134, v76, v80
    buffer_store_dwordx3 v[132:134], v9, s[20:23], s35 offen offset:0 sc1
    v_cvt_pk_bf16_f32 v136, v61, v65
    v_cvt_pk_bf16_f32 v137, v69, v73
    v_cvt_pk_bf16_f32 v138, v77, v81
    buffer_store_dwordx3 v[136:138], v9, s[20:23], s35 offen offset:768 sc1
    v_mfma_f32_16x16x32_bf16 v[48:51], v[96:99], a[84:87], v[48:51]
    s_add_u32 s36, s36, 12288
    s_add_u32 s46, s46, 1
    v_mfma_f32_16x16x32_bf16 v[52:55], v[92:95], a[64:67], v[52:55]
    s_cmp_eq_u32 s36, 159744
    v_mfma_f32_16x16x32_bf16 v[52:55], v[96:99], a[88:91], v[52:55]
    s_cselect_b32 s36, 0, s36
    s_add_u32 m0, s36, s42
    v_mfma_f32_16x16x32_bf16 v[56:59], v[92:95], a[68:71], v[56:59]
    s_mov_b32 s14, 113246208
    v_mfma_f32_16x16x32_bf16 v[56:59], v[96:99], a[92:95], v[56:59]
    buffer_load_dwordx4 v1, s[12:15], s34 offen offset:0 nt lds
    s_waitcnt lgkmcnt(6)
    v_mfma_f32_16x16x32_bf16 v[36:39], v[100:103], a[96:99], v[36:39]
    buffer_load_dwordx4 v2, s[12:15], s34 offen offset:1024 nt lds
    buffer_load_dwordx4 v3, s[12:15], s34 offen offset:2048 nt lds
    v_mfma_f32_16x16x32_bf16 v[36:39], v[104:107], a[120:123], v[36:39]
    s_add_u32 s34, s34, s43
    v_mfma_f32_16x16x32_bf16 v[40:43], v[100:103], a[100:103], v[40:43]
    s_add_u32 s36, s36, 12288
    s_add_u32 s46, s46, 1
    v_mfma_f32_16x16x32_bf16 v[40:43], v[104:107], a[124:127], v[40:43]
    s_cmp_eq_u32 s36, 159744
    s_cselect_b32 s36, 0, s36
    v_mfma_f32_16x16x32_bf16 v[44:47], v[100:103], a[104:107], v[44:47]
    s_add_u32 m0, s36, s42
    v_mfma_f32_16x16x32_bf16 v[44:47], v[104:107], a[128:131], v[44:47]
    s_mov_b32 s14, 113246208
    buffer_load_dwordx4 v1, s[12:15], s34 offen offset:0 nt lds
    v_mfma_f32_16x16x32_bf16 v[48:51], v[100:103], a[108:111], v[48:51]
    v_cvt_pk_bf16_f32 v140, v62, v66
    v_cvt_pk_bf16_f32 v141, v70, v74
    v_cvt_pk_bf16_f32 v142, v78, v82
    buffer_store_dwordx3 v[140:142], v9, s[20:23], s35 offen offset:1536 sc1
    v_cvt_pk_bf16_f32 v144, v63, v67
    v_cvt_pk_bf16_f32 v145, v71, v75
    v_cvt_pk_bf16_f32 v146, v79, v83
    buffer_store_dwordx3 v[144:146], v9, s[20:23], s35 offen offset:2304 sc1
    v_mfma_f32_16x16x32_bf16 v[48:51], v[104:107], a[132:135], v[48:51]
    buffer_load_dwordx4 v2, s[12:15], s34 offen offset:1024 nt lds
    buffer_load_dwordx4 v3, s[12:15], s34 offen offset:2048 nt lds
    v_mfma_f32_16x16x32_bf16 v[52:55], v[100:103], a[112:115], v[52:55]
    s_add_u32 s34, s34, s43
    v_mfma_f32_16x16x32_bf16 v[52:55], v[104:107], a[136:139], v[52:55]
    s_add_u32 s36, s36, 12288
    s_add_u32 s46, s46, 1
    v_mfma_f32_16x16x32_bf16 v[56:59], v[100:103], a[116:119], v[56:59]
    s_cmp_eq_u32 s36, 159744
    v_mfma_f32_16x16x32_bf16 v[56:59], v[104:107], a[140:143], v[56:59]
    s_cselect_b32 s36, 0, s36
    s_waitcnt lgkmcnt(4)
    v_mfma_f32_16x16x32_bf16 v[36:39], v[108:111], a[144:147], v[36:39]
    s_bitcmp1_b64 s[58:59], s49
    s_cselect_b32 s51, -1, 0
    v_mfma_f32_16x16x32_bf16 v[36:39], v[112:115], a[168:171], v[36:39]
    s_cselect_b32 s47, s48, s34
    v_mfma_f32_16x16x32_bf16 v[40:43], v[108:111], a[148:151], v[40:43]
    s_bitcmp1_b64 s[56:57], s49
    s_cselect_b32 s52, -1, 0
    v_mfma_f32_16x16x32_bf16 v[40:43], v[112:115], a[172:175], v[40:43]
    s_cmp_eq_u32 s38, -1
    s_cselect_b32 s50, s51, 0
    v_mfma_f32_16x16x32_bf16 v[44:47], v[108:111], a[152:155], v[44:47]
    s_or_b32 s50, s50, s52
    v_mfma_f32_16x16x32_bf16 v[44:47], v[112:115], a[176:179], v[44:47]
    s_add_u32 m0, s36, s42
    v_add_u32 v4, s37, v8
    v_mfma_f32_16x16x32_bf16 v[48:51], v[108:111], a[156:159], v[48:51]
    s_add_u32 s37, s37, 12288
    v_xor_b32 v5, 64, v4
    v_mfma_f32_16x16x32_bf16 v[48:51], v[112:115], a[180:183], v[48:51]
    v_xor_b32 v6, 128, v4
    v_mfma_f32_16x16x32_bf16 v[52:55], v[108:111], a[160:163], v[52:55]
    v_xor_b32 v7, 192, v4
    s_cmp_eq_u32 s37, 159744
    v_mfma_f32_16x16x32_bf16 v[52:55], v[112:115], a[184:187], v[52:55]
    s_cselect_b32 s37, 0, s37
    v_mfma_f32_16x16x32_bf16 v[56:59], v[108:111], a[164:167], v[56:59]
    s_add_u32 s33, s33, 1
    v_mfma_f32_16x16x32_bf16 v[56:59], v[112:115], a[188:191], v[56:59]
    s_waitcnt vmcnt(23) lgkmcnt(0)
    s_barrier
    ds_read_b32 v154, v153 offset:0
    v_mfma_f32_16x16x32_bf16 v[36:39], v[116:119], a[192:195], v[36:39]
    ds_read_b128 v[84:87], v4 offset:0
    v_mfma_f32_16x16x32_bf16 v[36:39], v[120:123], a[216:219], v[36:39]
    ds_read_b128 v[88:91], v5 offset:0
    v_mfma_f32_16x16x32_bf16 v[40:43], v[116:119], a[196:199], v[40:43]
    ds_read_b128 v[92:95], v6 offset:0
    v_mfma_f32_16x16x32_bf16 v[40:43], v[120:123], a[220:223], v[40:43]
    ds_read_b128 v[96:99], v7 offset:0
    v_mfma_f32_16x16x32_bf16 v[44:47], v[116:119], a[200:203], v[44:47]
    ds_read_b128 v[100:103], v4 offset:256
    v_mfma_f32_16x16x32_bf16 v[44:47], v[120:123], a[224:227], v[44:47]
    s_waitcnt lgkmcnt(5)
    v_readfirstlane_b32 s44, v154
    v_mfma_f32_16x16x32_bf16 v[48:51], v[116:119], a[204:207], v[48:51]
    ds_read_b128 v[104:107], v5 offset:256
    v_mfma_f32_16x16x32_bf16 v[48:51], v[120:123], a[228:231], v[48:51]
    s_cmp_lt_u32 s44, 6291456
    s_cselect_b32 s53, s50, s52
    v_mfma_f32_16x16x32_bf16 v[52:55], v[116:119], a[208:211], v[52:55]
    s_and_b32 s54, s44, s51
    s_add_u32 s54, s54, s47
    v_mfma_f32_16x16x32_bf16 v[52:55], v[120:123], a[232:235], v[52:55]
    s_and_b32 s14, s53, 113246208
    v_mfma_f32_16x16x32_bf16 v[56:59], v[116:119], a[212:215], v[56:59]
    ds_read_b128 v[108:111], v6 offset:256
    v_mfma_f32_16x16x32_bf16 v[56:59], v[120:123], a[236:239], v[56:59]
    ds_read_b128 v[112:115], v7 offset:256
    v_mfma_f32_16x16x32_bf16 v[36:39], v[124:127], a[240:243], v[36:39]
    buffer_load_dwordx4 v1, s[12:15], s54 offen offset:0 nt lds
    v_mfma_f32_16x16x32_bf16 v[36:39], v[128:131], v[168:171], v[36:39]
    v_mfma_f32_16x16x32_bf16 v[40:43], v[124:127], a[244:247], v[40:43]
    v_mfma_f32_16x16x32_bf16 v[40:43], v[128:131], v[172:175], v[40:43]
    buffer_load_dwordx4 v2, s[12:15], s54 offen offset:1024 nt lds
    v_mfma_f32_16x16x32_bf16 v[44:47], v[124:127], a[248:251], v[44:47]
    v_mfma_f32_16x16x32_bf16 v[44:47], v[128:131], v[176:179], v[44:47]
    v_mfma_f32_16x16x32_bf16 v[48:51], v[124:127], a[252:255], v[48:51]
    buffer_load_dwordx4 v3, s[12:15], s54 offen offset:2048 nt lds
    v_mfma_f32_16x16x32_bf16 v[48:51], v[128:131], v[180:183], v[48:51]
    v_mfma_f32_16x16x32_bf16 v[52:55], v[124:127], v[160:163], v[52:55]
    v_mfma_f32_16x16x32_bf16 v[52:55], v[128:131], v[184:187], v[52:55]
    v_mfma_f32_16x16x32_bf16 v[56:59], v[124:127], v[164:167], v[56:59]
    v_mfma_f32_16x16x32_bf16 v[56:59], v[128:131], v[188:191], v[56:59]
    s_waitcnt lgkmcnt(6)
    v_mfma_f32_16x16x32_bf16 v[60:63], v[84:87], a[0:3], v[12:15]
    s_add_u32 s55, s33, 63
    s_and_b32 s55, s55, 63
    v_mfma_f32_16x16x32_bf16 v[60:63], v[88:91], a[24:27], v[60:63]
    ds_read_b128 v[116:119], v4 offset:512
    v_mfma_f32_16x16x32_bf16 v[64:67], v[84:87], a[4:7], v[16:19]
    v_readlane_b32 s35, v148, s55
    v_mfma_f32_16x16x32_bf16 v[64:67], v[88:91], a[28:31], v[64:67]
    ds_read_b128 v[120:123], v5 offset:512
    v_mfma_f32_16x16x32_bf16 v[68:71], v[84:87], a[8:11], v[20:23]
    v_mfma_f32_16x16x32_bf16 v[68:71], v[88:91], a[32:35], v[68:71]
    ds_read_b128 v[124:127], v6 offset:512
    v_mfma_f32_16x16x32_bf16 v[72:75], v[84:87], a[12:15], v[24:27]
    v_mfma_f32_16x16x32_bf16 v[72:75], v[88:91], a[36:39], v[72:75]
    ds_read_b128 v[128:131], v7 offset:512
    v_mfma_f32_16x16x32_bf16 v[76:79], v[84:87], a[16:19], v[28:31]
    s_and_b32 m0, s46, 63
    s_and_b32 s39, s53, 12288
    v_mfma_f32_16x16x32_bf16 v[76:79], v[88:91], a[40:43], v[76:79]
    v_writelane_b32 v148, s54, m0
    s_add_u32 s36, s36, s39
    v_mfma_f32_16x16x32_bf16 v[80:83], v[84:87], a[20:23], v[32:35]
    s_cmp_eq_u32 s36, 159744
    v_mfma_f32_16x16x32_bf16 v[80:83], v[88:91], a[44:47], v[80:83]
    s_cselect_b32 s36, 0, s36
    s_waitcnt lgkmcnt(8)
    v_mfma_f32_16x16x32_bf16 v[60:63], v[92:95], a[48:51], v[60:63]
    s_sub_u32 s46, s46, s53
    s_and_b32 s39, s52, s43
    v_mfma_f32_16x16x32_bf16 v[60:63], v[96:99], a[72:75], v[60:63]
    s_add_u32 s34, s34, s39
    v_mfma_f32_16x16x32_bf16 v[64:67], v[92:95], a[52:55], v[64:67]
    s_min_u32 s49, s33, 63
    s_add_u32 m0, s36, s42
    v_mfma_f32_16x16x32_bf16 v[64:67], v[96:99], a[76:79], v[64:67]
    s_mov_b32 s14, 113246208
    buffer_load_dwordx4 v1, s[12:15], s34 offen offset:0 nt lds
    v_mfma_f32_16x16x32_bf16 v[68:71], v[92:95], a[56:59], v[68:71]
    buffer_load_dwordx4 v2, s[12:15], s34 offen offset:1024 nt lds
    v_mfma_f32_16x16x32_bf16 v[68:71], v[96:99], a[80:83], v[68:71]
    buffer_load_dwordx4 v3, s[12:15], s34 offen offset:2048 nt lds
    s_add_u32 s34, s34, s43
    v_mfma_f32_16x16x32_bf16 v[72:75], v[92:95], a[60:63], v[72:75]
    v_cvt_pk_bf16_f32 v132, v36, v40
    v_cvt_pk_bf16_f32 v133, v44, v48
    v_cvt_pk_bf16_f32 v134, v52, v56
    buffer_store_dwordx3 v[132:134], v9, s[20:23], s35 offen offset:0 sc1
    v_cvt_pk_bf16_f32 v136, v37, v41
    v_cvt_pk_bf16_f32 v137, v45, v49
    v_cvt_pk_bf16_f32 v138, v53, v57
    buffer_store_dwordx3 v[136:138], v9, s[20:23], s35 offen offset:768 sc1
    v_mfma_f32_16x16x32_bf16 v[72:75], v[96:99], a[84:87], v[72:75]
    s_add_u32 s36, s36, 12288
    s_add_u32 s46, s46, 1
    v_mfma_f32_16x16x32_bf16 v[76:79], v[92:95], a[64:67], v[76:79]
    s_cmp_eq_u32 s36, 159744
    v_mfma_f32_16x16x32_bf16 v[76:79], v[96:99], a[88:91], v[76:79]
    s_cselect_b32 s36, 0, s36
    s_add_u32 m0, s36, s42
    v_mfma_f32_16x16x32_bf16 v[80:83], v[92:95], a[68:71], v[80:83]
    s_mov_b32 s14, 113246208
    v_mfma_f32_16x16x32_bf16 v[80:83], v[96:99], a[92:95], v[80:83]
    buffer_load_dwordx4 v1, s[12:15], s34 offen offset:0 nt lds
    s_waitcnt lgkmcnt(6)
    v_mfma_f32_16x16x32_bf16 v[60:63], v[100:103], a[96:99], v[60:63]
    buffer_load_dwordx4 v2, s[12:15], s34 offen offset:1024 nt lds
    buffer_load_dwordx4 v3, s[12:15], s34 offen offset:2048 nt lds
    v_mfma_f32_16x16x32_bf16 v[60:63], v[104:107], a[120:123], v[60:63]
    s_add_u32 s34, s34, s43
    v_mfma_f32_16x16x32_bf16 v[64:67], v[100:103], a[100:103], v[64:67]
    s_add_u32 s36, s36, 12288
    s_add_u32 s46, s46, 1
    v_mfma_f32_16x16x32_bf16 v[64:67], v[104:107], a[124:127], v[64:67]
    s_cmp_eq_u32 s36, 159744
    s_cselect_b32 s36, 0, s36
    v_mfma_f32_16x16x32_bf16 v[68:71], v[100:103], a[104:107], v[68:71]
    s_add_u32 m0, s36, s42
    v_mfma_f32_16x16x32_bf16 v[68:71], v[104:107], a[128:131], v[68:71]
    s_mov_b32 s14, 113246208
    buffer_load_dwordx4 v1, s[12:15], s34 offen offset:0 nt lds
    v_mfma_f32_16x16x32_bf16 v[72:75], v[100:103], a[108:111], v[72:75]
    v_cvt_pk_bf16_f32 v140, v38, v42
    v_cvt_pk_bf16_f32 v141, v46, v50
    v_cvt_pk_bf16_f32 v142, v54, v58
    buffer_store_dwordx3 v[140:142], v9, s[20:23], s35 offen offset:1536 sc1
    v_cvt_pk_bf16_f32 v144, v39, v43
    v_cvt_pk_bf16_f32 v145, v47, v51
    v_cvt_pk_bf16_f32 v146, v55, v59
    buffer_store_dwordx3 v[144:146], v9, s[20:23], s35 offen offset:2304 sc1
    v_mfma_f32_16x16x32_bf16 v[72:75], v[104:107], a[132:135], v[72:75]
    buffer_load_dwordx4 v2, s[12:15], s34 offen offset:1024 nt lds
    buffer_load_dwordx4 v3, s[12:15], s34 offen offset:2048 nt lds
    v_mfma_f32_16x16x32_bf16 v[76:79], v[100:103], a[112:115], v[76:79]
    s_add_u32 s34, s34, s43
    v_mfma_f32_16x16x32_bf16 v[76:79], v[104:107], a[136:139], v[76:79]
    s_add_u32 s36, s36, 12288
    s_add_u32 s46, s46, 1
    v_mfma_f32_16x16x32_bf16 v[80:83], v[100:103], a[116:119], v[80:83]
    s_cmp_eq_u32 s36, 159744
    v_mfma_f32_16x16x32_bf16 v[80:83], v[104:107], a[140:143], v[80:83]
    s_cselect_b32 s36, 0, s36
    s_waitcnt lgkmcnt(4)
    v_mfma_f32_16x16x32_bf16 v[60:63], v[108:111], a[144:147], v[60:63]
    s_bitcmp1_b64 s[58:59], s49
    s_cselect_b32 s51, -1, 0
    v_mfma_f32_16x16x32_bf16 v[60:63], v[112:115], a[168:171], v[60:63]
    s_cselect_b32 s47, s48, s34
    v_mfma_f32_16x16x32_bf16 v[64:67], v[108:111], a[148:151], v[64:67]
    s_bitcmp1_b64 s[56:57], s49
    s_cselect_b32 s52, -1, 0
    v_mfma_f32_16x16x32_bf16 v[64:67], v[112:115], a[172:175], v[64:67]
    s_cmp_eq_u32 s38, -1
    s_cselect_b32 s50, s51, 0
    v_mfma_f32_16x16x32_bf16 v[68:71], v[108:111], a[152:155], v[68:71]
    s_or_b32 s50, s50, s52
    v_mfma_f32_16x16x32_bf16 v[68:71], v[112:115], a[176:179], v[68:71]
    s_add_u32 m0, s36, s42
    v_add_u32 v4, s37, v8
    v_mfma_f32_16x16x32_bf16 v[72:75], v[108:111], a[156:159], v[72:75]
    s_add_u32 s37, s37, 12288
    v_xor_b32 v5, 64, v4
    v_mfma_f32_16x16x32_bf16 v[72:75], v[112:115], a[180:183], v[72:75]
    v_xor_b32 v6, 128, v4
    v_mfma_f32_16x16x32_bf16 v[76:79], v[108:111], a[160:163], v[76:79]
    v_xor_b32 v7, 192, v4
    s_cmp_eq_u32 s37, 159744
    v_mfma_f32_16x16x32_bf16 v[76:79], v[112:115], a[184:187], v[76:79]
    s_cselect_b32 s37, 0, s37
    v_mfma_f32_16x16x32_bf16 v[80:83], v[108:111], a[164:167], v[80:83]
    s_add_u32 s33, s33, 1
    v_mfma_f32_16x16x32_bf16 v[80:83], v[112:115], a[188:191], v[80:83]
    s_waitcnt vmcnt(23) lgkmcnt(0)
    s_barrier
    ds_read_b32 v154, v153 offset:256
    v_mfma_f32_16x16x32_bf16 v[60:63], v[116:119], a[192:195], v[60:63]
    ds_read_b128 v[84:87], v4 offset:0
    v_mfma_f32_16x16x32_bf16 v[60:63], v[120:123], a[216:219], v[60:63]
    ds_read_b128 v[88:91], v5 offset:0
    v_mfma_f32_16x16x32_bf16 v[64:67], v[116:119], a[196:199], v[64:67]
    ds_read_b128 v[92:95], v6 offset:0
    v_mfma_f32_16x16x32_bf16 v[64:67], v[120:123], a[220:223], v[64:67]
    ds_read_b128 v[96:99], v7 offset:0
    v_mfma_f32_16x16x32_bf16 v[68:71], v[116:119], a[200:203], v[68:71]
    ds_read_b128 v[100:103], v4 offset:256
    v_mfma_f32_16x16x32_bf16 v[68:71], v[120:123], a[224:227], v[68:71]
    s_waitcnt lgkmcnt(5)
    v_readfirstlane_b32 s44, v154
    v_mfma_f32_16x16x32_bf16 v[72:75], v[116:119], a[204:207], v[72:75]
    ds_read_b128 v[104:107], v5 offset:256
    v_mfma_f32_16x16x32_bf16 v[72:75], v[120:123], a[228:231], v[72:75]
    s_cmp_lt_u32 s44, 6291456
    s_cselect_b32 s53, s50, s52
    v_mfma_f32_16x16x32_bf16 v[76:79], v[116:119], a[208:211], v[76:79]
    s_and_b32 s54, s44, s51
    s_add_u32 s54, s54, s47
    v_mfma_f32_16x16x32_bf16 v[76:79], v[120:123], a[232:235], v[76:79]
    s_and_b32 s14, s53, 113246208
    v_mfma_f32_16x16x32_bf16 v[80:83], v[116:119], a[212:215], v[80:83]
    ds_read_b128 v[108:111], v6 offset:256
    v_mfma_f32_16x16x32_bf16 v[80:83], v[120:123], a[236:239], v[80:83]
    ds_read_b128 v[112:115], v7 offset:256
    v_mfma_f32_16x16x32_bf16 v[60:63], v[124:127], a[240:243], v[60:63]
    buffer_load_dwordx4 v1, s[12:15], s54 offen offset:0 nt lds
    v_mfma_f32_16x16x32_bf16 v[60:63], v[128:131], v[168:171], v[60:63]
    v_mfma_f32_16x16x32_bf16 v[64:67], v[124:127], a[244:247], v[64:67]
    v_mfma_f32_16x16x32_bf16 v[64:67], v[128:131], v[172:175], v[64:67]
    buffer_load_dwordx4 v2, s[12:15], s54 offen offset:1024 nt lds
    v_mfma_f32_16x16x32_bf16 v[68:71], v[124:127], a[248:251], v[68:71]
    v_mfma_f32_16x16x32_bf16 v[68:71], v[128:131], v[176:179], v[68:71]
    v_mfma_f32_16x16x32_bf16 v[72:75], v[124:127], a[252:255], v[72:75]
    buffer_load_dwordx4 v3, s[12:15], s54 offen offset:2048 nt lds
    v_mfma_f32_16x16x32_bf16 v[72:75], v[128:131], v[180:183], v[72:75]
    v_mfma_f32_16x16x32_bf16 v[76:79], v[124:127], v[160:163], v[76:79]
    v_mfma_f32_16x16x32_bf16 v[76:79], v[128:131], v[184:187], v[76:79]
    v_mfma_f32_16x16x32_bf16 v[80:83], v[124:127], v[164:167], v[80:83]
    s_cmp_lt_u32 s33, 4
    v_mfma_f32_16x16x32_bf16 v[80:83], v[128:131], v[188:191], v[80:83]
    s_cbranch_scc1 L_early2
    s_branch L_loop2
    .p2align 6
L_early3:
    s_waitcnt lgkmcnt(6)
    v_mfma_f32_16x16x32_bf16 v[36:39], v[84:87], a[0:3], v[12:15]
    s_add_u32 s55, s33, 63
    s_and_b32 s55, s55, 63
    v_mfma_f32_16x16x32_bf16 v[36:39], v[88:91], a[24:27], v[36:39]
    ds_read_b128 v[116:119], v4 offset:512
    v_mfma_f32_16x16x32_bf16 v[40:43], v[84:87], a[4:7], v[16:19]
    v_readlane_b32 s35, v148, s55
    v_mfma_f32_16x16x32_bf16 v[40:43], v[88:91], a[28:31], v[40:43]
    ds_read_b128 v[120:123], v5 offset:512
    v_mfma_f32_16x16x32_bf16 v[44:47], v[84:87], a[8:11], v[20:23]
    v_mfma_f32_16x16x32_bf16 v[44:47], v[88:91], a[32:35], v[44:47]
    ds_read_b128 v[124:127], v6 offset:512
    v_mfma_f32_16x16x32_bf16 v[48:51], v[84:87], a[12:15], v[24:27]
    v_mfma_f32_16x16x32_bf16 v[48:51], v[88:91], a[36:39], v[48:51]
    ds_read_b128 v[128:131], v7 offset:512
    v_mfma_f32_16x16x32_bf16 v[52:55], v[84:87], a[16:19], v[28:31]
    s_and_b32 m0, s46, 63
    s_and_b32 s39, s53, 12288
    v_mfma_f32_16x16x32_bf16 v[52:55], v[88:91], a[40:43], v[52:55]
    v_writelane_b32 v148, s54, m0
    s_add_u32 s36, s36, s39
    v_mfma_f32_16x16x32_bf16 v[56:59], v[84:87], a[20:23], v[32:35]
    s_cmp_eq_u32 s36, 159744
    v_mfma_f32_16x16x32_bf16 v[56:59], v[88:91], a[44:47], v[56:59]
    s_cselect_b32 s36, 0, s36
    s_waitcnt lgkmcnt(8)
    v_mfma_f32_16x16x32_bf16 v[36:39], v[92:95], a[48:51], v[36:39]
    s_sub_u32 s46, s46, s53
    s_and_b32 s39, s52, s43
    v_mfma_f32_16x16x32_bf16 v[36:39], v[96:99], a[72:75], v[36:39]
    s_add_u32 s34, s34, s39
    v_mfma_f32_16x16x32_bf16 v[40:43], v[92:95], a[52:55], v[40:43]
    s_min_u32 s49, s33, 63
    s_add_u32 m0, s36, s42
    v_mfma_f32_16x16x32_bf16 v[40:43], v[96:99], a[76:79], v[40:43]
    s_mov_b32 s14, 113246208
    buffer_load_dwordx4 v1, s[12:15], s34 offen offset:0 nt lds
    v_mfma_f32_16x16x32_bf16 v[44:47], v[92:95], a[56:59], v[44:47]
    buffer_load_dwordx4 v2, s[12:15], s34 offen offset:1024 nt lds
    v_mfma_f32_16x16x32_bf16 v[44:47], v[96:99], a[80:83], v[44:47]
    buffer_load_dwordx4 v3, s[12:15], s34 offen offset:2048 nt lds
    s_add_u32 s34, s34, s43
    v_mfma_f32_16x16x32_bf16 v[48:51], v[92:95], a[60:63], v[48:51]
    s_add_u32 s36, s36, 12288
    s_add_u32 s46, s46, 1
    v_mfma_f32_16x16x32_bf16 v[48:51], v[96:99], a[84:87], v[48:51]
    s_cmp_eq_u32 s36, 159744
    v_mfma_f32_16x16x32_bf16 v[52:55], v[92:95], a[64:67], v[52:55]
    s_cselect_b32 s36, 0, s36
    s_add_u32 m0, s36, s42
    v_mfma_f32_16x16x32_bf16 v[52:55], v[96:99], a[88:91], v[52:55]
    v_cvt_pk_bf16_f32 v132, v60, v64
    v_cvt_pk_bf16_f32 v133, v68, v72
    v_cvt_pk_bf16_f32 v134, v76, v80
    buffer_store_dwordx3 v[132:134], v9, s[20:23], s35 offen offset:0 sc1
    v_cvt_pk_bf16_f32 v136, v61, v65
    v_cvt_pk_bf16_f32 v137, v69, v73
    v_cvt_pk_bf16_f32 v138, v77, v81
    buffer_store_dwordx3 v[136:138], v9, s[20:23], s35 offen offset:768 sc1
    v_mfma_f32_16x16x32_bf16 v[56:59], v[92:95], a[68:71], v[56:59]
    s_mov_b32 s14, 113246208
    v_mfma_f32_16x16x32_bf16 v[56:59], v[96:99], a[92:95], v[56:59]
    buffer_load_dwordx4 v1, s[12:15], s34 offen offset:0 nt lds
    s_waitcnt lgkmcnt(6)
    v_mfma_f32_16x16x32_bf16 v[36:39], v[100:103], a[96:99], v[36:39]
    buffer_load_dwordx4 v2, s[12:15], s34 offen offset:1024 nt lds
    buffer_load_dwordx4 v3, s[12:15], s34 offen offset:2048 nt lds
    v_mfma_f32_16x16x32_bf16 v[36:39], v[104:107], a[120:123], v[36:39]
    s_add_u32 s34, s34, s43
    v_mfma_f32_16x16x32_bf16 v[40:43], v[100:103], a[100:103], v[40:43]
    s_add_u32 s36, s36, 12288
    s_add_u32 s46, s46, 1
    v_mfma_f32_16x16x32_bf16 v[40:43], v[104:107], a[124:127], v[40:43]
    s_cmp_eq_u32 s36, 159744
    s_cselect_b32 s36, 0, s36
    v_mfma_f32_16x16x32_bf16 v[44:47], v[100:103], a[104:107], v[44:47]
    s_add_u32 m0, s36, s42
    v_mfma_f32_16x16x32_bf16 v[44:47], v[104:107], a[128:131], v[44:47]
    s_mov_b32 s14, 113246208
    buffer_load_dwordx4 v1, s[12:15], s34 offen offset:0 nt lds
    v_mfma_f32_16x16x32_bf16 v[48:51], v[100:103], a[108:111], v[48:51]
    buffer_load_dwordx4 v2, s[12:15], s34 offen offset:1024 nt lds
    buffer_load_dwordx4 v3, s[12:15], s34 offen offset:2048 nt lds
    v_mfma_f32_16x16x32_bf16 v[48:51], v[104:107], a[132:135], v[48:51]
    s_add_u32 s34, s34, s43
    v_mfma_f32_16x16x32_bf16 v[52:55], v[100:103], a[112:115], v[52:55]
    s_add_u32 s36, s36, 12288
    s_add_u32 s46, s46, 1
    v_mfma_f32_16x16x32_bf16 v[52:55], v[104:107], a[136:139], v[52:55]
    v_cvt_pk_bf16_f32 v140, v62, v66
    v_cvt_pk_bf16_f32 v141, v70, v74
    v_cvt_pk_bf16_f32 v142, v78, v82
    buffer_store_dwordx3 v[140:142], v9, s[20:23], s35 offen offset:1536 sc1
    v_cvt_pk_bf16_f32 v144, v63, v67
    v_cvt_pk_bf16_f32 v145, v71, v75
    v_cvt_pk_bf16_f32 v146, v79, v83
    buffer_store_dwordx3 v[144:146], v9, s[20:23], s35 offen offset:2304 sc1
    v_mfma_f32_16x16x32_bf16 v[56:59], v[100:103], a[116:119], v[56:59]
    s_cmp_eq_u32 s36, 159744
    v_mfma_f32_16x16x32_bf16 v[56:59], v[104:107], a[140:143], v[56:59]
    s_cselect_b32 s36, 0, s36
    s_waitcnt lgkmcnt(4)
    v_mfma_f32_16x16x32_bf16 v[36:39], v[108:111], a[144:147], v[36:39]
    s_bitcmp1_b64 s[58:59], s49
    s_cselect_b32 s51, -1, 0
    v_mfma_f32_16x16x32_bf16 v[36:39], v[112:115], a[168:171], v[36:39]
    s_cselect_b32 s47, s48, s34
    v_mfma_f32_16x16x32_bf16 v[40:43], v[108:111], a[148:151], v[40:43]
    s_bitcmp1_b64 s[56:57], s49
    s_cselect_b32 s52, -1, 0
    v_mfma_f32_16x16x32_bf16 v[40:43], v[112:115], a[172:175], v[40:43]
    s_cmp_eq_u32 s38, -1
    s_cselect_b32 s50, s51, 0
    v_mfma_f32_16x16x32_bf16 v[44:47], v[108:111], a[152:155], v[44:47]
    s_or_b32 s50, s50, s52
    v_mfma_f32_16x16x32_bf16 v[44:47], v[112:115], a[176:179], v[44:47]
    s_add_u32 m0, s36, s42
    v_add_u32 v4, s37, v8
    v_mfma_f32_16x16x32_bf16 v[48:51], v[108:111], a[156:159], v[48:51]
    s_add_u32 s37, s37, 12288
    v_xor_b32 v5, 64, v4
    v_mfma_f32_16x16x32_bf16 v[48:51], v[112:115], a[180:183], v[48:51]
    v_xor_b32 v6, 128, v4
    v_mfma_f32_16x16x32_bf16 v[52:55], v[108:111], a[160:163], v[52:55]
    v_xor_b32 v7, 192, v4
    s_cmp_eq_u32 s37, 159744
    v_mfma_f32_16x16x32_bf16 v[52:55], v[112:115], a[184:187], v[52:55]
    s_cselect_b32 s37, 0, s37
    v_mfma_f32_16x16x32_bf16 v[56:59], v[108:111], a[164:167], v[56:59]
    s_add_u32 s33, s33, 1
    v_mfma_f32_16x16x32_bf16 v[56:59], v[112:115], a[188:191], v[56:59]
    s_waitcnt vmcnt(23) lgkmcnt(0)
    s_barrier
    ds_read_b32 v154, v153 offset:0
    v_mfma_f32_16x16x32_bf16 v[36:39], v[116:119], a[192:195], v[36:39]
    ds_read_b128 v[84:87], v4 offset:0
    v_mfma_f32_16x16x32_bf16 v[36:39], v[120:123], a[216:219], v[36:39]
    ds_read_b128 v[88:91], v5 offset:0
    v_mfma_f32_16x16x32_bf16 v[40:43], v[116:119], a[196:199], v[40:43]
    ds_read_b128 v[92:95], v6 offset:0
    v_mfma_f32_16x16x32_bf16 v[40:43], v[120:123], a[220:223], v[40:43]
    ds_read_b128 v[96:99], v7 offset:0
    v_mfma_f32_16x16x32_bf16 v[44:47], v[116:119], a[200:203], v[44:47]
    ds_read_b128 v[100:103], v4 offset:256
    v_mfma_f32_16x16x32_bf16 v[44:47], v[120:123], a[224:227], v[44:47]
    s_waitcnt lgkmcnt(5)
    v_readfirstlane_b32 s44, v154
    v_mfma_f32_16x16x32_bf16 v[48:51], v[116:119], a[204:207], v[48:51]
    ds_read_b128 v[104:107], v5 offset:256
    v_mfma_f32_16x16x32_bf16 v[48:51], v[120:123], a[228:231], v[48:51]
    s_cmp_lt_u32 s44, 6291456
    s_cselect_b32 s53, s50, s52
    v_mfma_f32_16x16x32_bf16 v[52:55], v[116:119], a[208:211], v[52:55]
    s_and_b32 s54, s44, s51
    s_add_u32 s54, s54, s47
    v_mfma_f32_16x16x32_bf16 v[52:55], v[120:123], a[232:235], v[52:55]
    s_and_b32 s14, s53, 113246208
    v_mfma_f32_16x16x32_bf16 v[56:59], v[116:119], a[212:215], v[56:59]
    ds_read_b128 v[108:111], v6 offset:256
    v_mfma_f32_16x16x32_bf16 v[56:59], v[120:123], a[236:239], v[56:59]
    ds_read_b128 v[112:115], v7 offset:256
    v_mfma_f32_16x16x32_bf16 v[36:39], v[124:127], a[240:243], v[36:39]
    v_mfma_f32_16x16x32_bf16 v[36:39], v[128:131], v[168:171], v[36:39]
    buffer_load_dwordx4 v1, s[12:15], s54 offen offset:0 nt lds
    v_mfma_f32_16x16x32_bf16 v[40:43], v[124:127], a[244:247], v[40:43]
    v_mfma_f32_16x16x32_bf16 v[40:43], v[128:131], v[172:175], v[40:43]
    v_mfma_f32_16x16x32_bf16 v[44:47], v[124:127], a[248:251], v[44:47]
    buffer_load_dwordx4 v2, s[12:15], s54 offen offset:1024 nt lds
    v_mfma_f32_16x16x32_bf16 v[44:47], v[128:131], v[176:179], v[44:47]
    v_mfma_f32_16x16x32_bf16 v[48:51], v[124:127], a[252:255], v[48:51]
    v_mfma_f32_16x16x32_bf16 v[48:51], v[128:131], v[180:183], v[48:51]
    buffer_load_dwordx4 v3, s[12:15], s54 offen offset:2048 nt lds
    v_mfma_f32_16x16x32_bf16 v[52:55], v[124:127], v[160:163], v[52:55]
    v_mfma_f32_16x16x32_bf16 v[52:55], v[128:131], v[184:187], v[52:55]
    v_mfma_f32_16x16x32_bf16 v[56:59], v[124:127], v[164:167], v[56:59]
    v_mfma_f32_16x16x32_bf16 v[56:59], v[128:131], v[188:191], v[56:59]
    s_waitcnt lgkmcnt(6)
    v_mfma_f32_16x16x32_bf16 v[60:63], v[84:87], a[0:3], v[12:15]
    s_add_u32 s55, s33, 63
    s_and_b32 s55, s55, 63
    v_mfma_f32_16x16x32_bf16 v[60:63], v[88:91], a[24:27], v[60:63]
    ds_read_b128 v[116:119], v4 offset:512
    v_mfma_f32_16x16x32_bf16 v[64:67], v[84:87], a[4:7], v[16:19]
    v_readlane_b32 s35, v148, s55
    v_mfma_f32_16x16x32_bf16 v[64:67], v[88:91], a[28:31], v[64:67]
    ds_read_b128 v[120:123], v5 offset:512
    v_mfma_f32_16x16x32_bf16 v[68:71], v[84:87], a[8:11], v[20:23]
    v_mfma_f32_16x16x32_bf16 v[68:71], v[88:91], a[32:35], v[68:71]
    ds_read_b128 v[124:127], v6 offset:512
    v_mfma_f32_16x16x32_bf16 v[72:75], v[84:87], a[12:15], v[24:27]
    v_mfma_f32_16x16x32_bf16 v[72:75], v[88:91], a[36:39], v[72:75]
    ds_read_b128 v[128:131], v7 offset:512
    v_mfma_f32_16x16x32_bf16 v[76:79], v[84:87], a[16:19], v[28:31]
    s_and_b32 m0, s46, 63
    s_and_b32 s39, s53, 12288
    v_mfma_f32_16x16x32_bf16 v[76:79], v[88:91], a[40:43], v[76:79]
    v_writelane_b32 v148, s54, m0
    s_add_u32 s36, s36, s39
    v_mfma_f32_16x16x32_bf16 v[80:83], v[84:87], a[20:23], v[32:35]
    s_cmp_eq_u32 s36, 159744
    v_mfma_f32_16x16x32_bf16 v[80:83], v[88:91], a[44:47], v[80:83]
    s_cselect_b32 s36, 0, s36
    s_waitcnt lgkmcnt(8)
    v_mfma_f32_16x16x32_bf16 v[60:63], v[92:95], a[48:51], v[60:63]
    s_sub_u32 s46, s46, s53
    s_and_b32 s39, s52, s43
    v_mfma_f32_16x16x32_bf16 v[60:63], v[96:99], a[72:75], v[60:63]
    s_add_u32 s34, s34, s39
    v_mfma_f32_16x16x32_bf16 v[64:67], v[92:95], a[52:55], v[64:67]
    s_min_u32 s49, s33, 63
    s_add_u32 m0, s36, s42
    v_mfma_f32_16x16x32_bf16 v[64:67], v[96:99], a[76:79], v[64:67]
    s_mov_b32 s14, 113246208
    buffer_load_dwordx4 v1, s[12:15], s34 offen offset:0 nt lds
    v_mfma_f32_16x16x32_bf16 v[68:71], v[92:95], a[56:59], v[68:71]
    buffer_load_dwordx4 v2, s[12:15], s34 offen offset:1024 nt lds
    v_mfma_f32_16x16x32_bf16 v[68:71], v[96:99], a[80:83], v[68:71]
    buffer_load_dwordx4 v3, s[12:15], s34 offen offset:2048 nt lds
    s_add_u32 s34, s34, s43
    v_mfma_f32_16x16x32_bf16 v[72:75], v[92:95], a[60:63], v[72:75]
    s_add_u32 s36, s36, 12288
    s_add_u32 s46, s46, 1
    v_mfma_f32_16x16x32_bf16 v[72:75], v[96:99], a[84:87], v[72:75]
    s_cmp_eq_u32 s36, 159744
    v_mfma_f32_16x16x32_bf16 v[76:79], v[92:95], a[64:67], v[76:79]
    s_cselect_b32 s36, 0, s36
    s_add_u32 m0, s36, s42
    v_mfma_f32_16x16x32_bf16 v[76:79], v[96:99], a[88:91], v[76:79]
    v_cvt_pk_bf16_f32 v132, v36, v40
    v_cvt_pk_bf16_f32 v133, v44, v48
    v_cvt_pk_bf16_f32 v134, v52, v56
    buffer_store_dwordx3 v[132:134], v9, s[20:23], s35 offen offset:0 sc1
    v_cvt_pk_bf16_f32 v136, v37, v41
    v_cvt_pk_bf16_f32 v137, v45, v49
    v_cvt_pk_bf16_f32 v138, v53, v57
    buffer_store_dwordx3 v[136:138], v9, s[20:23], s35 offen offset:768 sc1
    v_mfma_f32_16x16x32_bf16 v[80:83], v[92:95], a[68:71], v[80:83]
    s_mov_b32 s14, 113246208
    v_mfma_f32_16x16x32_bf16 v[80:83], v[96:99], a[92:95], v[80:83]
    buffer_load_dwordx4 v1, s[12:15], s34 offen offset:0 nt lds
    s_waitcnt lgkmcnt(6)
    v_mfma_f32_16x16x32_bf16 v[60:63], v[100:103], a[96:99], v[60:63]
    buffer_load_dwordx4 v2, s[12:15], s34 offen offset:1024 nt lds
    buffer_load_dwordx4 v3, s[12:15], s34 offen offset:2048 nt lds
    v_mfma_f32_16x16x32_bf16 v[60:63], v[104:107], a[120:123], v[60:63]
    s_add_u32 s34, s34, s43
    v_mfma_f32_16x16x32_bf16 v[64:67], v[100:103], a[100:103], v[64:67]
    s_add_u32 s36, s36, 12288
    s_add_u32 s46, s46, 1
    v_mfma_f32_16x16x32_bf16 v[64:67], v[104:107], a[124:127], v[64:67]
    s_cmp_eq_u32 s36, 159744
    s_cselect_b32 s36, 0, s36
    v_mfma_f32_16x16x32_bf16 v[68:71], v[100:103], a[104:107], v[68:71]
    s_add_u32 m0, s36, s42
    v_mfma_f32_16x16x32_bf16 v[68:71], v[104:107], a[128:131], v[68:71]
    s_mov_b32 s14, 113246208
    buffer_load_dwordx4 v1, s[12:15], s34 offen offset:0 nt lds
    v_mfma_f32_16x16x32_bf16 v[72:75], v[100:103], a[108:111], v[72:75]
    buffer_load_dwordx4 v2, s[12:15], s34 offen offset:1024 nt lds
    buffer_load_dwordx4 v3, s[12:15], s34 offen offset:2048 nt lds
    v_mfma_f32_16x16x32_bf16 v[72:75], v[104:107], a[132:135], v[72:75]
    s_add_u32 s34, s34, s43
    v_mfma_f32_16x16x32_bf16 v[76:79], v[100:103], a[112:115], v[76:79]
    s_add_u32 s36, s36, 12288
    s_add_u32 s46, s46, 1
    v_mfma_f32_16x16x32_bf16 v[76:79], v[104:107], a[136:139], v[76:79]
    v_cvt_pk_bf16_f32 v140, v38, v42
    v_cvt_pk_bf16_f32 v141, v46, v50
    v_cvt_pk_bf16_f32 v142, v54, v58
    buffer_store_dwordx3 v[140:142], v9, s[20:23], s35 offen offset:1536 sc1
    v_cvt_pk_bf16_f32 v144, v39, v43
    v_cvt_pk_bf16_f32 v145, v47, v51
    v_cvt_pk_bf16_f32 v146, v55, v59
    buffer_store_dwordx3 v[144:146], v9, s[20:23], s35 offen offset:2304 sc1
    v_mfma_f32_16x16x32_bf16 v[80:83], v[100:103], a[116:119], v[80:83]
    s_cmp_eq_u32 s36, 159744
    v_mfma_f32_16x16x32_bf16 v[80:83], v[104:107], a[140:143], v[80:83]
    s_cselect_b32 s36, 0, s36
    s_waitcnt lgkmcnt(4)
    v_mfma_f32_16x16x32_bf16 v[60:63], v[108:111], a[144:147], v[60:63]
    s_bitcmp1_b64 s[58:59], s49
    s_cselect_b32 s51, -1, 0
    v_mfma_f32_16x16x32_bf16 v[60:63], v[112:115], a[168:171], v[60:63]
    s_cselect_b32 s47, s48, s34
    v_mfma_f32_16x16x32_bf16 v[64:67], v[108:111], a[148:151], v[64:67]
    s_bitcmp1_b64 s[56:57], s49
    s_cselect_b32 s52, -1, 0
    v_mfma_f32_16x16x32_bf16 v[64:67], v[112:115], a[172:175], v[64:67]
    s_cmp_eq_u32 s38, -1
    s_cselect_b32 s50, s51, 0
    v_mfma_f32_16x16x32_bf16 v[68:71], v[108:111], a[152:155], v[68:71]
    s_or_b32 s50, s50, s52
    v_mfma_f32_16x16x32_bf16 v[68:71], v[112:115], a[176:179], v[68:71]
    s_add_u32 m0, s36, s42
    v_add_u32 v4, s37, v8
    v_mfma_f32_16x16x32_bf16 v[72:75], v[108:111], a[156:159], v[72:75]
    s_add_u32 s37, s37, 12288
    v_xor_b32 v5, 64, v4
    v_mfma_f32_16x16x32_bf16 v[72:75], v[112:115], a[180:183], v[72:75]
    v_xor_b32 v6, 128, v4
    v_mfma_f32_16x16x32_bf16 v[76:79], v[108:111], a[160:163], v[76:79]
    v_xor_b32 v7, 192, v4
    s_cmp_eq_u32 s37, 159744
    v_mfma_f32_16x16x32_bf16 v[76:79], v[112:115], a[184:187], v[76:79]
    s_cselect_b32 s37, 0, s37
    v_mfma_f32_16x16x32_bf16 v[80:83], v[108:111], a[164:167], v[80:83]
    s_add_u32 s33, s33, 1
    v_mfma_f32_16x16x32_bf16 v[80:83], v[112:115], a[188:191], v[80:83]
    s_waitcnt vmcnt(23) lgkmcnt(0)
    s_barrier
    ds_read_b32 v154, v153 offset:256
    v_mfma_f32_16x16x32_bf16 v[60:63], v[116:119], a[192:195], v[60:63]
    ds_read_b128 v[84:87], v4 offset:0
    v_mfma_f32_16x16x32_bf16 v[60:63], v[120:123], a[216:219], v[60:63]
    ds_read_b128 v[88:91], v5 offset:0
    v_mfma_f32_16x16x32_bf16 v[64:67], v[116:119], a[196:199], v[64:67]
    ds_read_b128 v[92:95], v6 offset:0
    v_mfma_f32_16x16x32_bf16 v[64:67], v[120:123], a[220:223], v[64:67]
    ds_read_b128 v[96:99], v7 offset:0
    v_mfma_f32_16x16x32_bf16 v[68:71], v[116:119], a[200:203], v[68:71]
    ds_read_b128 v[100:103], v4 offset:256
    v_mfma_f32_16x16x32_bf16 v[68:71], v[120:123], a[224:227], v[68:71]
    s_waitcnt lgkmcnt(5)
    v_readfirstlane_b32 s44, v154
    v_mfma_f32_16x16x32_bf16 v[72:75], v[116:119], a[204:207], v[72:75]
    ds_read_b128 v[104:107], v5 offset:256
    v_mfma_f32_16x16x32_bf16 v[72:75], v[120:123], a[228:231], v[72:75]
    s_cmp_lt_u32 s44, 6291456
    s_cselect_b32 s53, s50, s52
    v_mfma_f32_16x16x32_bf16 v[76:79], v[116:119], a[208:211], v[76:79]
    s_and_b32 s54, s44, s51
    s_add_u32 s54, s54, s47
    v_mfma_f32_16x16x32_bf16 v[76:79], v[120:123], a[232:235], v[76:79]
    s_and_b32 s14, s53, 113246208
    v_mfma_f32_16x16x32_bf16 v[80:83], v[116:119], a[212:215], v[80:83]
    ds_read_b128 v[108:111], v6 offset:256
    v_mfma_f32_16x16x32_bf16 v[80:83], v[120:123], a[236:239], v[80:83]
    ds_read_b128 v[112:115], v7 offset:256
    v_mfma_f32_16x16x32_bf16 v[60:63], v[124:127], a[240:243], v[60:63]
    v_mfma_f32_16x16x32_bf16 v[60:63], v[128:131], v[168:171], v[60:63]
    buffer_load_dwordx4 v1, s[12:15], s54 offen offset:0 nt lds
    v_mfma_f32_16x16x32_bf16 v[64:67], v[124:127], a[244:247], v[64:67]
    v_mfma_f32_16x16x32_bf16 v[64:67], v[128:131], v[172:175], v[64:67]
    v_mfma_f32_16x16x32_bf16 v[68:71], v[124:127], a[248:251], v[68:71]
    buffer_load_dwordx4 v2, s[12:15], s54 offen offset:1024 nt lds
    v_mfma_f32_16x16x32_bf16 v[68:71], v[128:131], v[176:179], v[68:71]
    v_mfma_f32_16x16x32_bf16 v[72:75], v[124:127], a[252:255], v[72:75]
    v_mfma_f32_16x16x32_bf16 v[72:75], v[128:131], v[180:183], v[72:75]
    buffer_load_dwordx4 v3, s[12:15], s54 offen offset:2048 nt lds
    v_mfma_f32_16x16x32_bf16 v[76:79], v[124:127], v[160:163], v[76:79]
    v_mfma_f32_16x16x32_bf16 v[76:79], v[128:131], v[184:187], v[76:79]
    v_mfma_f32_16x16x32_bf16 v[80:83], v[124:127], v[164:167], v[80:83]
    s_cmp_lt_u32 s33, 4
    v_mfma_f32_16x16x32_bf16 v[80:83], v[128:131], v[188:191], v[80:83]
    s_cbranch_scc1 L_early3
    s_branch L_loop3
L_k0:
    s_waitcnt vmcnt(15)
    ds_write_b32 v152, v150 offset:0
    s_branch L_kr0
L_k1:
    s_waitcnt vmcnt(15)
    ds_write_b32 v152, v151 offset:256
    s_branch L_kr1
L_ev0:
    s_waitcnt vmcnt(15)
    v_readfirstlane_b32 s39, v150
    s_mov_b32 s30, 256
    s_cmp_eq_u32 s66, 0
    s_cbranch_scc1 L_chk0
    v_add_u32 v149, 8, v149
    s_mov_b32 s66, 0
    s_cmp_lg_u32 s39, 0
    s_cbranch_scc1 L_evr0
    s_mov_b32 s24, s74
    s_mov_b32 s25, s75
    s_mov_b32 s26, 1065984
    v_and_b32 v154, 0xff000000, v149
    v_add_u32 v154, s70, v154
    v_mov_b32 v155, 0
    buffer_store_dword v155, v154, s[24:27], 0 offen sc0 sc1
    v_mov_b32 v156, 1
    s_waitcnt vmcnt(0)
    buffer_atomic_add v156, v149, s[28:31], 0 offen sc1
    s_branch L_evr0
L_chk0:
    s_cmp_lg_u32 s39, 0
    s_cbranch_scc1 L_ok0
    s_add_u32 s67, s67, 1
    s_cmp_gt_u32 s67, 20000
    s_cbranch_scc1 L_ok0
    v_mov_b32 v154, 0
    buffer_atomic_add v154, v149, s[28:31], 0 offen sc0 sc1
    s_waitcnt vmcnt(0)
    v_readfirstlane_b32 s39, v154
    s_nop 1
    s_branch L_chk0
L_ok0:
    s_mov_b32 s28, s74
    s_mov_b32 s29, s75
    s_mov_b32 s67, 1065984
    s_mov_b32 s66, 12288
    v_and_b32 v149, 0xff000000, v149
    v_add_u32 v149, s70, v149
    s_branch L_evr0
L_ev1:
    s_waitcnt vmcnt(15)
    v_readfirstlane_b32 s39, v151
    s_mov_b32 s30, 256
    s_cmp_eq_u32 s66, 0
    s_cbranch_scc1 L_chk1
    v_add_u32 v149, 8, v149
    s_mov_b32 s66, 0
    s_cmp_lg_u32 s39, 0
    s_cbranch_scc1 L_evr1
    s_mov_b32 s24, s74
    s_mov_b32 s25, s75
    s_mov_b32 s26, 1065984
    v_and_b32 v154, 0xff000000, v149
    v_add_u32 v154, s70, v154
    v_mov_b32 v155, 0
    buffer_store_dword v155, v154, s[24:27], 0 offen sc0 sc1
    v_mov_b32 v156, 1
    s_waitcnt vmcnt(0)
    buffer_atomic_add v156, v149, s[28:31], 0 offen sc1
    s_branch L_evr1
L_chk1:
    s_cmp_lg_u32 s39, 0
    s_cbranch_scc1 L_ok1
    s_add_u32 s67, s67, 1
    s_cmp_gt_u32 s67, 20000
    s_cbranch_scc1 L_ok1
    v_mov_b32 v154, 0
    buffer_atomic_add v154, v149, s[28:31], 0 offen sc0 sc1
    s_waitcnt vmcnt(0)
    v_readfirstlane_b32 s39, v154
    s_nop 1
    s_branch L_chk1
L_ok1:
    s_mov_b32 s28, s74
    s_mov_b32 s29, s75
    s_mov_b32 s67, 1065984
    s_mov_b32 s66, 12288
    v_and_b32 v149, 0xff000000, v149
    v_add_u32 v149, s70, v149
    s_branch L_evr1
L_drain1:
    s_waitcnt lgkmcnt(6)
    v_mfma_f32_16x16x32_bf16 v[60:63], v[84:87], a[0:3], v[12:15]
    v_mfma_f32_16x16x32_bf16 v[60:63], v[88:91], a[24:27], v[60:63]
    ds_read_b128 v[116:119], v4 offset:512
    v_mfma_f32_16x16x32_bf16 v[64:67], v[84:87], a[4:7], v[16:19]
    v_mfma_f32_16x16x32_bf16 v[64:67], v[88:91], a[28:31], v[64:67]
    ds_read_b128 v[120:123], v5 offset:512
    v_mfma_f32_16x16x32_bf16 v[68:71], v[84:87], a[8:11], v[20:23]
    v_mfma_f32_16x16x32_bf16 v[68:71], v[88:91], a[32:35], v[68:71]
    ds_read_b128 v[124:127], v6 offset:512
    v_mfma_f32_16x16x32_bf16 v[72:75], v[84:87], a[12:15], v[24:27]
    v_mfma_f32_16x16x32_bf16 v[72:75], v[88:91], a[36:39], v[72:75]
    ds_read_b128 v[128:131], v7 offset:512
    v_mfma_f32_16x16x32_bf16 v[76:79], v[84:87], a[16:19], v[28:31]
    v_cvt_pk_bf16_f32 v192, v36, v40
    v_mfma_f32_16x16x32_bf16 v[76:79], v[88:91], a[40:43], v[76:79]
    v_cvt_pk_bf16_f32 v193, v44, v48
    v_mfma_f32_16x16x32_bf16 v[80:83], v[84:87], a[20:23], v[32:35]
    v_cvt_pk_bf16_f32 v194, v52, v56
    v_mfma_f32_16x16x32_bf16 v[80:83], v[88:91], a[44:47], v[80:83]
    v_cvt_pk_bf16_f32 v196, v37, v41
    s_waitcnt lgkmcnt(8)
    v_mfma_f32_16x16x32_bf16 v[60:63], v[92:95], a[48:51], v[60:63]
    v_cvt_pk_bf16_f32 v197, v45, v49
    v_mfma_f32_16x16x32_bf16 v[60:63], v[96:99], a[72:75], v[60:63]
    v_cvt_pk_bf16_f32 v198, v53, v57
    v_mfma_f32_16x16x32_bf16 v[64:67], v[92:95], a[52:55], v[64:67]
    v_cvt_pk_bf16_f32 v200, v38, v42
    v_mfma_f32_16x16x32_bf16 v[64:67], v[96:99], a[76:79], v[64:67]
    v_cvt_pk_bf16_f32 v201, v46, v50
    v_mfma_f32_16x16x32_bf16 v[68:71], v[92:95], a[56:59], v[68:71]
    v_cvt_pk_bf16_f32 v202, v54, v58
    v_mfma_f32_16x16x32_bf16 v[68:71], v[96:99], a[80:83], v[68:71]
    v_cvt_pk_bf16_f32 v204, v39, v43
    v_mfma_f32_16x16x32_bf16 v[72:75], v[92:95], a[60:63], v[72:75]
    v_cvt_pk_bf16_f32 v205, v47, v51
    v_mfma_f32_16x16x32_bf16 v[72:75], v[96:99], a[84:87], v[72:75]
    v_cvt_pk_bf16_f32 v206, v55, v59
    v_mfma_f32_16x16x32_bf16 v[76:79], v[92:95], a[64:67], v[76:79]
    v_add_u32 v4, s37, v8
    v_mfma_f32_16x16x32_bf16 v[76:79], v[96:99], a[88:91], v[76:79]
    v_xor_b32 v5, 64, v4
    v_mfma_f32_16x16x32_bf16 v[80:83], v[92:95], a[68:71], v[80:83]
    v_xor_b32 v6, 128, v4
    v_mfma_f32_16x16x32_bf16 v[80:83], v[96:99], a[92:95], v[80:83]
    v_xor_b32 v7, 192, v4
    s_waitcnt lgkmcnt(6)
    v_mfma_f32_16x16x32_bf16 v[60:63], v[100:103], a[96:99], v[60:63]
    s_add_u32 s55, s33, 63
    v_mfma_f32_16x16x32_bf16 v[60:63], v[104:107], a[120:123], v[60:63]
    s_and_b32 s55, s55, 63
    v_mfma_f32_16x16x32_bf16 v[64:67], v[100:103], a[100:103], v[64:67]
    v_readlane_b32 s44, v148, s55
    v_mfma_f32_16x16x32_bf16 v[64:67], v[104:107], a[124:127], v[64:67]
    s_add_u32 s55, s33, 64
    v_mfma_f32_16x16x32_bf16 v[68:71], v[100:103], a[104:107], v[68:71]
    s_and_b32 s55, s55, 63
    v_mfma_f32_16x16x32_bf16 v[68:71], v[104:107], a[128:131], v[68:71]
    v_readlane_b32 s45, v148, s55
    v_mfma_f32_16x16x32_bf16 v[72:75], v[100:103], a[108:111], v[72:75]
    s_add_u32 s55, s33, 65
    v_mfma_f32_16x16x32_bf16 v[72:75], v[104:107], a[132:135], v[72:75]
    s_and_b32 s55, s55, 63
    v_mfma_f32_16x16x32_bf16 v[76:79], v[100:103], a[112:115], v[76:79]
    v_readlane_b32 s35, v148, s55
    v_mfma_f32_16x16x32_bf16 v[76:79], v[104:107], a[136:139], v[76:79]
    v_mfma_f32_16x16x32_bf16 v[80:83], v[100:103], a[116:119], v[80:83]
    v_mfma_f32_16x16x32_bf16 v[80:83], v[104:107], a[140:143], v[80:83]
    s_waitcnt lgkmcnt(4)
    v_mfma_f32_16x16x32_bf16 v[60:63], v[108:111], a[144:147], v[60:63]
    v_mfma_f32_16x16x32_bf16 v[60:63], v[112:115], a[168:171], v[60:63]
    v_mfma_f32_16x16x32_bf16 v[64:67], v[108:111], a[148:151], v[64:67]
    v_mfma_f32_16x16x32_bf16 v[64:67], v[112:115], a[172:175], v[64:67]
    v_mfma_f32_16x16x32_bf16 v[68:71], v[108:111], a[152:155], v[68:71]
    v_mfma_f32_16x16x32_bf16 v[68:71], v[112:115], a[176:179], v[68:71]
    v_mfma_f32_16x16x32_bf16 v[72:75], v[108:111], a[156:159], v[72:75]
    v_mfma_f32_16x16x32_bf16 v[72:75], v[112:115], a[180:183], v[72:75]
    v_mfma_f32_16x16x32_bf16 v[76:79], v[108:111], a[160:163], v[76:79]
    v_mfma_f32_16x16x32_bf16 v[76:79], v[112:115], a[184:187], v[76:79]
    v_mfma_f32_16x16x32_bf16 v[80:83], v[108:111], a[164:167], v[80:83]
    v_mfma_f32_16x16x32_bf16 v[80:83], v[112:115], a[188:191], v[80:83]
    s_waitcnt vmcnt(7) lgkmcnt(0)
    s_barrier
    v_mfma_f32_16x16x32_bf16 v[60:63], v[116:119], a[192:195], v[60:63]
    ds_read_b128 v[84:87], v4 offset:0
    v_mfma_f32_16x16x32_bf16 v[60:63], v[120:123], a[216:219], v[60:63]
    ds_read_b128 v[88:91], v5 offset:0
    v_mfma_f32_16x16x32_bf16 v[64:67], v[116:119], a[196:199], v[64:67]
    ds_read_b128 v[92:95], v6 offset:0
    v_mfma_f32_16x16x32_bf16 v[64:67], v[120:123], a[220:223], v[64:67]
    ds_read_b128 v[96:99], v7 offset:0
    v_mfma_f32_16x16x32_bf16 v[68:71], v[116:119], a[200:203], v[68:71]
    ds_read_b128 v[100:103], v4 offset:256
    v_mfma_f32_16x16x32_bf16 v[68:71], v[120:123], a[224:227], v[68:71]
    ds_read_b128 v[104:107], v5 offset:256
    v_mfma_f32_16x16x32_bf16 v[72:75], v[116:119], a[204:207], v[72:75]
    ds_read_b128 v[108:111], v6 offset:256
    v_mfma_f32_16x16x32_bf16 v[72:75], v[120:123], a[228:231], v[72:75]
    ds_read_b128 v[112:115], v7 offset:256
    v_mfma_f32_16x16x32_bf16 v[76:79], v[116:119], a[208:211], v[76:79]
    v_mfma_f32_16x16x32_bf16 v[76:79], v[120:123], a[232:235], v[76:79]
    v_mfma_f32_16x16x32_bf16 v[80:83], v[116:119], a[212:215], v[80:83]
    v_mfma_f32_16x16x32_bf16 v[80:83], v[120:123], a[236:239], v[80:83]
    v_mfma_f32_16x16x32_bf16 v[60:63], v[124:127], a[240:243], v[60:63]
    v_mfma_f32_16x16x32_bf16 v[60:63], v[128:131], v[168:171], v[60:63]
    v_mfma_f32_16x16x32_bf16 v[64:67], v[124:127], a[244:247], v[64:67]
    v_mfma_f32_16x16x32_bf16 v[64:67], v[128:131], v[172:175], v[64:67]
    v_mfma_f32_16x16x32_bf16 v[68:71], v[124:127], a[248:251], v[68:71]
    v_mfma_f32_16x16x32_bf16 v[68:71], v[128:131], v[176:179], v[68:71]
    v_mfma_f32_16x16x32_bf16 v[72:75], v[124:127], a[252:255], v[72:75]
    v_mfma_f32_16x16x32_bf16 v[72:75], v[128:131], v[180:183], v[72:75]
    v_mfma_f32_16x16x32_bf16 v[76:79], v[124:127], v[160:163], v[76:79]
    v_mfma_f32_16x16x32_bf16 v[76:79], v[128:131], v[184:187], v[76:79]
    v_mfma_f32_16x16x32_bf16 v[80:83], v[124:127], v[164:167], v[80:83]
    v_mfma_f32_16x16x32_bf16 v[80:83], v[128:131], v[188:191], v[80:83]
    s_waitcnt lgkmcnt(6)
    v_mfma_f32_16x16x32_bf16 v[36:39], v[84:87], a[0:3], v[12:15]
    v_mfma_f32_16x16x32_bf16 v[36:39], v[88:91], a[24:27], v[36:39]
    ds_read_b128 v[116:119], v4 offset:512
    v_mfma_f32_16x16x32_bf16 v[40:43], v[84:87], a[4:7], v[16:19]
    v_mfma_f32_16x16x32_bf16 v[40:43], v[88:91], a[28:31], v[40:43]
    ds_read_b128 v[120:123], v5 offset:512
    v_mfma_f32_16x16x32_bf16 v[44:47], v[84:87], a[8:11], v[20:23]
    v_mfma_f32_16x16x32_bf16 v[44:47], v[88:91], a[32:35], v[44:47]
    ds_read_b128 v[124:127], v6 offset:512
    v_mfma_f32_16x16x32_bf16 v[48:51], v[84:87], a[12:15], v[24:27]
    v_mfma_f32_16x16x32_bf16 v[48:51], v[88:91], a[36:39], v[48:51]
    ds_read_b128 v[128:131], v7 offset:512
    v_mfma_f32_16x16x32_bf16 v[52:55], v[84:87], a[16:19], v[28:31]
    v_cvt_pk_bf16_f32 v208, v60, v64
    v_mfma_f32_16x16x32_bf16 v[52:55], v[88:91], a[40:43], v[52:55]
    v_cvt_pk_bf16_f32 v209, v68, v72
    v_mfma_f32_16x16x32_bf16 v[56:59], v[84:87], a[20:23], v[32:35]
    v_cvt_pk_bf16_f32 v210, v76, v80
    v_mfma_f32_16x16x32_bf16 v[56:59], v[88:91], a[44:47], v[56:59]
    v_cvt_pk_bf16_f32 v212, v61, v65
    s_waitcnt lgkmcnt(8)
    v_mfma_f32_16x16x32_bf16 v[36:39], v[92:95], a[48:51], v[36:39]
    v_cvt_pk_bf16_f32 v213, v69, v73
    v_mfma_f32_16x16x32_bf16 v[36:39], v[96:99], a[72:75], v[36:39]
    v_cvt_pk_bf16_f32 v214, v77, v81
    v_mfma_f32_16x16x32_bf16 v[40:43], v[92:95], a[52:55], v[40:43]
    v_cvt_pk_bf16_f32 v216, v62, v66
    v_mfma_f32_16x16x32_bf16 v[40:43], v[96:99], a[76:79], v[40:43]
    v_cvt_pk_bf16_f32 v217, v70, v74
    v_mfma_f32_16x16x32_bf16 v[44:47], v[92:95], a[56:59], v[44:47]
    v_cvt_pk_bf16_f32 v218, v78, v82
    v_mfma_f32_16x16x32_bf16 v[44:47], v[96:99], a[80:83], v[44:47]
    v_cvt_pk_bf16_f32 v220, v63, v67
    v_mfma_f32_16x16x32_bf16 v[48:51], v[92:95], a[60:63], v[48:51]
    v_cvt_pk_bf16_f32 v221, v71, v75
    v_mfma_f32_16x16x32_bf16 v[48:51], v[96:99], a[84:87], v[48:51]
    v_cvt_pk_bf16_f32 v222, v79, v83
    v_mfma_f32_16x16x32_bf16 v[52:55], v[92:95], a[64:67], v[52:55]
    v_mfma_f32_16x16x32_bf16 v[52:55], v[96:99], a[88:91], v[52:55]
    v_mfma_f32_16x16x32_bf16 v[56:59], v[92:95], a[68:71], v[56:59]
    v_mfma_f32_16x16x32_bf16 v[56:59], v[96:99], a[92:95], v[56:59]
    s_waitcnt lgkmcnt(6)
    v_mfma_f32_16x16x32_bf16 v[36:39], v[100:103], a[96:99], v[36:39]
    v_mfma_f32_16x16x32_bf16 v[36:39], v[104:107], a[120:123], v[36:39]
    v_mfma_f32_16x16x32_bf16 v[40:43], v[100:103], a[100:103], v[40:43]
    v_mfma_f32_16x16x32_bf16 v[40:43], v[104:107], a[124:127], v[40:43]
    v_mfma_f32_16x16x32_bf16 v[44:47], v[100:103], a[104:107], v[44:47]
    v_mfma_f32_16x16x32_bf16 v[44:47], v[104:107], a[128:131], v[44:47]
    v_mfma_f32_16x16x32_bf16 v[48:51], v[100:103], a[108:111], v[48:51]
    v_mfma_f32_16x16x32_bf16 v[48:51], v[104:107], a[132:135], v[48:51]
    v_mfma_f32_16x16x32_bf16 v[52:55], v[100:103], a[112:115], v[52:55]
    v_mfma_f32_16x16x32_bf16 v[52:55], v[104:107], a[136:139], v[52:55]
    v_mfma_f32_16x16x32_bf16 v[56:59], v[100:103], a[116:119], v[56:59]
    v_mfma_f32_16x16x32_bf16 v[56:59], v[104:107], a[140:143], v[56:59]
    s_waitcnt lgkmcnt(4)
    v_mfma_f32_16x16x32_bf16 v[36:39], v[108:111], a[144:147], v[36:39]
    v_mfma_f32_16x16x32_bf16 v[36:39], v[112:115], a[168:171], v[36:39]
    v_mfma_f32_16x16x32_bf16 v[40:43], v[108:111], a[148:151], v[40:43]
    v_mfma_f32_16x16x32_bf16 v[40:43], v[112:115], a[172:175], v[40:43]
    v_mfma_f32_16x16x32_bf16 v[44:47], v[108:111], a[152:155], v[44:47]
    v_mfma_f32_16x16x32_bf16 v[44:47], v[112:115], a[176:179], v[44:47]
    v_mfma_f32_16x16x32_bf16 v[48:51], v[108:111], a[156:159], v[48:51]
    v_mfma_f32_16x16x32_bf16 v[48:51], v[112:115], a[180:183], v[48:51]
    v_mfma_f32_16x16x32_bf16 v[52:55], v[108:111], a[160:163], v[52:55]
    v_mfma_f32_16x16x32_bf16 v[52:55], v[112:115], a[184:187], v[52:55]
    v_mfma_f32_16x16x32_bf16 v[56:59], v[108:111], a[164:167], v[56:59]
    v_mfma_f32_16x16x32_bf16 v[56:59], v[112:115], a[188:191], v[56:59]
    s_waitcnt lgkmcnt(2)
    v_mfma_f32_16x16x32_bf16 v[36:39], v[116:119], a[192:195], v[36:39]
    buffer_store_dwordx3 v[192:194], v9, s[20:23], s44 offen offset:0 sc1
    v_mfma_f32_16x16x32_bf16 v[36:39], v[120:123], a[216:219], v[36:39]
    v_mfma_f32_16x16x32_bf16 v[40:43], v[116:119], a[196:199], v[40:43]
    v_mfma_f32_16x16x32_bf16 v[40:43], v[120:123], a[220:223], v[40:43]
    buffer_store_dwordx3 v[196:198], v9, s[20:23], s44 offen offset:768 sc1
    v_mfma_f32_16x16x32_bf16 v[44:47], v[116:119], a[200:203], v[44:47]
    v_mfma_f32_16x16x32_bf16 v[44:47], v[120:123], a[224:227], v[44:47]
    v_mfma_f32_16x16x32_bf16 v[48:51], v[116:119], a[204:207], v[48:51]
    buffer_store_dwordx3 v[200:202], v9, s[20:23], s44 offen offset:1536 sc1
    v_mfma_f32_16x16x32_bf16 v[48:51], v[120:123], a[228:231], v[48:51]
    v_mfma_f32_16x16x32_bf16 v[52:55], v[116:119], a[208:211], v[52:55]
    v_mfma_f32_16x16x32_bf16 v[52:55], v[120:123], a[232:235], v[52:55]
    buffer_store_dwordx3 v[204:206], v9, s[20:23], s44 offen offset:2304 sc1
    v_mfma_f32_16x16x32_bf16 v[56:59], v[116:119], a[212:215], v[56:59]
    v_mfma_f32_16x16x32_bf16 v[56:59], v[120:123], a[236:239], v[56:59]
    s_waitcnt lgkmcnt(0)
    v_mfma_f32_16x16x32_bf16 v[36:39], v[124:127], a[240:243], v[36:39]
    buffer_store_dwordx3 v[208:210], v9, s[20:23], s45 offen offset:0 sc1
    v_mfma_f32_16x16x32_bf16 v[36:39], v[128:131], v[168:171], v[36:39]
    v_mfma_f32_16x16x32_bf16 v[40:43], v[124:127], a[244:247], v[40:43]
    v_mfma_f32_16x16x32_bf16 v[40:43], v[128:131], v[172:175], v[40:43]
    buffer_store_dwordx3 v[212:214], v9, s[20:23], s45 offen offset:768 sc1
    v_mfma_f32_16x16x32_bf16 v[44:47], v[124:127], a[248:251], v[44:47]
    v_mfma_f32_16x16x32_bf16 v[44:47], v[128:131], v[176:179], v[44:47]
    v_mfma_f32_16x16x32_bf16 v[48:51], v[124:127], a[252:255], v[48:51]
    buffer_store_dwordx3 v[216:218], v9, s[20:23], s45 offen offset:1536 sc1
    v_mfma_f32_16x16x32_bf16 v[48:51], v[128:131], v[180:183], v[48:51]
    v_mfma_f32_16x16x32_bf16 v[52:55], v[124:127], v[160:163], v[52:55]
    v_mfma_f32_16x16x32_bf16 v[52:55], v[128:131], v[184:187], v[52:55]
    buffer_store_dwordx3 v[220:222], v9, s[20:23], s45 offen offset:2304 sc1
    v_mfma_f32_16x16x32_bf16 v[56:59], v[124:127], v[164:167], v[56:59]
    v_mfma_f32_16x16x32_bf16 v[56:59], v[128:131], v[188:191], v[56:59]
    s_nop 7
    v_cvt_pk_bf16_f32 v132, v36, v40
    v_cvt_pk_bf16_f32 v133, v44, v48
    v_cvt_pk_bf16_f32 v134, v52, v56
    buffer_store_dwordx3 v[132:134], v9, s[20:23], s35 offen offset:0 sc1
    v_cvt_pk_bf16_f32 v136, v37, v41
    v_cvt_pk_bf16_f32 v137, v45, v49
    v_cvt_pk_bf16_f32 v138, v53, v57
    buffer_store_dwordx3 v[136:138], v9, s[20:23], s35 offen offset:768 sc1
    v_cvt_pk_bf16_f32 v140, v38, v42
    v_cvt_pk_bf16_f32 v141, v46, v50
    v_cvt_pk_bf16_f32 v142, v54, v58
    buffer_store_dwordx3 v[140:142], v9, s[20:23], s35 offen offset:1536 sc1
    v_cvt_pk_bf16_f32 v144, v39, v43
    v_cvt_pk_bf16_f32 v145, v47, v51
    v_cvt_pk_bf16_f32 v146, v55, v59
    buffer_store_dwordx3 v[144:146], v9, s[20:23], s35 offen offset:2304 sc1
    s_add_u32 s33, s33, 2
    s_branch L_done
L_drain0:
    s_waitcnt lgkmcnt(6)
    v_mfma_f32_16x16x32_bf16 v[36:39], v[84:87], a[0:3], v[12:15]
    v_mfma_f32_16x16x32_bf16 v[36:39], v[88:91], a[24:27], v[36:39]
    ds_read_b128 v[116:119], v4 offset:512
    v_mfma_f32_16x16x32_bf16 v[40:43], v[84:87], a[4:7], v[16:19]
    v_mfma_f32_16x16x32_bf16 v[40:43], v[88:91], a[28:31], v[40:43]
    ds_read_b128 v[120:123], v5 offset:512
    v_mfma_f32_16x16x32_bf16 v[44:47], v[84:87], a[8:11], v[20:23]
    v_mfma_f32_16x16x32_bf16 v[44:47], v[88:91], a[32:35], v[44:47]
    ds_read_b128 v[124:127], v6 offset:512
    v_mfma_f32_16x16x32_bf16 v[48:51], v[84:87], a[12:15], v[24:27]
    v_mfma_f32_16x16x32_bf16 v[48:51], v[88:91], a[36:39], v[48:51]
    ds_read_b128 v[128:131], v7 offset:512
    v_mfma_f32_16x16x32_bf16 v[52:55], v[84:87], a[16:19], v[28:31]
    v_cvt_pk_bf16_f32 v192, v60, v64
    v_mfma_f32_16x16x32_bf16 v[52:55], v[88:91], a[40:43], v[52:55]
    v_cvt_pk_bf16_f32 v193, v68, v72
    v_mfma_f32_16x16x32_bf16 v[56:59], v[84:87], a[20:23], v[32:35]
    v_cvt_pk_bf16_f32 v194, v76, v80
    v_mfma_f32_16x16x32_bf16 v[56:59], v[88:91], a[44:47], v[56:59]
    v_cvt_pk_bf16_f32 v196, v61, v65
    s_waitcnt lgkmcnt(8)
    v_mfma_f32_16x16x32_bf16 v[36:39], v[92:95], a[48:51], v[36:39]
    v_cvt_pk_bf16_f32 v197, v69, v73
    v_mfma_f32_16x16x32_bf16 v[36:39], v[96:99], a[72:75], v[36:39]
    v_cvt_pk_bf16_f32 v198, v77, v81
    v_mfma_f32_16x16x32_bf16 v[40:43], v[92:95], a[52:55], v[40:43]
    v_cvt_pk_bf16_f32 v200, v62, v66
    v_mfma_f32_16x16x32_bf16 v[40:43], v[96:99], a[76:79], v[40:43]
    v_cvt_pk_bf16_f32 v201, v70, v74
    v_mfma_f32_16x16x32_bf16 v[44:47], v[92:95], a[56:59], v[44:47]
    v_cvt_pk_bf16_f32 v202, v78, v82
    v_mfma_f32_16x16x32_bf16 v[44:47], v[96:99], a[80:83], v[44:47]
    v_cvt_pk_bf16_f32 v204, v63, v67
    v_mfma_f32_16x16x32_bf16 v[48:51], v[92:95], a[60:63], v[48:51]
    v_cvt_pk_bf16_f32 v205, v71, v75
    v_mfma_f32_16x16x32_bf16 v[48:51], v[96:99], a[84:87], v[48:51]
    v_cvt_pk_bf16_f32 v206, v79, v83
    v_mfma_f32_16x16x32_bf16 v[52:55], v[92:95], a[64:67], v[52:55]
    v_add_u32 v4, s37, v8
    v_mfma_f32_16x16x32_bf16 v[52:55], v[96:99], a[88:91], v[52:55]
    v_xor_b32 v5, 64, v4
    v_mfma_f32_16x16x32_bf16 v[56:59], v[92:95], a[68:71], v[56:59]
    v_xor_b32 v6, 128, v4
    v_mfma_f32_16x16x32_bf16 v[56:59], v[96:99], a[92:95], v[56:59]
    v_xor_b32 v7, 192, v4
    s_waitcnt lgkmcnt(6)
    v_mfma_f32_16x16x32_bf16 v[36:39], v[100:103], a[96:99], v[36:39]
    s_add_u32 s55, s33, 63
    v_mfma_f32_16x16x32_bf16 v[36:39], v[104:107], a[120:123], v[36:39]
    s_and_b32 s55, s55, 63
    v_mfma_f32_16x16x32_bf16 v[40:43], v[100:103], a[100:103], v[40:43]
    v_readlane_b32 s44, v148, s55
    v_mfma_f32_16x16x32_bf16 v[40:43], v[104:107], a[124:127], v[40:43]
    s_add_u32 s55, s33, 64
    v_mfma_f32_16x16x32_bf16 v[44:47], v[100:103], a[104:107], v[44:47]
    s_and_b32 s55, s55, 63
    v_mfma_f32_16x16x32_bf16 v[44:47], v[104:107], a[128:131], v[44:47]
    v_readlane_b32 s45, v148, s55
    v_mfma_f32_16x16x32_bf16 v[48:51], v[100:103], a[108:111], v[48:51]
    s_add_u32 s55, s33, 65
    v_mfma_f32_16x16x32_bf16 v[48:51], v[104:107], a[132:135], v[48:51]
    s_and_b32 s55, s55, 63
    v_mfma_f32_16x16x32_bf16 v[52:55], v[100:103], a[112:115], v[52:55]
    v_readlane_b32 s35, v148, s55
    v_mfma_f32_16x16x32_bf16 v[52:55], v[104:107], a[136:139], v[52:55]
    v_mfma_f32_16x16x32_bf16 v[56:59], v[100:103], a[116:119], v[56:59]
    v_mfma_f32_16x16x32_bf16 v[56:59], v[104:107], a[140:143], v[56:59]
    s_waitcnt lgkmcnt(4)
    v_mfma_f32_16x16x32_bf16 v[36:39], v[108:111], a[144:147], v[36:39]
    v_mfma_f32_16x16x32_bf16 v[36:39], v[112:115], a[168:171], v[36:39]
    v_mfma_f32_16x16x32_bf16 v[40:43], v[108:111], a[148:151], v[40:43]
    v_mfma_f32_16x16x32_bf16 v[40:43], v[112:115], a[172:175], v[40:43]
    v_mfma_f32_16x16x32_bf16 v[44:47], v[108:111], a[152:155], v[44:47]
    v_mfma_f32_16x16x32_bf16 v[44:47], v[112:115], a[176:179], v[44:47]
    v_mfma_f32_16x16x32_bf16 v[48:51], v[108:111], a[156:159], v[48:51]
    v_mfma_f32_16x16x32_bf16 v[48:51], v[112:115], a[180:183], v[48:51]
    v_mfma_f32_16x16x32_bf16 v[52:55], v[108:111], a[160:163], v[52:55]
    v_mfma_f32_16x16x32_bf16 v[52:55], v[112:115], a[184:187], v[52:55]
    v_mfma_f32_16x16x32_bf16 v[56:59], v[108:111], a[164:167], v[56:59]
    v_mfma_f32_16x16x32_bf16 v[56:59], v[112:115], a[188:191], v[56:59]
    s_waitcnt vmcnt(7) lgkmcnt(0)
    s_barrier
    v_mfma_f32_16x16x32_bf16 v[36:39], v[116:119], a[192:195], v[36:39]
    ds_read_b128 v[84:87], v4 offset:0
    v_mfma_f32_16x16x32_bf16 v[36:39], v[120:123], a[216:219], v[36:39]
    ds_read_b128 v[88:91], v5 offset:0
    v_mfma_f32_16x16x32_bf16 v[40:43], v[116:119], a[196:199], v[40:43]
    ds_read_b128 v[92:95], v6 offset:0
    v_mfma_f32_16x16x32_bf16 v[40:43], v[120:123], a[220:223], v[40:43]
    ds_read_b128 v[96:99], v7 offset:0
    v_mfma_f32_16x16x32_bf16 v[44:47], v[116:119], a[200:203], v[44:47]
    ds_read_b128 v[100:103], v4 offset:256
    v_mfma_f32_16x16x32_bf16 v[44:47], v[120:123], a[224:227], v[44:47]
    ds_read_b128 v[104:107], v5 offset:256
    v_mfma_f32_16x16x32_bf16 v[48:51], v[116:119], a[204:207], v[48:51]
    ds_read_b128 v[108:111], v6 offset:256
    v_mfma_f32_16x16x32_bf16 v[48:51], v[120:123], a[228:231], v[48:51]
    ds_read_b128 v[112:115], v7 offset:256
    v_mfma_f32_16x16x32_bf16 v[52:55], v[116:119], a[208:211], v[52:55]
    v_mfma_f32_16x16x32_bf16 v[52:55], v[120:123], a[232:235], v[52:55]
    v_mfma_f32_16x16x32_bf16 v[56:59], v[116:119], a[212:215], v[56:59]
    v_mfma_f32_16x16x32_bf16 v[56:59], v[120:123], a[236:239], v[56:59]
    v_mfma_f32_16x16x32_bf16 v[36:39], v[124:127], a[240:243], v[36:39]
    v_mfma_f32_16x16x32_bf16 v[36:39], v[128:131], v[168:171], v[36:39]
    v_mfma_f32_16x16x32_bf16 v[40:43], v[124:127], a[244:247], v[40:43]
    v_mfma_f32_16x16x32_bf16 v[40:43], v[128:131], v[172:175], v[40:43]
    v_mfma_f32_16x16x32_bf16 v[44:47], v[124:127], a[248:251], v[44:47]
    v_mfma_f32_16x16x32_bf16 v[44:47], v[128:131], v[176:179], v[44:47]
    v_mfma_f32_16x16x32_bf16 v[48:51], v[124:127], a[252:255], v[48:51]
    v_mfma_f32_16x16x32_bf16 v[48:51], v[128:131], v[180:183], v[48:51]
    v_mfma_f32_16x16x32_bf16 v[52:55], v[124:127], v[160:163], v[52:55]
    v_mfma_f32_16x16x32_bf16 v[52:55], v[128:131], v[184:187], v[52:55]
    v_mfma_f32_16x16x32_bf16 v[56:59], v[124:127], v[164:167], v[56:59]
    v_mfma_f32_16x16x32_bf16 v[56:59], v[128:131], v[188:191], v[56:59]
    s_waitcnt lgkmcnt(6)
    v_mfma_f32_16x16x32_bf16 v[60:63], v[84:87], a[0:3], v[12:15]
    v_mfma_f32_16x16x32_bf16 v[60:63], v[88:91], a[24:27], v[60:63]
    ds_read_b128 v[116:119], v4 offset:512
    v_mfma_f32_16x16x32_bf16 v[64:67], v[84:87], a[4:7], v[16:19]
    v_mfma_f32_16x16x32_bf16 v[64:67], v[88:91], a[28:31], v[64:67]
    ds_read_b128 v[120:123], v5 offset:512
    v_mfma_f32_16x16x32_bf16 v[68:71], v[84:87], a[8:11], v[20:23]
    v_mfma_f32_16x16x32_bf16 v[68:71], v[88:91], a[32:35], v[68:71]
    ds_read_b128 v[124:127], v6 offset:512
    v_mfma_f32_16x16x32_bf16 v[72:75], v[84:87], a[12:15], v[24:27]
    v_mfma_f32_16x16x32_bf16 v[72:75], v[88:91], a[36:39], v[72:75]
    ds_read_b128 v[128:131], v7 offset:512
    v_mfma_f32_16x16x32_bf16 v[76:79], v[84:87], a[16:19], v[28:31]
    v_cvt_pk_bf16_f32 v208, v36, v40
    v_mfma_f32_16x16x32_bf16 v[76:79], v[88:91], a[40:43], v[76:79]
    v_cvt_pk_bf16_f32 v209, v44, v48
    v_mfma_f32_16x16x32_bf16 v[80:83], v[84:87], a[20:23], v[32:35]
    v_cvt_pk_bf16_f32 v210, v52, v56
    v_mfma_f32_16x16x32_bf16 v[80:83], v[88:91], a[44:47], v[80:83]
    v_cvt_pk_bf16_f32 v212, v37, v41
    s_waitcnt lgkmcnt(8)
    v_mfma_f32_16x16x32_bf16 v[60:63], v[92:95], a[48:51], v[60:63]
    v_cvt_pk_bf16_f32 v213, v45, v49
    v_mfma_f32_16x16x32_bf16 v[60:63], v[96:99], a[72:75], v[60:63]
    v_cvt_pk_bf16_f32 v214, v53, v57
    v_mfma_f32_16x16x32_bf16 v[64:67], v[92:95], a[52:55], v[64:67]
    v_cvt_pk_bf16_f32 v216, v38, v42
    v_mfma_f32_16x16x32_bf16 v[64:67], v[96:99], a[76:79], v[64:67]
    v_cvt_pk_bf16_f32 v217, v46, v50
    v_mfma_f32_16x16x32_bf16 v[68:71], v[92:95], a[56:59], v[68:71]
    v_cvt_pk_bf16_f32 v218, v54, v58
    v_mfma_f32_16x16x32_bf16 v[68:71], v[96:99], a[80:83], v[68:71]
    v_cvt_pk_bf16_f32 v220, v39, v43
    v_mfma_f32_16x16x32_bf16 v[72:75], v[92:95], a[60:63], v[72:75]
    v_cvt_pk_bf16_f32 v221, v47, v51
    v_mfma_f32_16x16x32_bf16 v[72:75], v[96:99], a[84:87], v[72:75]
    v_cvt_pk_bf16_f32 v222, v55, v59
    v_mfma_f32_16x16x32_bf16 v[76:79], v[92:95], a[64:67], v[76:79]
    v_mfma_f32_16x16x32_bf16 v[76:79], v[96:99], a[88:91], v[76:79]
    v_mfma_f32_16x16x32_bf16 v[80:83], v[92:95], a[68:71], v[80:83]
    v_mfma_f32_16x16x32_bf16 v[80:83], v[96:99], a[92:95], v[80:83]
    s_waitcnt lgkmcnt(6)
    v_mfma_f32_16x16x32_bf16 v[60:63], v[100:103], a[96:99], v[60:63]
    v_mfma_f32_16x16x32_bf16 v[60:63], v[104:107], a[120:123], v[60:63]
    v_mfma_f32_16x16x32_bf16 v[64:67], v[100:103], a[100:103], v[64:67]
    v_mfma_f32_16x16x32_bf16 v[64:67], v[104:107], a[124:127], v[64:67]
    v_mfma_f32_16x16x32_bf16 v[68:71], v[100:103], a[104:107], v[68:71]
    v_mfma_f32_16x16x32_bf16 v[68:71], v[104:107], a[128:131], v[68:71]
    v_mfma_f32_16x16x32_bf16 v[72:75], v[100:103], a[108:111], v[72:75]
    v_mfma_f32_16x16x32_bf16 v[72:75], v[104:107], a[132:135], v[72:75]
    v_mfma_f32_16x16x32_bf16 v[76:79], v[100:103], a[112:115], v[76:79]
    v_mfma_f32_16x16x32_bf16 v[76:79], v[104:107], a[136:139], v[76:79]
    v_mfma_f32_16x16x32_bf16 v[80:83], v[100:103], a[116:119], v[80:83]
    v_mfma_f32_16x16x32_bf16 v[80:83], v[104:107], a[140:143], v[80:83]
    s_waitcnt lgkmcnt(4)
    v_mfma_f32_16x16x32_bf16 v[60:63], v[108:111], a[144:147], v[60:63]
    v_mfma_f32_16x16x32_bf16 v[60:63], v[112:115], a[168:171], v[60:63]
    v_mfma_f32_16x16x32_bf16 v[64:67], v[108:111], a[148:151], v[64:67]
    v_mfma_f32_16x16x32_bf16 v[64:67], v[112:115], a[172:175], v[64:67]
    v_mfma_f32_16x16x32_bf16 v[68:71], v[108:111], a[152:155], v[68:71]
    v_mfma_f32_16x16x32_bf16 v[68:71], v[112:115], a[176:179], v[68:71]
    v_mfma_f32_16x16x32_bf16 v[72:75], v[108:111], a[156:159], v[72:75]
    v_mfma_f32_16x16x32_bf16 v[72:75], v[112:115], a[180:183], v[72:75]
    v_mfma_f32_16x16x32_bf16 v[76:79], v[108:111], a[160:163], v[76:79]
    v_mfma_f32_16x16x32_bf16 v[76:79], v[112:115], a[184:187], v[76:79]
    v_mfma_f32_16x16x32_bf16 v[80:83], v[108:111], a[164:167], v[80:83]
    v_mfma_f32_16x16x32_bf16 v[80:83], v[112:115], a[188:191], v[80:83]
    s_waitcnt lgkmcnt(2)
    v_mfma_f32_16x16x32_bf16 v[60:63], v[116:119], a[192:195], v[60:63]
    buffer_store_dwordx3 v[192:194], v9, s[20:23], s44 offen offset:0 sc1
    v_mfma_f32_16x16x32_bf16 v[60:63], v[120:123], a[216:219], v[60:63]
    v_mfma_f32_16x16x32_bf16 v[64:67], v[116:119], a[196:199], v[64:67]
    v_mfma_f32_16x16x32_bf16 v[64:67], v[120:123], a[220:223], v[64:67]
    buffer_store_dwordx3 v[196:198], v9, s[20:23], s44 offen offset:768 sc1
    v_mfma_f32_16x16x32_bf16 v[68:71], v[116:119], a[200:203], v[68:71]
    v_mfma_f32_16x16x32_bf16 v[68:71], v[120:123], a[224:227], v[68:71]
    v_mfma_f32_16x16x32_bf16 v[72:75], v[116:119], a[204:207], v[72:75]
    buffer_store_dwordx3 v[200:202], v9, s[20:23], s44 offen offset:1536 sc1
    v_mfma_f32_16x16x32_bf16 v[72:75], v[120:123], a[228:231], v[72:75]
    v_mfma_f32_16x16x32_bf16 v[76:79], v[116:119], a[208:211], v[76:79]
    v_mfma_f32_16x16x32_bf16 v[76:79], v[120:123], a[232:235], v[76:79]
    buffer_store_dwordx3 v[204:206], v9, s[20:23], s44 offen offset:2304 sc1
    v_mfma_f32_16x16x32_bf16 v[80:83], v[116:119], a[212:215], v[80:83]
    v_mfma_f32_16x16x32_bf16 v[80:83], v[120:123], a[236:239], v[80:83]
    s_waitcnt lgkmcnt(0)
    v_mfma_f32_16x16x32_bf16 v[60:63], v[124:127], a[240:243], v[60:63]
    buffer_store_dwordx3 v[208:210], v9, s[20:23], s45 offen offset:0 sc1
    v_mfma_f32_16x16x32_bf16 v[60:63], v[128:131], v[168:171], v[60:63]
    v_mfma_f32_16x16x32_bf16 v[64:67], v[124:127], a[244:247], v[64:67]
    v_mfma_f32_16x16x32_bf16 v[64:67], v[128:131], v[172:175], v[64:67]
    buffer_store_dwordx3 v[212:214], v9, s[20:23], s45 offen offset:768 sc1
    v_mfma_f32_16x16x32_bf16 v[68:71], v[124:127], a[248:251], v[68:71]
    v_mfma_f32_16x16x32_bf16 v[68:71], v[128:131], v[176:179], v[68:71]
    v_mfma_f32_16x16x32_bf16 v[72:75], v[124:127], a[252:255], v[72:75]
    buffer_store_dwordx3 v[216:218], v9, s[20:23], s45 offen offset:1536 sc1
    v_mfma_f32_16x16x32_bf16 v[72:75], v[128:131], v[180:183], v[72:75]
    v_mfma_f32_16x16x32_bf16 v[76:79], v[124:127], v[160:163], v[76:79]
    v_mfma_f32_16x16x32_bf16 v[76:79], v[128:131], v[184:187], v[76:79]
    buffer_store_dwordx3 v[220:222], v9, s[20:23], s45 offen offset:2304 sc1
    v_mfma_f32_16x16x32_bf16 v[80:83], v[124:127], v[164:167], v[80:83]
    v_mfma_f32_16x16x32_bf16 v[80:83], v[128:131], v[188:191], v[80:83]
    s_nop 7
    v_cvt_pk_bf16_f32 v132, v60, v64
    v_cvt_pk_bf16_f32 v133, v68, v72
    v_cvt_pk_bf16_f32 v134, v76, v80
    buffer_store_dwordx3 v[132:134], v9, s[20:23], s35 offen offset:0 sc1
    v_cvt_pk_bf16_f32 v136, v61, v65
    v_cvt_pk_bf16_f32 v137, v69, v73
    v_cvt_pk_bf16_f32 v138, v77, v81
    buffer_store_dwordx3 v[136:138], v9, s[20:23], s35 offen offset:768 sc1
    v_cvt_pk_bf16_f32 v140, v62, v66
    v_cvt_pk_bf16_f32 v141, v70, v74
    v_cvt_pk_bf16_f32 v142, v78, v82
    buffer_store_dwordx3 v[140:142], v9, s[20:23], s35 offen offset:1536 sc1
    v_cvt_pk_bf16_f32 v144, v63, v67
    v_cvt_pk_bf16_f32 v145, v71, v75
    v_cvt_pk_bf16_f32 v146, v79, v83
    buffer_store_dwordx3 v[144:146], v9, s[20:23], s35 offen offset:2304 sc1
    s_add_u32 s33, s33, 2
L_done:
L_end:
    s_endpgm
.section .rodata,"a"
.p2align 6
.amdhsa_kernel standalone__standard_2d_1d_3d_conv__vision_kernel
  .amdhsa_next_free_vgpr 512
  .amdhsa_next_free_sgpr 102
  .amdhsa_accum_offset 256
  .amdhsa_group_segment_fixed_size 0
  .amdhsa_kernarg_size 48
  .amdhsa_user_sgpr_count 2
  .amdhsa_user_sgpr_kernarg_segment_ptr 1
  .amdhsa_system_sgpr_workgroup_id_x 1
.end_amdhsa_kernel
```
